```python
import torch

def _softmax(x, axis=-1):
    return torch.softmax(x, dim=axis)

def _gelu(x):
    return torch.nn.functional.gelu(x, approximate='tanh')

def _silu(x):
    return torch.nn.functional.silu(x)

def _sigmoid(x):
    return torch.sigmoid(x)

def _layernorm(x, axis=-1, eps=1e-05):
    m = x.mean(dim=axis, keepdim=True)
    v = x.var(dim=axis, keepdim=True, unbiased=False)
    return (x - m) / torch.sqrt(v + eps)

def _scatter_add(tgt, idx, src, axis=0):
    return tgt.clone().index_add_(axis, idx, src)

def _segment_sum(src, seg, n):
    out = torch.zeros((n,) + src.shape[1:], dtype=src.dtype)
    return out.index_add_(0, seg, src)

def _pad(x, pw):
    flat = tuple((v for pair in reversed(pw) for v in pair))
    return torch.nn.functional.pad(x, flat)
kernel_name = 'standalone__dilated_atrous__vision'

def setup_inputs():

    _w = lambda a: (lambda t: t.to(torch.bfloat16) if t.is_floating_point() else t)(torch.as_tensor(a))
    H = W = 224
    C = 96
    k = 5
    return {'x': _w((lambda *s: torch.randn(*s, dtype=torch.bfloat16) * 0.05)(1, H, W, C)), 'w': _w((lambda *s: torch.randn(*s, dtype=torch.bfloat16) * 0.05)(k, k, C, C) * (1.0 / (k * C ** 0.5)))}

def reference(x, w):
    B, H, W, C = x.shape
    k = 5
    rate = 2
    pad = (k - 1) * rate // 2
    xp = _pad(x, ((0, 0), (pad, pad), (pad, pad), (0, 0)))
    out = torch.zeros_like(x)
    for i in range(k):
        for j in range(k):
            tap = xp[:, i * rate:i * rate + H, j * rate:j * rate + W, :].clone()
            out = out + torch.einsum('bhwc,co->bhwo', tap, w[i, j])
    return out
```

```asm
; @launch grid=(256,1,1) block=(512,1,1) lds=163840
.amdgcn_target "amdgcn-amd-amdhsa--gfx950"
.text
.globl standalone__dilated_atrous__vision_kernel
.p2align 12
.p2align 8
.type standalone__dilated_atrous__vision_kernel,@function
standalone__dilated_atrous__vision_kernel:
    s_cmp_lt_u32 s2, 256
    s_cbranch_scc1 L_go
    s_endpgm
L_go:
    s_load_dwordx8 s[4:11], s[0:1], 0
    s_load_dwordx2 s[24:25], s[0:1], 32
    v_lshrrev_b32 v1, 6, v0
    s_nop 0
    v_readfirstlane_b32 s36, v1
    v_and_b32 v0, 63, v0
    s_cmp_lg_u32 s36, 2
    s_cbranch_scc1 L_n0
    s_and_b32 s59, s2, 7
    s_mul_i32 s59, s59, 23
    s_lshr_b32 s58, s2, 3
    s_add_u32 s59, s59, s58
    s_cmp_ge_u32 s58, 23
    s_cselect_b32 s59, 255, s59
    s_cmp_lt_u32 s59, 180
    s_cbranch_scc1 L_prod
    s_branch L_noprod0
L_prod:
    s_setprio 3
    s_mul_i32 s46, s59, 3641
    s_lshr_b32 s46, s46, 16
    s_mul_i32 s47, s46, 18
    s_sub_u32 s47, s59, s47
    s_cmp_ge_u32 s46, 5
    s_cselect_b32 s48, 5, 0
    s_cselect_b32 s50, 1, 5
    s_cselect_b32 s51, 5, 1
    s_sub_u32 s49, s46, s48
    s_mul_i32 s50, s50, s49
    s_mul_i32 s50, s50, 18432
    s_mul_i32 s51, s51, 18432
    s_mul_i32 s56, s47, 86
    s_lshr_b32 s56, s56, 8
    s_mul_i32 s57, s56, 3072 - 192
    s_lshl_b32 s58, s47, 6
    s_add_u32 s50, s50, s57
    s_add_u32 s50, s50, s58
    v_lshrrev_b32 v188, 2, v0
    v_mul_u32_u24 v188, 192, v188
    v_and_b32 v189, 3, v0
    v_lshl_add_u32 v188, v189, 4, v188
    s_waitcnt lgkmcnt(0)
    s_mov_b32 s16, s6
    s_and_b32 s17, s7, 0xffff
    s_mov_b32 s18, 0x70800
    s_mov_b32 s19, 0x20000
    buffer_load_dwordx4 v[124:127], v188, s[16:19], s50 offen
    s_add_u32 s50, s50, s51
    buffer_load_dwordx4 v[132:135], v188, s[16:19], s50 offen
    s_add_u32 s50, s50, s51
    buffer_load_dwordx4 v[140:143], v188, s[16:19], s50 offen
    s_add_u32 s50, s50, s51
    buffer_load_dwordx4 v[148:151], v188, s[16:19], s50 offen
    s_add_u32 s50, s50, s51
    buffer_load_dwordx4 v[156:159], v188, s[16:19], s50 offen
    s_branch L_prod2
L_n0:
    s_cmp_lt_u32 s36, 4
    s_cbranch_scc1 L_c
L_h:
    s_setprio 3
    v_lshrrev_b32 v21, 4, v0
    v_bfe_u32 v22, v0, 2, 2
    v_and_b32 v23, 3, v0
    v_bfrev_b32 v24, 2
    s_bfe_u32 s32, s2, 0x20003
    s_lshr_b32 s39, s32, 1
    s_and_b32 s37, s32, 1
    s_xor_b32 s38, s37, s39
    s_lshl_b32 s56, s38, 1
    s_sub_u32 s56, 1, s56
    s_bitcmp1_b32 s2, 5
    s_cselect_b32 s40, 0, 128
    s_cselect_b32 s41, 64, 0
    s_cselect_b32 s42, 128, 64
    s_bfe_u32 s48, s2, 0x10005
    s_bfe_u32 s49, s2, 0x10006
    s_lshr_b32 s50, s2, 7
    s_and_b32 s51, s2, 1
    s_lshl1_add_u32 s50, s51, s50
    s_bfe_u32 s51, s2, 0x20001
    s_lshl_b32 s59, s32, 3
    s_lshr_b32 s57, 0x0c1b0000, s59
    s_and_b32 s57, s57, 0xff
    s_lshr_b32 s58, 0x000c1b00, s59
    s_and_b32 s58, s58, 0xff
    s_mul_i32 s59, s51, 28
    s_add_u32 s57, s57, s59
    s_mul_i32 s59, s50, 28
    s_add_u32 s58, s58, s59
    s_lshl1_add_u32 s57, s57, s49
    s_lshl1_add_u32 s58, s58, s48
    s_mul_i32 s57, s57, 224
    s_add_u32 s57, s57, s58
    s_mul_i32 s33, s57, 192
    s_mov_b32 s57, 86016
    s_cmp_eq_u32 s37, 1
    s_cselect_b32 s35, s57, 384
    s_cselect_b32 s34, 384, s57
    s_cselect_b32 s46, s50, s51
    s_cselect_b32 s47, s51, s50
    s_mul_i32 s34, s34, s56
    s_mul_i32 s58, s38, 3
    s_cmp_eq_u32 s46, s58
    s_cselect_b32 s58, 2, 0
    s_sub_u32 s46, s36, 4
    s_cmp_eq_u32 s46, 0
    s_cselect_b32 s58, s58, 0
    v_cmp_gt_u32 vcc, s58, v21
    v_mul_i32_i24 v25, s34, v21
    v_mad_i32_i24 v25, v22, s35, v25
    v_lshl_add_u32 v25, v23, 4, v25
    s_lshl2_add_u32 s57, s46, -2
    s_mul_i32 s57, s57, s34
    s_add_u32 s57, s57, s33
    s_lshl1_add_u32 s57, s35, s57
    v_add_u32 v26, s57, v25
    v_cndmask_b32 v2, v26, v24, vcc
    s_lshl_b32 s101, s35, 2
    s_mul_i32 s59, s39, 3
    s_cmp_eq_u32 s47, s59
    s_cselect_b32 s57, 2, 0
    s_cmp_eq_u32 s39, 0
    s_cselect_b32 s58, s57, 0
    s_cselect_b32 s57, 0, s57
    s_sub_u32 s57, 4, s57
    v_cmp_gt_u32 vcc, s58, v22
    v_subrev_u32 v26, s101, v2
    s_mul_i32 s47, s46, 5120
    v_cndmask_b32 v1, v26, v24, vcc
    v_cmp_le_u32 vcc, s57, v22
    s_sub_u32 s100, 1, s39
    s_mul_i32 s100, s100, 6
    v_cndmask_b32 v3, v2, v24, vcc
    s_lshl1_add_u32 s57, s100, -2
    s_mul_i32 s57, s57, s35
    s_mul_i32 s58, s34, 14
    s_add_u32 s57, s57, s58
    s_add_u32 s57, s57, s33
    v_add_u32 v4, s57, v25
    s_waitcnt lgkmcnt(0)
    s_mov_b32 s12, s4
    s_and_b32 s13, s5, 0xffff
    s_mov_b32 s14, 0x930000
    s_mov_b32 s15, 0x20000
    s_cmp_lg_u32 s46, 0
    s_cbranch_scc1 L_ne0
    s_mov_b32 m0, 153600
    s_mov_b32 s58, s40
    buffer_load_dwordx4 v4, s[12:15], s58 offen lds
    s_mov_b32 m0, 154624
    s_add_u32 s58, s40, s101
    buffer_load_dwordx4 v4, s[12:15], s58 offen lds
L_ne0:
    s_add_u32 m0, s47, 61440
    s_mov_b32 s58, s40
    buffer_load_dwordx4 v1, s[12:15], s58 offen lds
    s_add_u32 m0, s47, 62464
    s_nop 0
    buffer_load_dwordx4 v2, s[12:15], s58 offen lds
    s_add_u32 m0, s47, 63488
    s_add_u32 s58, s58, s101
    buffer_load_dwordx4 v2, s[12:15], s58 offen lds
    s_add_u32 m0, s47, 64512
    s_add_u32 s58, s58, s101
    buffer_load_dwordx4 v2, s[12:15], s58 offen lds
    s_add_u32 m0, s47, 65536
    s_add_u32 s58, s58, s101
    buffer_load_dwordx4 v3, s[12:15], s58 offen lds
    s_cmp_ge_u32 s46, 2
    s_cbranch_scc1 L_hB
    s_branch L_lateA
L_hB:
    s_branch L_lateB
L_c:
    s_cmp_lg_u32 s36, 0
    s_cbranch_scc1 L_cw
    s_getpc_b64 s[56:57]
L_pc:
    s_add_u32 s56, s56, standalone__dilated_atrous__vision_kernel + 2048 - L_pc
    s_addc_u32 s57, s57, 0
    s_lshr_b32 s58, s2, 3
    s_mul_i32 s59, s58, 43
    s_lshr_b32 s59, s59, 8
    s_mul_i32 s59, s59, 6
    s_sub_u32 s58, s58, s59
    s_lshl_b32 s58, s58, 13
    v_lshlrev_b32 v2, 7, v0
    v_add_u32 v2, s58, v2
    global_load_dword v20, v2, s[56:57]
    s_branch L_noprod0
L_cw:
    s_lshr_b32 s99, s36, 1
    s_bfe_u32 s32, s2, 0x20003
    s_lshr_b32 s39, s32, 1
    s_and_b32 s37, s32, 1
    s_xor_b32 s38, s37, s39
    s_lshl_b32 s56, s38, 1
    s_sub_u32 s56, 1, s56
    s_bitcmp1_b32 s2, 5
    s_cselect_b32 s40, 0, 128
    s_cselect_b32 s41, 64, 0
    s_cselect_b32 s42, 128, 64
    s_mul_i32 s99, s99, 3072
    s_mov_b32 s57, 92160
    s_cmp_eq_u32 s37, 1
    s_cselect_b32 s95, 18432, s57
    s_cselect_b32 s96, s57, 18432
    s_mul_i32 s94, s95, s38
    s_lshl2_add_u32 s94, s94, s99
    s_mul_i32 s95, s95, s56
    s_lshl2_add_u32 s96, s96, s94
    s_mul_i32 s97, s37, 5
    s_add_u32 s97, s97, s38
    s_mul_i32 s97, s97, 73728
    s_add_u32 s97, s97, s99
    s_mul_i32 s98, s56, 18432
    v_lshlrev_b32 v22, 4, v0
    v_and_b32 v23, 32, v0
    v_xor_b32 v23, v23, v22
    v_xor_b32 v24, 32, v22
    s_setprio 1
    s_waitcnt lgkmcnt(0)
    s_mov_b32 s16, s6
    s_and_b32 s17, s7, 0xffff
    s_mov_b32 s18, 0x70800
    s_mov_b32 s19, 0x20000
    s_mul_i32 s59, s40, 96
    s_add_u32 s59, s59, s94
    s_add_u32 m0, s99, 0
    s_nop 0
    buffer_load_dwordx4 v22, s[16:19], s59 offen offset:0 lds
    buffer_load_dwordx4 v23, s[16:19], s59 offen offset:1024 lds
    buffer_load_dwordx4 v24, s[16:19], s59 offen offset:2048 lds
    s_add_u32 m0, s99, 6144
    s_add_u32 s59, s59, s95
    buffer_load_dwordx4 v22, s[16:19], s59 offen offset:0 lds
    buffer_load_dwordx4 v23, s[16:19], s59 offen offset:1024 lds
    buffer_load_dwordx4 v24, s[16:19], s59 offen offset:2048 lds
    s_add_u32 m0, s99, 12288
    s_add_u32 s59, s59, s95
    buffer_load_dwordx4 v22, s[16:19], s59 offen offset:0 lds
    buffer_load_dwordx4 v23, s[16:19], s59 offen offset:1024 lds
    buffer_load_dwordx4 v24, s[16:19], s59 offen offset:2048 lds
    s_add_u32 m0, s99, 18432
    s_add_u32 s59, s59, s95
    buffer_load_dwordx4 v22, s[16:19], s59 offen offset:0 lds
    buffer_load_dwordx4 v23, s[16:19], s59 offen offset:1024 lds
    buffer_load_dwordx4 v24, s[16:19], s59 offen offset:2048 lds
    s_add_u32 m0, s99, 24576
    s_add_u32 s59, s59, s95
    buffer_load_dwordx4 v22, s[16:19], s59 offen offset:0 lds
    buffer_load_dwordx4 v23, s[16:19], s59 offen offset:1024 lds
    buffer_load_dwordx4 v24, s[16:19], s59 offen offset:2048 lds
    s_setprio 1
    s_mul_i32 s59, s40, 96
    s_add_u32 s59, s59, s96
    s_add_u32 m0, s99, 30720
    s_nop 0
    buffer_load_dwordx4 v22, s[16:19], s59 offen offset:0 lds
    buffer_load_dwordx4 v23, s[16:19], s59 offen offset:1024 lds
    buffer_load_dwordx4 v24, s[16:19], s59 offen offset:2048 lds
    s_add_u32 m0, s99, 36864
    s_add_u32 s59, s59, s95
    buffer_load_dwordx4 v22, s[16:19], s59 offen offset:0 lds
    buffer_load_dwordx4 v23, s[16:19], s59 offen offset:1024 lds
    buffer_load_dwordx4 v24, s[16:19], s59 offen offset:2048 lds
    s_add_u32 m0, s99, 43008
    s_add_u32 s59, s59, s95
    buffer_load_dwordx4 v22, s[16:19], s59 offen offset:0 lds
    buffer_load_dwordx4 v23, s[16:19], s59 offen offset:1024 lds
    buffer_load_dwordx4 v24, s[16:19], s59 offen offset:2048 lds
    s_add_u32 m0, s99, 49152
    s_add_u32 s59, s59, s95
    buffer_load_dwordx4 v22, s[16:19], s59 offen offset:0 lds
    buffer_load_dwordx4 v23, s[16:19], s59 offen offset:1024 lds
    buffer_load_dwordx4 v24, s[16:19], s59 offen offset:2048 lds
    s_add_u32 m0, s99, 55296
    s_add_u32 s59, s59, s95
    buffer_load_dwordx4 v22, s[16:19], s59 offen offset:0 lds
    buffer_load_dwordx4 v23, s[16:19], s59 offen offset:1024 lds
    buffer_load_dwordx4 v24, s[16:19], s59 offen offset:2048 lds
    s_branch L_noprod0
L_prod2:
    s_and_b32 s25, s25, 0xffff
    s_mov_b32 s26, 0xb4000
    s_mov_b32 s27, 0x20000
    s_lshl_b32 s48, s48, 2
    s_add_u32 s48, s48, s49
    s_mul_i32 s48, s48, 18432
    s_mul_i32 s58, s56, 3
    s_sub_u32 s58, s47, s58
    s_lshl_b32 s58, s58, 11
    s_add_u32 s48, s48, s58
    s_lshr_b32 s58, s56, 1
    s_mul_i32 s58, s58, 6144
    s_add_u32 s48, s48, s58
    s_and_b32 s58, s56, 1
    s_lshl_b32 s58, s58, 9
    s_add_u32 s48, s48, s58
    s_mov_b32 s47, 0xffff0000
    v_lshlrev_b32 v189, 4, v0
    v_add_u32 v191, 159744, v189
    v_bfe_u32 v190, v0, 2, 2
    v_bfe_u32 v160, v0, 4, 1
    v_lshl_add_u32 v190, v160, 3, v190
    v_lshlrev_b32 v190, 6, v190
    v_and_b32 v160, 3, v0
    v_lshl_add_u32 v190, v160, 3, v190
    v_and_b32 v160, 32, v0
    v_add_u32 v190, v190, v160
    v_add_u32 v190, 159744, v190
    v_lshl_add_u32 v189, v160, 4, v189
    s_mov_b32 s50, 0x3e572045
    s_mov_b32 s51, 0xbf303b34
    s_waitcnt vmcnt(4)
    v_lshlrev_b32 v160, 16, v124
    v_and_b32 v161, s47, v124
    v_lshlrev_b32 v162, 16, v125
    v_and_b32 v163, s47, v125
    v_lshlrev_b32 v164, 16, v126
    v_and_b32 v165, s47, v126
    v_lshlrev_b32 v166, 16, v127
    v_and_b32 v167, s47, v127
    v_mul_f32 v168, s50, v160
    v_mul_f32 v169, s50, v161
    v_mul_f32 v170, s50, v162
    v_mul_f32 v171, s50, v163
    v_mul_f32 v172, s50, v164
    v_mul_f32 v173, s50, v165
    v_mul_f32 v174, s50, v166
    v_mul_f32 v175, s50, v167
    v_mul_f32 v120, s51, v160
    v_mul_f32 v121, s51, v161
    v_mul_f32 v122, s51, v162
    v_mul_f32 v123, s51, v163
    v_mul_f32 v128, s51, v164
    v_mul_f32 v129, s51, v165
    v_mul_f32 v130, s51, v166
    v_mul_f32 v131, s51, v167
    s_mov_b32 s50, 0x3ea15834
    s_mov_b32 s51, 0xbedc4a01
    s_waitcnt vmcnt(3)
    v_lshlrev_b32 v160, 16, v132
    v_and_b32 v161, s47, v132
    v_lshlrev_b32 v162, 16, v133
    v_and_b32 v163, s47, v133
    v_lshlrev_b32 v164, 16, v134
    v_and_b32 v165, s47, v134
    v_lshlrev_b32 v166, 16, v135
    v_and_b32 v167, s47, v135
    v_mul_f32 v176, s50, v160
    v_mul_f32 v177, s50, v161
    v_mul_f32 v178, s50, v162
    v_mul_f32 v179, s50, v163
    v_mul_f32 v180, s50, v164
    v_mul_f32 v181, s50, v165
    v_mul_f32 v182, s50, v166
    v_mul_f32 v183, s50, v167
    v_mul_f32 v136, s51, v160
    v_mul_f32 v137, s51, v161
    v_mul_f32 v138, s51, v162
    v_mul_f32 v139, s51, v163
    v_mul_f32 v144, s51, v164
    v_mul_f32 v145, s51, v165
    v_mul_f32 v146, s51, v166
    v_mul_f32 v147, s51, v167
    s_mov_b32 s50, 0x3ef2044d
    s_mov_b32 s51, 0xbe89ae41
    s_waitcnt vmcnt(2)
    v_lshlrev_b32 v160, 16, v140
    v_and_b32 v161, s47, v140
    v_lshlrev_b32 v162, 16, v141
    v_and_b32 v163, s47, v141
    v_lshlrev_b32 v164, 16, v142
    v_and_b32 v165, s47, v142
    v_lshlrev_b32 v166, 16, v143
    v_and_b32 v167, s47, v143
    v_fmac_f32 v168, s50, v160
    v_fmac_f32 v169, s50, v161
    v_fmac_f32 v170, s50, v162
    v_fmac_f32 v171, s50, v163
    v_fmac_f32 v172, s50, v164
    v_fmac_f32 v173, s50, v165
    v_fmac_f32 v174, s50, v166
    v_fmac_f32 v175, s50, v167
    v_fmac_f32 v120, s51, v160
    v_fmac_f32 v121, s51, v161
    v_fmac_f32 v122, s51, v162
    v_fmac_f32 v123, s51, v163
    v_fmac_f32 v128, s51, v164
    v_fmac_f32 v129, s51, v165
    v_fmac_f32 v130, s51, v166
    v_fmac_f32 v131, s51, v167
    s_mov_b32 s50, 0x3f35833a
    s_mov_b32 s51, 0xbe2c19d1
    s_waitcnt vmcnt(1)
    v_lshlrev_b32 v160, 16, v148
    v_and_b32 v161, s47, v148
    v_lshlrev_b32 v162, 16, v149
    v_and_b32 v163, s47, v149
    v_lshlrev_b32 v164, 16, v150
    v_and_b32 v165, s47, v150
    v_lshlrev_b32 v166, 16, v151
    v_and_b32 v167, s47, v151
    v_fmac_f32 v176, s50, v160
    v_fmac_f32 v177, s50, v161
    v_fmac_f32 v178, s50, v162
    v_fmac_f32 v179, s50, v163
    v_fmac_f32 v180, s50, v164
    v_fmac_f32 v181, s50, v165
    v_fmac_f32 v182, s50, v166
    v_fmac_f32 v183, s50, v167
    v_fmac_f32 v136, s51, v160
    v_fmac_f32 v137, s51, v161
    v_fmac_f32 v138, s51, v162
    v_fmac_f32 v139, s51, v163
    v_fmac_f32 v144, s51, v164
    v_fmac_f32 v145, s51, v165
    v_fmac_f32 v146, s51, v166
    v_fmac_f32 v147, s51, v167
    s_mov_b32 s50, 0x3f88226c
    s_mov_b32 s51, 0xbdd72045
    s_waitcnt vmcnt(0)
    v_lshlrev_b32 v160, 16, v156
    v_and_b32 v161, s47, v156
    v_lshlrev_b32 v162, 16, v157
    v_and_b32 v163, s47, v157
    v_lshlrev_b32 v164, 16, v158
    v_and_b32 v165, s47, v158
    v_lshlrev_b32 v166, 16, v159
    v_and_b32 v167, s47, v159
    v_fmac_f32 v168, s50, v160
    v_fmac_f32 v169, s50, v161
    v_fmac_f32 v170, s50, v162
    v_fmac_f32 v171, s50, v163
    v_fmac_f32 v172, s50, v164
    v_fmac_f32 v173, s50, v165
    v_fmac_f32 v174, s50, v166
    v_fmac_f32 v175, s50, v167
    v_fmac_f32 v120, s51, v160
    v_fmac_f32 v121, s51, v161
    v_fmac_f32 v122, s51, v162
    v_fmac_f32 v123, s51, v163
    v_fmac_f32 v128, s51, v164
    v_fmac_f32 v129, s51, v165
    v_fmac_f32 v130, s51, v166
    v_fmac_f32 v131, s51, v167
    s_mov_b32 s50, 0xbfa00000
    v_add_f32 v160, v168, v176
    v_add_f32 v161, v169, v177
    v_add_f32 v162, v170, v178
    v_add_f32 v163, v171, v179
    v_add_f32 v164, v172, v180
    v_add_f32 v165, v173, v181
    v_add_f32 v166, v174, v182
    v_add_f32 v167, v175, v183
    v_sub_f32 v176, v168, v176
    v_sub_f32 v177, v169, v177
    v_sub_f32 v178, v170, v178
    v_sub_f32 v179, v171, v179
    v_sub_f32 v180, v172, v180
    v_sub_f32 v181, v173, v181
    v_sub_f32 v182, v174, v182
    v_sub_f32 v183, v175, v183
    v_cvt_pk_bf16_f32 v124, v160, v161
    v_cvt_pk_bf16_f32 v125, v162, v163
    v_cvt_pk_bf16_f32 v126, v164, v165
    v_cvt_pk_bf16_f32 v127, v166, v167
    ds_write_b128 v191, v[124:127] offset:0
    v_cvt_pk_bf16_f32 v132, v176, v177
    v_cvt_pk_bf16_f32 v133, v178, v179
    v_cvt_pk_bf16_f32 v134, v180, v181
    v_cvt_pk_bf16_f32 v135, v182, v183
    ds_write_b128 v191, v[132:135] offset:1024
    ds_read_b64_tr_b16 v[168:169], v190 offset:0
    ds_read_b64_tr_b16 v[170:171], v190 offset:256
    ds_read_b64_tr_b16 v[172:173], v190 offset:1024
    ds_read_b64_tr_b16 v[174:175], v190 offset:1280
    v_add_f32 v160, v120, v136
    v_add_f32 v161, v121, v137
    v_add_f32 v162, v122, v138
    v_add_f32 v163, v123, v139
    v_add_f32 v164, v128, v144
    v_add_f32 v165, v129, v145
    v_add_f32 v166, v130, v146
    v_add_f32 v167, v131, v147
    v_sub_f32 v136, v120, v136
    v_sub_f32 v137, v121, v137
    v_sub_f32 v138, v122, v138
    v_sub_f32 v139, v123, v139
    v_sub_f32 v144, v128, v144
    v_sub_f32 v145, v129, v145
    v_sub_f32 v146, v130, v146
    v_sub_f32 v147, v131, v147
    v_cvt_pk_bf16_f32 v140, v160, v161
    v_cvt_pk_bf16_f32 v141, v162, v163
    v_cvt_pk_bf16_f32 v142, v164, v165
    v_cvt_pk_bf16_f32 v143, v166, v167
    ds_write_b128 v191, v[140:143] offset:2048
    v_mul_f32 v136, s50, v136
    v_mul_f32 v137, s50, v137
    v_mul_f32 v138, s50, v138
    v_mul_f32 v139, s50, v139
    v_mul_f32 v144, s50, v144
    v_mul_f32 v145, s50, v145
    v_mul_f32 v146, s50, v146
    v_mul_f32 v147, s50, v147
    v_cvt_pk_bf16_f32 v148, v136, v137
    v_cvt_pk_bf16_f32 v149, v138, v139
    v_cvt_pk_bf16_f32 v150, v144, v145
    v_cvt_pk_bf16_f32 v151, v146, v147
    ds_write_b128 v191, v[148:151] offset:3072
    ds_read_b64_tr_b16 v[176:177], v190 offset:2048
    ds_read_b64_tr_b16 v[178:179], v190 offset:2304
    ds_read_b64_tr_b16 v[180:181], v190 offset:3072
    ds_read_b64_tr_b16 v[182:183], v190 offset:3328
    s_waitcnt lgkmcnt(8)
    buffer_store_dwordx4 v[168:171], v189, s[24:27], s48 offen sc1
    s_add_u32 s48, s48, 92160
    s_waitcnt lgkmcnt(6)
    buffer_store_dwordx4 v[172:175], v189, s[24:27], s48 offen sc1
    s_add_u32 s48, s48, 92160
    s_waitcnt lgkmcnt(2)
    buffer_store_dwordx4 v[176:179], v189, s[24:27], s48 offen sc1
    s_add_u32 s48, s48, 92160
    s_waitcnt lgkmcnt(0)
    buffer_store_dwordx4 v[180:183], v189, s[24:27], s48 offen sc1
    v_bfrev_b32 v18, 2
    s_and_b32 s58, s59, 1
    s_lshl_b32 s58, s58, 6
    v_writelane_b32 v18, s58, 0
    s_branch L_noprod
L_lateA:
    s_mov_b32 s20, s8
    s_and_b32 s21, s9, 0xffff
    s_mov_b32 s22, 0x930000
    s_mov_b32 s23, 0x20000
    s_lshl_b32 s57, s32, 3
    s_lshr_b32 s58, 0x00804000, s57
    s_and_b32 s43, s58, 0xff
    s_lshr_b32 s58, 0x40008040, s57
    s_and_b32 s44, s58, 0xff
    s_lshr_b32 s58, 0x80400080, s57
    s_and_b32 s45, s58, 0xff
    v_and_b32 v24, 15, v0
    v_and_b32 v25, 7, v0
    v_lshlrev_b32 v26, 2, v21
    v_sub_u32 v9, v26, v25
    v_lshrrev_b32 v26, 1, v25
    v_xor_b32 v26, v26, v21
    v_lshlrev_b32 v26, 4, v26
    v_lshl_add_u32 v26, v25, 6, v26
    v_lshrrev_b32 v28, 3, v24
    v_mul_u32_u24 v28, 10240, v28
    s_lshl_b32 s58, s46, 11
    s_add_u32 s58, s58, 92160
    v_add3_u32 v5, v26, v28, s58
    v_bfe_u32 v29, v0, 1, 2
    v_and_b32 v30, 1, v0
    v_cmp_eq_u32 vcc, v29, v21
    v_sub_u32 v26, 0, v30
    v_add_u32 v30, s100, v30
    v_cndmask_b32 v10, 64, v26, vcc
    s_lshr_b32 s58, s100, 1
    v_and_b32 v26, 2, v0
    v_xor_b32 v26, v26, v21
    v_xor_b32 v26, s58, v26
    v_lshlrev_b32 v26, 4, v26
    v_lshl_add_u32 v26, v30, 6, v26
    v_lshl_add_u32 v26, v29, 9, v26
    s_mov_b32 s58, 100352
    v_add3_u32 v6, v26, v28, s58
    v_lshlrev_b32 v24, 4, v24
    s_add_u32 s58, s47, 61440
    v_lshl_add_u32 v26, v21, 1, 0
    v_min_u32 v26, 4, v26
    v_lshl_add_u32 v26, v26, 10, v24
    v_add_u32 v11, s58, v26
    v_lshl_add_u32 v26, v21, 1, 1
    v_min_u32 v26, 4, v26
    v_lshl_add_u32 v26, v26, 10, v24
    v_add_u32 v12, s58, v26
    v_lshl_add_u32 v26, v21, 8, v24
    v_add_u32 v8, 153600, v26
    v_lshrrev_b32 v24, 2, v0
    v_bfe_u32 v26, v0, 3, 2
    v_xor_b32 v26, v26, v23
    v_lshlrev_b32 v26, 4, v26
    v_lshl_add_u32 v26, v24, 6, v26
    s_mul_i32 s58, s46, 3072
    s_add_u32 s58, s58, 133120
    v_add_u32 v7, s58, v26
    v_and_b32 v26, 7, v24
    v_lshrrev_b32 v24, 3, v24
    v_lshl_add_u32 v26, v26, 1, v24
    v_mul_i32_i24 v26, s35, v26
    v_lshl_add_u32 v26, v23, 4, v26
    s_mul_i32 s58, s46, 3
    s_mul_i32 s58, s58, s34
    s_add_u32 s58, s58, s33
    v_add_u32 v13, s58, v26
    v_add_u32 v14, s34, v13
    v_add_u32 v15, s34, v14
    v_xor_b32 v204, 32, v5
    v_and_b32 v21, 8, v0
    v_cmp_ne_u32 vcc, 0, v21
    v_mov_b32 v21, 0x3f61
    v_mov_b32 v24, 0x3f610000
    v_mov_b32 v22, 0xc029
    v_mov_b32 v25, 0xc0290000
    v_mov_b32 v23, 0x3f80
    v_mov_b32 v26, 0x3f800000
    v_cndmask_b32 v21, v21, v24, vcc
    v_cndmask_b32 v22, v22, v25, vcc
    v_cndmask_b32 v23, v23, v26, vcc
    v_cmp_eq_i32 vcc, -3, v9
    s_nop 1
    v_cndmask_b32 v31, 0, v21, vcc
    v_cmp_eq_i32 vcc, -2, v9
    s_nop 1
    v_cndmask_b32 v30, 0, v21, vcc
    v_cndmask_b32 v31, v31, v22, vcc
    v_cmp_eq_i32 vcc, -1, v9
    s_nop 1
    v_cndmask_b32 v29, 0, v21, vcc
    v_cndmask_b32 v30, v30, v22, vcc
    v_cndmask_b32 v31, v31, v23, vcc
    v_cmp_eq_i32 vcc, 0, v9
    s_nop 1
    v_cndmask_b32 v28, 0, v21, vcc
    v_cndmask_b32 v29, v29, v22, vcc
    v_cndmask_b32 v30, v30, v23, vcc
    v_cmp_eq_i32 vcc, 1, v9
    s_nop 1
    v_cndmask_b32 v28, v28, v22, vcc
    v_cndmask_b32 v29, v29, v23, vcc
    v_cmp_eq_i32 vcc, 2, v9
    s_nop 1
    v_cndmask_b32 v28, v28, v23, vcc
    v_cmp_eq_i32 vcc, -3, v10
    s_nop 1
    v_cndmask_b32 v35, 0, v21, vcc
    v_cmp_eq_i32 vcc, -2, v10
    s_nop 1
    v_cndmask_b32 v34, 0, v21, vcc
    v_cndmask_b32 v35, v35, v22, vcc
    v_cmp_eq_i32 vcc, -1, v10
    s_nop 1
    v_cndmask_b32 v33, 0, v21, vcc
    v_cndmask_b32 v34, v34, v22, vcc
    v_cndmask_b32 v35, v35, v23, vcc
    v_cmp_eq_i32 vcc, 0, v10
    s_nop 1
    v_cndmask_b32 v32, 0, v21, vcc
    v_cndmask_b32 v33, v33, v22, vcc
    v_cndmask_b32 v34, v34, v23, vcc
    v_cmp_eq_i32 vcc, 1, v10
    s_nop 1
    v_cndmask_b32 v32, v32, v22, vcc
    v_cndmask_b32 v33, v33, v23, vcc
    v_cmp_eq_i32 vcc, 2, v10
    s_nop 1
    v_cndmask_b32 v32, v32, v23, vcc
    s_nop 1
    v_and_b32 v21, 8, v0
    v_cmp_ne_u32 vcc, 0, v21
    v_mov_b32 v21, 0xbf160000
    v_mov_b32 v24, 0x3f160000
    v_mov_b32 v22, 0x3fc0bec8
    v_mov_b32 v25, 0xbfc0bec8
    v_mov_b32 v23, 0x3f80
    v_mov_b32 v26, 0x3f80
    v_cndmask_b32 v21, v21, v24, vcc
    v_cndmask_b32 v22, v22, v25, vcc
    v_cndmask_b32 v23, v23, v26, vcc
    v_cmp_eq_i32 vcc, -3, v9
    s_nop 1
    v_cndmask_b32 v211, 0, v21, vcc
    v_cmp_eq_i32 vcc, -2, v9
    s_nop 1
    v_cndmask_b32 v210, 0, v21, vcc
    v_cndmask_b32 v211, v211, v22, vcc
    v_cmp_eq_i32 vcc, -1, v9
    s_nop 1
    v_cndmask_b32 v209, 0, v21, vcc
    v_cndmask_b32 v210, v210, v22, vcc
    v_cndmask_b32 v211, v211, v23, vcc
    v_cmp_eq_i32 vcc, 0, v9
    s_nop 1
    v_cndmask_b32 v208, 0, v21, vcc
    v_cndmask_b32 v209, v209, v22, vcc
    v_cndmask_b32 v210, v210, v23, vcc
    v_cmp_eq_i32 vcc, 1, v9
    s_nop 1
    v_cndmask_b32 v208, v208, v22, vcc
    v_cndmask_b32 v209, v209, v23, vcc
    v_cmp_eq_i32 vcc, 2, v9
    s_nop 1
    v_cndmask_b32 v208, v208, v23, vcc
    v_cmp_eq_i32 vcc, -3, v10
    s_nop 1
    v_cndmask_b32 v215, 0, v21, vcc
    v_cmp_eq_i32 vcc, -2, v10
    s_nop 1
    v_cndmask_b32 v214, 0, v21, vcc
    v_cndmask_b32 v215, v215, v22, vcc
    v_cmp_eq_i32 vcc, -1, v10
    s_nop 1
    v_cndmask_b32 v213, 0, v21, vcc
    v_cndmask_b32 v214, v214, v22, vcc
    v_cndmask_b32 v215, v215, v23, vcc
    v_cmp_eq_i32 vcc, 0, v10
    s_nop 1
    v_cndmask_b32 v212, 0, v21, vcc
    v_cndmask_b32 v213, v213, v22, vcc
    v_cndmask_b32 v214, v214, v23, vcc
    v_cmp_eq_i32 vcc, 1, v10
    s_nop 1
    v_cndmask_b32 v212, v212, v22, vcc
    v_cndmask_b32 v213, v213, v23, vcc
    v_cmp_eq_i32 vcc, 2, v10
    s_nop 1
    v_cndmask_b32 v212, v212, v23, vcc
    s_nop 1
    v_and_b32 v21, 8, v0
    v_cmp_ne_u32 vcc, 0, v21
    v_mov_b32 v21, 0xbfb40000
    v_mov_b32 v24, 0x3fb40000
    v_mov_b32 v22, 0x3f20c010
    v_mov_b32 v25, 0xbf20c010
    v_mov_b32 v23, 0x3f80
    v_mov_b32 v26, 0x3f80
    v_cndmask_b32 v21, v21, v24, vcc
    v_cndmask_b32 v22, v22, v25, vcc
    v_cndmask_b32 v23, v23, v26, vcc
    v_cmp_eq_i32 vcc, -3, v9
    s_nop 1
    v_cndmask_b32 v219, 0, v21, vcc
    v_cmp_eq_i32 vcc, -2, v9
    s_nop 1
    v_cndmask_b32 v218, 0, v21, vcc
    v_cndmask_b32 v219, v219, v22, vcc
    v_cmp_eq_i32 vcc, -1, v9
    s_nop 1
    v_cndmask_b32 v217, 0, v21, vcc
    v_cndmask_b32 v218, v218, v22, vcc
    v_cndmask_b32 v219, v219, v23, vcc
    v_cmp_eq_i32 vcc, 0, v9
    s_nop 1
    v_cndmask_b32 v216, 0, v21, vcc
    v_cndmask_b32 v217, v217, v22, vcc
    v_cndmask_b32 v218, v218, v23, vcc
    v_cmp_eq_i32 vcc, 1, v9
    s_nop 1
    v_cndmask_b32 v216, v216, v22, vcc
    v_cndmask_b32 v217, v217, v23, vcc
    v_cmp_eq_i32 vcc, 2, v9
    s_nop 1
    v_cndmask_b32 v216, v216, v23, vcc
    v_cmp_eq_i32 vcc, -3, v10
    s_nop 1
    v_cndmask_b32 v223, 0, v21, vcc
    v_cmp_eq_i32 vcc, -2, v10
    s_nop 1
    v_cndmask_b32 v222, 0, v21, vcc
    v_cndmask_b32 v223, v223, v22, vcc
    v_cmp_eq_i32 vcc, -1, v10
    s_nop 1
    v_cndmask_b32 v221, 0, v21, vcc
    v_cndmask_b32 v222, v222, v22, vcc
    v_cndmask_b32 v223, v223, v23, vcc
    v_cmp_eq_i32 vcc, 0, v10
    s_nop 1
    v_cndmask_b32 v220, 0, v21, vcc
    v_cndmask_b32 v221, v221, v22, vcc
    v_cndmask_b32 v222, v222, v23, vcc
    v_cmp_eq_i32 vcc, 1, v10
    s_nop 1
    v_cndmask_b32 v220, v220, v22, vcc
    v_cndmask_b32 v221, v221, v23, vcc
    v_cmp_eq_i32 vcc, 2, v10
    s_nop 1
    v_cndmask_b32 v220, v220, v23, vcc
    s_nop 1
    s_setprio 3
    s_waitcnt vmcnt(0)
    ds_read_b64_tr_b16 v[68:69], v11 offset:0
    ds_read_b64_tr_b16 v[70:71], v12 offset:0
    ds_read_b64_tr_b16 v[72:73], v11 offset:8
    ds_read_b64_tr_b16 v[74:75], v12 offset:8
    ds_read_b64_tr_b16 v[76:77], v11 offset:256
    ds_read_b64_tr_b16 v[78:79], v12 offset:256
    ds_read_b64_tr_b16 v[80:81], v11 offset:264
    ds_read_b64_tr_b16 v[82:83], v12 offset:264
    ds_read_b64_tr_b16 v[84:85], v11 offset:512
    ds_read_b64_tr_b16 v[86:87], v12 offset:512
    ds_read_b64_tr_b16 v[88:89], v11 offset:520
    ds_read_b64_tr_b16 v[90:91], v12 offset:520
    s_branch L_is1
.p2align 12
L_pg1:
    s_setpc_b64 s[62:63]
L_is1:
    ds_read_b64_tr_b16 v[92:93], v11 offset:768
    ds_read_b64_tr_b16 v[94:95], v12 offset:768
    ds_read_b64_tr_b16 v[96:97], v11 offset:776
    ds_read_b64_tr_b16 v[98:99], v12 offset:776
    ds_read_b64_tr_b16 v[164:165], v8 offset:0
    ds_read_b64_tr_b16 v[166:167], v8 offset:1024
    ds_read_b64_tr_b16 v[168:169], v8 offset:8
    ds_read_b64_tr_b16 v[170:171], v8 offset:1032
    v_add_u32 v11, 71680, v11
    v_add_u32 v12, 71680, v12
    s_waitcnt lgkmcnt(12)
    v_mfma_f32_16x16x32_bf16 v[36:39], v[68:71], v[28:31], 0
    v_mfma_f32_16x16x32_bf16 v[40:43], v[72:75], v[28:31], 0
    v_mfma_f32_16x16x32_bf16 v[44:47], v[76:79], v[28:31], 0
    v_mfma_f32_16x16x32_bf16 v[48:51], v[80:83], v[28:31], 0
    s_nop 5
    v_cvt_pk_bf16_f32 v52, v36, v37
    v_cvt_pk_bf16_f32 v53, v38, v39
    v_cvt_pk_bf16_f32 v54, v40, v41
    v_cvt_pk_bf16_f32 v55, v42, v43
    v_cvt_pk_bf16_f32 v56, v44, v45
    v_cvt_pk_bf16_f32 v57, v46, v47
    v_cvt_pk_bf16_f32 v58, v48, v49
    v_cvt_pk_bf16_f32 v59, v50, v51
    ds_write_b128 v5, v[52:55] offset:0
    ds_write_b128 v204, v[56:59] offset:512
    s_waitcnt lgkmcnt(2)
    v_mfma_f32_16x16x32_bf16 v[36:39], v[84:87], v[28:31], 0
    v_mfma_f32_16x16x32_bf16 v[40:43], v[88:91], v[28:31], 0
    v_mfma_f32_16x16x32_bf16 v[44:47], v[92:95], v[28:31], 0
    v_mfma_f32_16x16x32_bf16 v[48:51], v[96:99], v[28:31], 0
    s_nop 5
    v_cvt_pk_bf16_f32 v60, v36, v37
    v_cvt_pk_bf16_f32 v61, v38, v39
    v_cvt_pk_bf16_f32 v62, v40, v41
    v_cvt_pk_bf16_f32 v63, v42, v43
    v_cvt_pk_bf16_f32 v64, v44, v45
    v_cvt_pk_bf16_f32 v65, v46, v47
    v_cvt_pk_bf16_f32 v66, v48, v49
    v_cvt_pk_bf16_f32 v67, v50, v51
    ds_write_b128 v5, v[60:63] offset:1024
    ds_write_b128 v204, v[64:67] offset:1536
    s_add_u32 m0, s47, 133120
    s_mov_b32 s58, s41
    buffer_load_dwordx4 v1, s[12:15], s58 offen lds
    s_add_u32 m0, s47, 134144
    s_nop 0
    buffer_load_dwordx4 v2, s[12:15], s58 offen lds
    s_add_u32 m0, s47, 135168
    s_add_u32 s58, s58, s101
    buffer_load_dwordx4 v2, s[12:15], s58 offen lds
    s_add_u32 m0, s47, 136192
    s_add_u32 s58, s58, s101
    buffer_load_dwordx4 v2, s[12:15], s58 offen lds
    s_add_u32 m0, s47, 137216
    s_add_u32 s58, s58, s101
    buffer_load_dwordx4 v3, s[12:15], s58 offen lds
    s_mov_b32 m0, 155648
    s_mov_b32 s58, s41
    s_cmp_lg_u32 s46, 1
    s_cbranch_scc1 L_el2
    buffer_load_dwordx4 v4, s[12:15], s58 offen lds
L_el2:
    s_mov_b32 m0, 156672
    s_add_u32 s58, s58, s101
    s_cmp_lg_u32 s46, 1
    s_cbranch_scc1 L_el3
    buffer_load_dwordx4 v4, s[12:15], s58 offen lds
L_el3:
    s_mov_b32 m0, 157696
    s_mov_b32 s58, s42
    s_cmp_lg_u32 s46, 0
    s_cbranch_scc1 L_el4
    buffer_load_dwordx4 v4, s[12:15], s58 offen lds
L_el4:
    s_mov_b32 m0, 158720
    s_add_u32 s58, s58, s101
    s_cmp_lg_u32 s46, 0
    s_cbranch_scc1 L_el5
    buffer_load_dwordx4 v4, s[12:15], s58 offen lds
L_el5:
    s_cmp_lg_u32 s46, 0
    s_cbranch_scc1 L_ex1
    v_mfma_f32_16x16x32_bf16 v[36:39], v[164:167], v[32:35], 0
    v_mfma_f32_16x16x32_bf16 v[40:43], v[168:171], v[32:35], 0
    s_nop 7
    v_cvt_pk_bf16_f32 v188, v36, v37
    v_cvt_pk_bf16_f32 v189, v38, v39
    v_cvt_pk_bf16_f32 v190, v40, v41
    v_cvt_pk_bf16_f32 v191, v42, v43
    ds_write_b128 v6, v[188:191] offset:0
L_ex1:
    s_waitcnt lgkmcnt(0)
    s_barrier
    v_mfma_f32_16x16x32_bf16 v[36:39], v[68:71], v[208:211], 0
    v_mfma_f32_16x16x32_bf16 v[40:43], v[72:75], v[208:211], 0
    v_mfma_f32_16x16x32_bf16 v[44:47], v[76:79], v[208:211], 0
    v_mfma_f32_16x16x32_bf16 v[48:51], v[80:83], v[208:211], 0
    s_nop 5
    v_cvt_pk_bf16_f32 v192, v36, v37
    v_cvt_pk_bf16_f32 v193, v38, v39
    v_cvt_pk_bf16_f32 v194, v40, v41
    v_cvt_pk_bf16_f32 v195, v42, v43
    v_cvt_pk_bf16_f32 v196, v44, v45
    v_cvt_pk_bf16_f32 v197, v46, v47
    v_cvt_pk_bf16_f32 v198, v48, v49
    v_cvt_pk_bf16_f32 v199, v50, v51
    v_mfma_f32_16x16x32_bf16 v[36:39], v[84:87], v[208:211], 0
    v_mfma_f32_16x16x32_bf16 v[40:43], v[88:91], v[208:211], 0
    v_mfma_f32_16x16x32_bf16 v[44:47], v[92:95], v[208:211], 0
    v_mfma_f32_16x16x32_bf16 v[48:51], v[96:99], v[208:211], 0
    s_nop 5
    v_cvt_pk_bf16_f32 v200, v36, v37
    v_cvt_pk_bf16_f32 v201, v38, v39
    v_cvt_pk_bf16_f32 v202, v40, v41
    v_cvt_pk_bf16_f32 v203, v42, v43
    v_cvt_pk_bf16_f32 v224, v44, v45
    v_cvt_pk_bf16_f32 v225, v46, v47
    v_cvt_pk_bf16_f32 v226, v48, v49
    v_cvt_pk_bf16_f32 v227, v50, v51
    s_cmp_lg_u32 s46, 0
    s_cbranch_scc1 L_ex2
    v_mfma_f32_16x16x32_bf16 v[36:39], v[164:167], v[212:215], 0
    v_mfma_f32_16x16x32_bf16 v[40:43], v[168:171], v[212:215], 0
    s_nop 7
    v_cvt_pk_bf16_f32 v228, v36, v37
    v_cvt_pk_bf16_f32 v229, v38, v39
    v_cvt_pk_bf16_f32 v230, v40, v41
    v_cvt_pk_bf16_f32 v231, v42, v43
L_ex2:
    s_waitcnt lgkmcnt(0)
    s_barrier
    v_mfma_f32_16x16x32_bf16 v[36:39], v[68:71], v[216:219], 0
    v_mfma_f32_16x16x32_bf16 v[40:43], v[72:75], v[216:219], 0
    v_mfma_f32_16x16x32_bf16 v[44:47], v[76:79], v[216:219], 0
    v_mfma_f32_16x16x32_bf16 v[48:51], v[80:83], v[216:219], 0
    s_nop 5
    v_cvt_pk_bf16_f32 v232, v36, v37
    v_cvt_pk_bf16_f32 v233, v38, v39
    v_cvt_pk_bf16_f32 v234, v40, v41
    v_cvt_pk_bf16_f32 v235, v42, v43
    v_cvt_pk_bf16_f32 v236, v44, v45
    v_cvt_pk_bf16_f32 v237, v46, v47
    v_cvt_pk_bf16_f32 v238, v48, v49
    v_cvt_pk_bf16_f32 v239, v50, v51
    v_mfma_f32_16x16x32_bf16 v[36:39], v[84:87], v[216:219], 0
    v_mfma_f32_16x16x32_bf16 v[40:43], v[88:91], v[216:219], 0
    v_mfma_f32_16x16x32_bf16 v[44:47], v[92:95], v[216:219], 0
    v_mfma_f32_16x16x32_bf16 v[48:51], v[96:99], v[216:219], 0
    s_nop 5
    v_cvt_pk_bf16_f32 v240, v36, v37
    v_cvt_pk_bf16_f32 v241, v38, v39
    v_cvt_pk_bf16_f32 v242, v40, v41
    v_cvt_pk_bf16_f32 v243, v42, v43
    v_cvt_pk_bf16_f32 v244, v44, v45
    v_cvt_pk_bf16_f32 v245, v46, v47
    v_cvt_pk_bf16_f32 v246, v48, v49
    v_cvt_pk_bf16_f32 v247, v50, v51
    s_cmp_lg_u32 s46, 0
    s_cbranch_scc1 L_ex3
    v_mfma_f32_16x16x32_bf16 v[36:39], v[164:167], v[220:223], 0
    v_mfma_f32_16x16x32_bf16 v[40:43], v[168:171], v[220:223], 0
    s_nop 7
    v_cvt_pk_bf16_f32 v248, v36, v37
    v_cvt_pk_bf16_f32 v249, v38, v39
    v_cvt_pk_bf16_f32 v250, v40, v41
    v_cvt_pk_bf16_f32 v251, v42, v43
L_ex3:
    s_waitcnt vmcnt(0)
    ds_read_b64_tr_b16 v[100:101], v11 offset:0
    ds_read_b64_tr_b16 v[102:103], v12 offset:0
    ds_read_b64_tr_b16 v[104:105], v11 offset:8
    ds_read_b64_tr_b16 v[106:107], v12 offset:8
    ds_read_b64_tr_b16 v[108:109], v11 offset:256
    ds_read_b64_tr_b16 v[110:111], v12 offset:256
    ds_read_b64_tr_b16 v[112:113], v11 offset:264
    ds_read_b64_tr_b16 v[114:115], v12 offset:264
    ds_read_b64_tr_b16 v[116:117], v11 offset:512
    ds_read_b64_tr_b16 v[118:119], v12 offset:512
    ds_read_b64_tr_b16 v[120:121], v11 offset:520
    ds_read_b64_tr_b16 v[122:123], v12 offset:520
    ds_read_b64_tr_b16 v[124:125], v11 offset:768
    ds_read_b64_tr_b16 v[126:127], v12 offset:768
    ds_read_b64_tr_b16 v[128:129], v11 offset:776
    ds_read_b64_tr_b16 v[130:131], v12 offset:776
    ds_read_b64_tr_b16 v[172:173], v8 offset:2048
    ds_read_b64_tr_b16 v[174:175], v8 offset:3072
    ds_read_b64_tr_b16 v[176:177], v8 offset:2056
    ds_read_b64_tr_b16 v[178:179], v8 offset:3080
    ds_read_b64_tr_b16 v[180:181], v8 offset:4096
    ds_read_b64_tr_b16 v[182:183], v8 offset:5120
    ds_read_b64_tr_b16 v[184:185], v8 offset:4104
    ds_read_b64_tr_b16 v[186:187], v8 offset:5128
    s_waitcnt lgkmcnt(15)
    v_mfma_f32_16x16x32_bf16 v[36:39], v[100:103], v[28:31], 0
    v_mfma_f32_16x16x32_bf16 v[40:43], v[104:107], v[28:31], 0
    v_mfma_f32_16x16x32_bf16 v[44:47], v[108:111], v[28:31], 0
    v_mfma_f32_16x16x32_bf16 v[48:51], v[112:115], v[28:31], 0
    s_nop 5
    v_cvt_pk_bf16_f32 v252, v36, v37
    v_cvt_pk_bf16_f32 v253, v38, v39
    v_cvt_pk_bf16_f32 v254, v40, v41
    v_cvt_pk_bf16_f32 v255, v42, v43
    v_cvt_pk_bf16_f32 v52, v44, v45
    v_cvt_pk_bf16_f32 v53, v46, v47
    v_cvt_pk_bf16_f32 v54, v48, v49
    v_cvt_pk_bf16_f32 v55, v50, v51
    ds_write_b128 v5, v[252:255] offset:20480
    ds_write_b128 v204, v[52:55] offset:20992
    s_waitcnt lgkmcnt(2)
    v_mfma_f32_16x16x32_bf16 v[36:39], v[116:119], v[28:31], 0
    v_mfma_f32_16x16x32_bf16 v[40:43], v[120:123], v[28:31], 0
    v_mfma_f32_16x16x32_bf16 v[44:47], v[124:127], v[28:31], 0
    v_mfma_f32_16x16x32_bf16 v[48:51], v[128:131], v[28:31], 0
    s_nop 5
    v_cvt_pk_bf16_f32 v56, v36, v37
    v_cvt_pk_bf16_f32 v57, v38, v39
    v_cvt_pk_bf16_f32 v58, v40, v41
    v_cvt_pk_bf16_f32 v59, v42, v43
    v_cvt_pk_bf16_f32 v60, v44, v45
    v_cvt_pk_bf16_f32 v61, v46, v47
    v_cvt_pk_bf16_f32 v62, v48, v49
    v_cvt_pk_bf16_f32 v63, v50, v51
    ds_write_b128 v5, v[56:59] offset:21504
    ds_write_b128 v204, v[60:63] offset:22016
    s_cmp_lg_u32 s46, 1
    s_cbranch_scc1 L_ex4
    v_mfma_f32_16x16x32_bf16 v[36:39], v[172:175], v[32:35], 0
    v_mfma_f32_16x16x32_bf16 v[40:43], v[176:179], v[32:35], 0
    s_nop 7
    v_cvt_pk_bf16_f32 v64, v36, v37
    v_cvt_pk_bf16_f32 v65, v38, v39
    v_cvt_pk_bf16_f32 v66, v40, v41
    v_cvt_pk_bf16_f32 v67, v42, v43
    ds_write_b128 v6, v[64:67] offset:20480
L_ex4:
    s_add_u32 m0, s47, 133120
    s_mov_b32 s58, s42
    buffer_load_dwordx4 v1, s[12:15], s58 offen lds
    s_add_u32 m0, s47, 134144
    s_nop 0
    buffer_load_dwordx4 v2, s[12:15], s58 offen lds
    s_add_u32 m0, s47, 135168
    s_add_u32 s58, s58, s101
    buffer_load_dwordx4 v2, s[12:15], s58 offen lds
    s_add_u32 m0, s47, 136192
    s_add_u32 s58, s58, s101
    buffer_load_dwordx4 v2, s[12:15], s58 offen lds
    s_add_u32 m0, s47, 137216
    s_add_u32 s58, s58, s101
    buffer_load_dwordx4 v3, s[12:15], s58 offen lds
    s_waitcnt lgkmcnt(0)
    s_barrier
    s_waitcnt vmcnt(0)
    ds_read_b64_tr_b16 v[132:133], v11 offset:0
    ds_read_b64_tr_b16 v[134:135], v12 offset:0
    ds_read_b64_tr_b16 v[136:137], v11 offset:8
    ds_read_b64_tr_b16 v[138:139], v12 offset:8
    ds_read_b64_tr_b16 v[140:141], v11 offset:256
    ds_read_b64_tr_b16 v[142:143], v12 offset:256
    ds_read_b64_tr_b16 v[144:145], v11 offset:264
    ds_read_b64_tr_b16 v[146:147], v12 offset:264
    ds_read_b64_tr_b16 v[148:149], v11 offset:512
    ds_read_b64_tr_b16 v[150:151], v12 offset:512
    ds_read_b64_tr_b16 v[152:153], v11 offset:520
    ds_read_b64_tr_b16 v[154:155], v12 offset:520
    ds_read_b64_tr_b16 v[156:157], v11 offset:768
    ds_read_b64_tr_b16 v[158:159], v12 offset:768
    ds_read_b64_tr_b16 v[160:161], v11 offset:776
    ds_read_b64_tr_b16 v[162:163], v12 offset:776
    s_waitcnt lgkmcnt(0)
    v_mfma_f32_16x16x32_bf16 v[36:39], v[132:135], v[28:31], 0
    v_mfma_f32_16x16x32_bf16 v[40:43], v[136:139], v[28:31], 0
    v_mfma_f32_16x16x32_bf16 v[44:47], v[140:143], v[28:31], 0
    v_mfma_f32_16x16x32_bf16 v[48:51], v[144:147], v[28:31], 0
    s_nop 5
    v_cvt_pk_bf16_f32 v188, v36, v37
    v_cvt_pk_bf16_f32 v189, v38, v39
    v_cvt_pk_bf16_f32 v190, v40, v41
    v_cvt_pk_bf16_f32 v191, v42, v43
    v_cvt_pk_bf16_f32 v68, v44, v45
    v_cvt_pk_bf16_f32 v69, v46, v47
    v_cvt_pk_bf16_f32 v70, v48, v49
    v_cvt_pk_bf16_f32 v71, v50, v51
    v_mfma_f32_16x16x32_bf16 v[36:39], v[148:151], v[28:31], 0
    v_mfma_f32_16x16x32_bf16 v[40:43], v[152:155], v[28:31], 0
    v_mfma_f32_16x16x32_bf16 v[44:47], v[156:159], v[28:31], 0
    v_mfma_f32_16x16x32_bf16 v[48:51], v[160:163], v[28:31], 0
    s_nop 5
    v_cvt_pk_bf16_f32 v72, v36, v37
    v_cvt_pk_bf16_f32 v73, v38, v39
    v_cvt_pk_bf16_f32 v74, v40, v41
    v_cvt_pk_bf16_f32 v75, v42, v43
    v_cvt_pk_bf16_f32 v76, v44, v45
    v_cvt_pk_bf16_f32 v77, v46, v47
    v_cvt_pk_bf16_f32 v78, v48, v49
    v_cvt_pk_bf16_f32 v79, v50, v51
    s_cmp_lg_u32 s46, 0
    s_cbranch_scc1 L_ex5
    v_mfma_f32_16x16x32_bf16 v[36:39], v[180:183], v[32:35], 0
    v_mfma_f32_16x16x32_bf16 v[40:43], v[184:187], v[32:35], 0
    s_nop 7
    v_cvt_pk_bf16_f32 v80, v36, v37
    v_cvt_pk_bf16_f32 v81, v38, v39
    v_cvt_pk_bf16_f32 v82, v40, v41
    v_cvt_pk_bf16_f32 v83, v42, v43
L_ex5:
    s_waitcnt lgkmcnt(0)
    s_barrier
    ds_write_b128 v5, v[188:191] offset:0
    ds_write_b128 v204, v[68:71] offset:512
    ds_write_b128 v5, v[72:75] offset:1024
    ds_write_b128 v204, v[76:79] offset:1536
    s_cmp_lg_u32 s46, 0
    s_cbranch_scc1 L_ex6
    ds_write_b128 v6, v[80:83] offset:0
L_ex6:
    v_mfma_f32_16x16x32_bf16 v[36:39], v[100:103], v[208:211], 0
    v_mfma_f32_16x16x32_bf16 v[40:43], v[104:107], v[208:211], 0
    v_mfma_f32_16x16x32_bf16 v[44:47], v[108:111], v[208:211], 0
    v_mfma_f32_16x16x32_bf16 v[48:51], v[112:115], v[208:211], 0
    s_nop 5
    v_cvt_pk_bf16_f32 v84, v36, v37
    v_cvt_pk_bf16_f32 v85, v38, v39
    v_cvt_pk_bf16_f32 v86, v40, v41
    v_cvt_pk_bf16_f32 v87, v42, v43
    v_cvt_pk_bf16_f32 v88, v44, v45
    v_cvt_pk_bf16_f32 v89, v46, v47
    v_cvt_pk_bf16_f32 v90, v48, v49
    v_cvt_pk_bf16_f32 v91, v50, v51
    s_cmp_lg_u32 s46, 1
    s_cbranch_scc1 L_ex7
    v_mfma_f32_16x16x32_bf16 v[36:39], v[172:175], v[212:215], 0
    v_mfma_f32_16x16x32_bf16 v[40:43], v[176:179], v[212:215], 0
    s_nop 7
    v_cvt_pk_bf16_f32 v92, v36, v37
    v_cvt_pk_bf16_f32 v93, v38, v39
    v_cvt_pk_bf16_f32 v94, v40, v41
    v_cvt_pk_bf16_f32 v95, v42, v43
L_ex7:
    s_cmp_lg_u32 s46, 0
    s_cbranch_scc1 L_ex8
    v_mfma_f32_16x16x32_bf16 v[36:39], v[180:183], v[212:215], 0
    v_mfma_f32_16x16x32_bf16 v[40:43], v[184:187], v[212:215], 0
    s_nop 7
    v_cvt_pk_bf16_f32 v96, v36, v37
    v_cvt_pk_bf16_f32 v97, v38, v39
    v_cvt_pk_bf16_f32 v98, v40, v41
    v_cvt_pk_bf16_f32 v99, v42, v43
L_ex8:
    s_waitcnt lgkmcnt(0)
    s_barrier
    ds_write_b128 v5, v[192:195] offset:20480
    ds_write_b128 v204, v[196:199] offset:20992
    v_mfma_f32_16x16x32_bf16 v[36:39], v[116:119], v[208:211], 0
    v_mfma_f32_16x16x32_bf16 v[40:43], v[120:123], v[208:211], 0
    v_mfma_f32_16x16x32_bf16 v[44:47], v[124:127], v[208:211], 0
    v_mfma_f32_16x16x32_bf16 v[48:51], v[128:131], v[208:211], 0
    s_nop 5
    v_cvt_pk_bf16_f32 v252, v36, v37
    v_cvt_pk_bf16_f32 v253, v38, v39
    v_cvt_pk_bf16_f32 v254, v40, v41
    v_cvt_pk_bf16_f32 v255, v42, v43
    v_cvt_pk_bf16_f32 v52, v44, v45
    v_cvt_pk_bf16_f32 v53, v46, v47
    v_cvt_pk_bf16_f32 v54, v48, v49
    v_cvt_pk_bf16_f32 v55, v50, v51
    s_cmp_lg_u32 s46, 1
    s_cbranch_scc1 L_ex9
    v_mfma_f32_16x16x32_bf16 v[36:39], v[172:175], v[220:223], 0
    v_mfma_f32_16x16x32_bf16 v[40:43], v[176:179], v[220:223], 0
    s_nop 7
    v_cvt_pk_bf16_f32 v56, v36, v37
    v_cvt_pk_bf16_f32 v57, v38, v39
    v_cvt_pk_bf16_f32 v58, v40, v41
    v_cvt_pk_bf16_f32 v59, v42, v43
L_ex9:
    s_cmp_lg_u32 s46, 0
    s_cbranch_scc1 L_ex10
    v_mfma_f32_16x16x32_bf16 v[36:39], v[180:183], v[220:223], 0
    v_mfma_f32_16x16x32_bf16 v[40:43], v[184:187], v[220:223], 0
    s_nop 7
    v_cvt_pk_bf16_f32 v60, v36, v37
    v_cvt_pk_bf16_f32 v61, v38, v39
    v_cvt_pk_bf16_f32 v62, v40, v41
    v_cvt_pk_bf16_f32 v63, v42, v43
L_ex10:
    s_waitcnt lgkmcnt(0)
    s_barrier
    ds_write_b128 v5, v[200:203] offset:21504
    ds_write_b128 v204, v[224:227] offset:22016
    s_cmp_lg_u32 s46, 0
    s_cbranch_scc1 L_ex11
    ds_write_b128 v6, v[228:231] offset:20480
L_ex11:
    v_mfma_f32_16x16x32_bf16 v[36:39], v[132:135], v[208:211], 0
    v_mfma_f32_16x16x32_bf16 v[40:43], v[136:139], v[208:211], 0
    v_mfma_f32_16x16x32_bf16 v[44:47], v[140:143], v[208:211], 0
    v_mfma_f32_16x16x32_bf16 v[48:51], v[144:147], v[208:211], 0
    s_nop 5
    v_cvt_pk_bf16_f32 v64, v36, v37
    v_cvt_pk_bf16_f32 v65, v38, v39
    v_cvt_pk_bf16_f32 v66, v40, v41
    v_cvt_pk_bf16_f32 v67, v42, v43
    v_cvt_pk_bf16_f32 v188, v44, v45
    v_cvt_pk_bf16_f32 v189, v46, v47
    v_cvt_pk_bf16_f32 v190, v48, v49
    v_cvt_pk_bf16_f32 v191, v50, v51
    s_waitcnt lgkmcnt(0)
    s_barrier
    ds_write_b128 v5, v[84:87] offset:0
    ds_write_b128 v204, v[88:91] offset:512
    v_mfma_f32_16x16x32_bf16 v[36:39], v[148:151], v[208:211], 0
    v_mfma_f32_16x16x32_bf16 v[40:43], v[152:155], v[208:211], 0
    v_mfma_f32_16x16x32_bf16 v[44:47], v[156:159], v[208:211], 0
    v_mfma_f32_16x16x32_bf16 v[48:51], v[160:163], v[208:211], 0
    s_nop 5
    v_cvt_pk_bf16_f32 v68, v36, v37
    v_cvt_pk_bf16_f32 v69, v38, v39
    v_cvt_pk_bf16_f32 v70, v40, v41
    v_cvt_pk_bf16_f32 v71, v42, v43
    v_cvt_pk_bf16_f32 v72, v44, v45
    v_cvt_pk_bf16_f32 v73, v46, v47
    v_cvt_pk_bf16_f32 v74, v48, v49
    v_cvt_pk_bf16_f32 v75, v50, v51
    s_waitcnt lgkmcnt(0)
    s_barrier
    ds_write_b128 v5, v[252:255] offset:1024
    ds_write_b128 v204, v[52:55] offset:1536
    s_cmp_lg_u32 s46, 1
    s_cbranch_scc1 L_ex12
    ds_write_b128 v6, v[92:95] offset:0
L_ex12:
    v_mfma_f32_16x16x32_bf16 v[36:39], v[100:103], v[216:219], 0
    v_mfma_f32_16x16x32_bf16 v[40:43], v[104:107], v[216:219], 0
    v_mfma_f32_16x16x32_bf16 v[44:47], v[108:111], v[216:219], 0
    v_mfma_f32_16x16x32_bf16 v[48:51], v[112:115], v[216:219], 0
    s_nop 5
    v_cvt_pk_bf16_f32 v76, v36, v37
    v_cvt_pk_bf16_f32 v77, v38, v39
    v_cvt_pk_bf16_f32 v78, v40, v41
    v_cvt_pk_bf16_f32 v79, v42, v43
    v_cvt_pk_bf16_f32 v80, v44, v45
    v_cvt_pk_bf16_f32 v81, v46, v47
    v_cvt_pk_bf16_f32 v82, v48, v49
    v_cvt_pk_bf16_f32 v83, v50, v51
    s_waitcnt lgkmcnt(0)
    s_barrier
    ds_write_b128 v5, v[64:67] offset:20480
    ds_write_b128 v204, v[188:191] offset:20992
    v_mfma_f32_16x16x32_bf16 v[36:39], v[116:119], v[216:219], 0
    v_mfma_f32_16x16x32_bf16 v[40:43], v[120:123], v[216:219], 0
    v_mfma_f32_16x16x32_bf16 v[44:47], v[124:127], v[216:219], 0
    v_mfma_f32_16x16x32_bf16 v[48:51], v[128:131], v[216:219], 0
    s_nop 5
    v_cvt_pk_bf16_f32 v192, v36, v37
    v_cvt_pk_bf16_f32 v193, v38, v39
    v_cvt_pk_bf16_f32 v194, v40, v41
    v_cvt_pk_bf16_f32 v195, v42, v43
    v_cvt_pk_bf16_f32 v196, v44, v45
    v_cvt_pk_bf16_f32 v197, v46, v47
    v_cvt_pk_bf16_f32 v198, v48, v49
    v_cvt_pk_bf16_f32 v199, v50, v51
    s_waitcnt lgkmcnt(0)
    s_barrier
    ds_write_b128 v5, v[68:71] offset:21504
    ds_write_b128 v204, v[72:75] offset:22016
    s_cmp_lg_u32 s46, 0
    s_cbranch_scc1 L_ex13
    ds_write_b128 v6, v[96:99] offset:20480
L_ex13:
    v_mfma_f32_16x16x32_bf16 v[36:39], v[132:135], v[216:219], 0
    v_mfma_f32_16x16x32_bf16 v[40:43], v[136:139], v[216:219], 0
    v_mfma_f32_16x16x32_bf16 v[44:47], v[140:143], v[216:219], 0
    v_mfma_f32_16x16x32_bf16 v[48:51], v[144:147], v[216:219], 0
    s_nop 5
    v_cvt_pk_bf16_f32 v200, v36, v37
    v_cvt_pk_bf16_f32 v201, v38, v39
    v_cvt_pk_bf16_f32 v202, v40, v41
    v_cvt_pk_bf16_f32 v203, v42, v43
    v_cvt_pk_bf16_f32 v224, v44, v45
    v_cvt_pk_bf16_f32 v225, v46, v47
    v_cvt_pk_bf16_f32 v226, v48, v49
    v_cvt_pk_bf16_f32 v227, v50, v51
    s_waitcnt lgkmcnt(0)
    s_barrier
    ds_write_b128 v5, v[232:235] offset:0
    ds_write_b128 v204, v[236:239] offset:512
    v_mfma_f32_16x16x32_bf16 v[36:39], v[148:151], v[216:219], 0
    v_mfma_f32_16x16x32_bf16 v[40:43], v[152:155], v[216:219], 0
    v_mfma_f32_16x16x32_bf16 v[44:47], v[156:159], v[216:219], 0
    v_mfma_f32_16x16x32_bf16 v[48:51], v[160:163], v[216:219], 0
    s_nop 5
    v_cvt_pk_bf16_f32 v228, v36, v37
    v_cvt_pk_bf16_f32 v229, v38, v39
    v_cvt_pk_bf16_f32 v230, v40, v41
    v_cvt_pk_bf16_f32 v231, v42, v43
    v_cvt_pk_bf16_f32 v84, v44, v45
    v_cvt_pk_bf16_f32 v85, v46, v47
    v_cvt_pk_bf16_f32 v86, v48, v49
    v_cvt_pk_bf16_f32 v87, v50, v51
    s_waitcnt lgkmcnt(0)
    s_barrier
    ds_write_b128 v5, v[240:243] offset:1024
    ds_write_b128 v204, v[244:247] offset:1536
    s_cmp_lg_u32 s46, 0
    s_cbranch_scc1 L_ex14
    ds_write_b128 v6, v[248:251] offset:0
L_ex14:
    s_waitcnt lgkmcnt(0)
    s_barrier
    ds_write_b128 v5, v[76:79] offset:20480
    ds_write_b128 v204, v[80:83] offset:20992
    s_waitcnt lgkmcnt(0)
    s_barrier
    ds_write_b128 v5, v[192:195] offset:21504
    ds_write_b128 v204, v[196:199] offset:22016
    s_cmp_lg_u32 s46, 1
    s_cbranch_scc1 L_ex15
    ds_write_b128 v6, v[56:59] offset:20480
L_ex15:
    s_waitcnt lgkmcnt(0)
    s_barrier
    ds_write_b128 v5, v[200:203] offset:0
    ds_write_b128 v204, v[224:227] offset:512
    ds_write_b128 v5, v[228:231] offset:1024
    ds_write_b128 v204, v[84:87] offset:1536
    s_cmp_lg_u32 s46, 0
    s_cbranch_scc1 L_ex16
    ds_write_b128 v6, v[60:63] offset:0
L_ex16:
    s_waitcnt lgkmcnt(0)
    s_barrier
    v_bfe_u32 v21, v0, 3, 2
    v_add_u32 v21, 12, v21
    v_mul_i32_i24 v21, s34, v21
    v_bfe_u32 v22, v0, 2, 1
    v_add_u32 v22, s100, v22
    v_lshrrev_b32 v23, 5, v0
    v_lshl_add_u32 v22, v22, 1, v23
    v_mad_i32_i24 v21, v22, s35, v21
    v_and_b32 v24, 3, v0
    v_lshl_add_u32 v21, v24, 4, v21
    s_cmp_eq_u32 s32, 3
    s_cselect_b32 s59, 1, s46
    s_lshl_b32 s59, s59, 30
    s_add_u32 s58, s59, s33
    v_add_u32 v21, s58, v21
    v_bfe_u32 v22, v0, 2, 3
    v_lshlrev_b32 v22, 4, v22
    v_lshl_add_u32 v22, v23, 9, v22
    v_and_b32 v23, 1, v0
    v_lshl_add_u32 v22, v23, 8, v22
    v_bfe_u32 v23, v0, 1, 1
    v_lshl_add_u32 v22, v23, 11, v22
    v_add_u32 v22, 157696, v22
    s_waitcnt lgkmcnt(0)
    s_barrier
    s_waitcnt lgkmcnt(0)
    s_barrier
    s_waitcnt lgkmcnt(0)
    ds_read_b128 v[68:71], v7 offset:0
    s_waitcnt lgkmcnt(0)
    buffer_store_dwordx4 v[68:71], v13, s[20:23], s43 offen sc1
    s_barrier
    ds_read_b128 v[72:75], v7 offset:1024
    s_waitcnt lgkmcnt(0)
    buffer_store_dwordx4 v[72:75], v14, s[20:23], s43 offen sc1
    s_barrier
    ds_read_b128 v[76:79], v7 offset:2048
    s_waitcnt lgkmcnt(0)
    buffer_store_dwordx4 v[76:79], v15, s[20:23], s43 offen sc1
    ds_read_b128 v[36:39], v22 offset:0
    ds_read_b128 v[40:43], v22 offset:128
    ds_read_b128 v[44:47], v22 offset:1024
    ds_read_b128 v[48:51], v22 offset:1152
    s_waitcnt lgkmcnt(0)
    v_add_f32 v36, v36, v44
    v_add_f32 v37, v37, v45
    v_add_f32 v38, v38, v46
    v_add_f32 v39, v39, v47
    v_add_f32 v40, v40, v48
    v_add_f32 v41, v41, v49
    v_add_f32 v42, v42, v50
    v_add_f32 v43, v43, v51
    v_cvt_pk_bf16_f32 v44, v36, v37
    v_cvt_pk_bf16_f32 v45, v38, v39
    v_cvt_pk_bf16_f32 v46, v40, v41
    v_cvt_pk_bf16_f32 v47, v42, v43
    buffer_store_dwordx4 v[44:47], v21, s[20:23], s43 offen sc1
    s_branch L_xout
L_lateB:
    s_mov_b32 s20, s8
    s_and_b32 s21, s9, 0xffff
    s_mov_b32 s22, 0x930000
    s_mov_b32 s23, 0x20000
    s_lshl_b32 s57, s32, 3
    s_lshr_b32 s58, 0x00804000, s57
    s_and_b32 s43, s58, 0xff
    s_lshr_b32 s58, 0x40008040, s57
    s_and_b32 s44, s58, 0xff
    s_lshr_b32 s58, 0x80400080, s57
    s_and_b32 s45, s58, 0xff
    v_and_b32 v24, 15, v0
    v_and_b32 v25, 7, v0
    v_lshlrev_b32 v26, 2, v21
    v_sub_u32 v9, v26, v25
    v_lshrrev_b32 v26, 1, v25
    v_xor_b32 v26, v26, v21
    v_lshlrev_b32 v26, 4, v26
    v_lshl_add_u32 v26, v25, 6, v26
    v_lshrrev_b32 v28, 3, v24
    v_mul_u32_u24 v28, 10240, v28
    s_branch L_is2
.p2align 12
L_pg2:
    s_setpc_b64 s[62:63]
L_is2:
    s_lshl_b32 s58, s46, 11
    s_add_u32 s58, s58, 92160
    v_add3_u32 v5, v26, v28, s58
    v_bfe_u32 v29, v0, 1, 2
    v_and_b32 v30, 1, v0
    v_cmp_eq_u32 vcc, v29, v21
    v_sub_u32 v26, 0, v30
    v_add_u32 v30, s100, v30
    v_cndmask_b32 v10, 64, v26, vcc
    s_lshr_b32 s58, s100, 1
    v_and_b32 v26, 2, v0
    v_xor_b32 v26, v26, v21
    v_xor_b32 v26, s58, v26
    v_lshlrev_b32 v26, 4, v26
    v_lshl_add_u32 v26, v30, 6, v26
    v_lshl_add_u32 v26, v29, 9, v26
    s_mov_b32 s58, 100352
    v_add3_u32 v6, v26, v28, s58
    v_lshlrev_b32 v24, 4, v24
    s_add_u32 s58, s47, 61440
    v_lshl_add_u32 v26, v21, 1, 0
    v_min_u32 v26, 4, v26
    v_lshl_add_u32 v26, v26, 10, v24
    v_add_u32 v11, s58, v26
    v_lshl_add_u32 v26, v21, 1, 1
    v_min_u32 v26, 4, v26
    v_lshl_add_u32 v26, v26, 10, v24
    v_add_u32 v12, s58, v26
    v_lshl_add_u32 v26, v21, 8, v24
    v_add_u32 v8, 153600, v26
    v_lshrrev_b32 v24, 2, v0
    v_bfe_u32 v26, v0, 3, 2
    v_xor_b32 v26, v26, v23
    v_lshlrev_b32 v26, 4, v26
    v_lshl_add_u32 v26, v24, 6, v26
    s_mul_i32 s58, s46, 3072
    s_add_u32 s58, s58, 133120
    v_add_u32 v7, s58, v26
    v_and_b32 v26, 7, v24
    v_lshrrev_b32 v24, 3, v24
    v_lshl_add_u32 v26, v26, 1, v24
    v_mul_i32_i24 v26, s35, v26
    v_lshl_add_u32 v26, v23, 4, v26
    s_mul_i32 s58, s46, 3
    s_mul_i32 s58, s58, s34
    s_add_u32 s58, s58, s33
    v_add_u32 v13, s58, v26
    v_add_u32 v14, s34, v13
    v_add_u32 v15, s34, v14
    v_xor_b32 v180, 32, v5
    v_and_b32 v21, 8, v0
    v_cmp_ne_u32 vcc, 0, v21
    v_mov_b32 v21, 0x3f61
    v_mov_b32 v24, 0x3f610000
    v_mov_b32 v22, 0xc029
    v_mov_b32 v25, 0xc0290000
    v_mov_b32 v23, 0x3f80
    v_mov_b32 v26, 0x3f800000
    v_cndmask_b32 v21, v21, v24, vcc
    v_cndmask_b32 v22, v22, v25, vcc
    v_cndmask_b32 v23, v23, v26, vcc
    v_cmp_eq_i32 vcc, -3, v9
    s_nop 1
    v_cndmask_b32 v31, 0, v21, vcc
    v_cmp_eq_i32 vcc, -2, v9
    s_nop 1
    v_cndmask_b32 v30, 0, v21, vcc
    v_cndmask_b32 v31, v31, v22, vcc
    v_cmp_eq_i32 vcc, -1, v9
    s_nop 1
    v_cndmask_b32 v29, 0, v21, vcc
    v_cndmask_b32 v30, v30, v22, vcc
    v_cndmask_b32 v31, v31, v23, vcc
    v_cmp_eq_i32 vcc, 0, v9
    s_nop 1
    v_cndmask_b32 v28, 0, v21, vcc
    v_cndmask_b32 v29, v29, v22, vcc
    v_cndmask_b32 v30, v30, v23, vcc
    v_cmp_eq_i32 vcc, 1, v9
    s_nop 1
    v_cndmask_b32 v28, v28, v22, vcc
    v_cndmask_b32 v29, v29, v23, vcc
    v_cmp_eq_i32 vcc, 2, v9
    s_nop 1
    v_cndmask_b32 v28, v28, v23, vcc
    s_nop 1
    s_mov_b32 s28, s10
    s_and_b32 s29, s11, 0xffff
    s_mov_b32 s30, 0x100
    s_mov_b32 s31, 0x20000
    s_and_b32 s25, s25, 0xffff
    s_mov_b32 s26, 0xb4000
    s_mov_b32 s27, 0x20000
    v_lshlrev_b32 v20, 2, v0
    v_cmp_gt_u32 vcc, 2, v0
    v_add_u32 v20, 128, v20
    v_bfrev_b32 v19, 2
    v_cndmask_b32 v20, v19, v20, vcc
    s_and_b32 s99, s46, 1
    s_mul_i32 s99, s99, 3072
    s_mov_b32 s57, 92160
    s_cmp_eq_u32 s37, 1
    s_cselect_b32 s95, 18432, s57
    s_cselect_b32 s96, s57, 18432
    s_mul_i32 s94, s95, s38
    s_lshl2_add_u32 s94, s94, s99
    s_mul_i32 s95, s95, s56
    s_lshl2_add_u32 s96, s96, s94
    s_mul_i32 s97, s37, 5
    s_add_u32 s97, s97, s38
    s_mul_i32 s97, s97, 73728
    s_add_u32 s97, s97, s99
    s_mul_i32 s98, s56, 18432
    v_lshlrev_b32 v16, 4, v0
    v_and_b32 v17, 32, v0
    v_xor_b32 v17, v17, v16
    v_xor_b32 v18, 32, v16
    s_mov_b32 s16, s6
    s_and_b32 s17, s7, 0xffff
    s_mov_b32 s18, 0x70800
    s_mov_b32 s19, 0x20000
    v_and_b32 v21, 8, v0
    v_cmp_ne_u32 vcc, 0, v21
    v_mov_b32 v21, 0xbf160000
    v_mov_b32 v24, 0x3f160000
    v_mov_b32 v22, 0x3fc0bec8
    v_mov_b32 v25, 0xbfc0bec8
    v_mov_b32 v23, 0x3f80
    v_mov_b32 v26, 0x3f80
    v_cndmask_b32 v21, v21, v24, vcc
    v_cndmask_b32 v22, v22, v25, vcc
    v_cndmask_b32 v23, v23, v26, vcc
    v_cmp_eq_i32 vcc, -3, v9
    s_nop 1
    v_cndmask_b32 v35, 0, v21, vcc
    v_cmp_eq_i32 vcc, -2, v9
    s_nop 1
    v_cndmask_b32 v34, 0, v21, vcc
    v_cndmask_b32 v35, v35, v22, vcc
    v_cmp_eq_i32 vcc, -1, v9
    s_nop 1
    v_cndmask_b32 v33, 0, v21, vcc
    v_cndmask_b32 v34, v34, v22, vcc
    v_cndmask_b32 v35, v35, v23, vcc
    v_cmp_eq_i32 vcc, 0, v9
    s_nop 1
    v_cndmask_b32 v32, 0, v21, vcc
    v_cndmask_b32 v33, v33, v22, vcc
    v_cndmask_b32 v34, v34, v23, vcc
    v_cmp_eq_i32 vcc, 1, v9
    s_nop 1
    v_cndmask_b32 v32, v32, v22, vcc
    v_cndmask_b32 v33, v33, v23, vcc
    v_cmp_eq_i32 vcc, 2, v9
    s_nop 1
    v_cndmask_b32 v32, v32, v23, vcc
    s_nop 1
    v_and_b32 v21, 8, v0
    v_cmp_ne_u32 vcc, 0, v21
    v_mov_b32 v21, 0xbfb40000
    v_mov_b32 v24, 0x3fb40000
    v_mov_b32 v22, 0x3f20c010
    v_mov_b32 v25, 0xbf20c010
    v_mov_b32 v23, 0x3f80
    v_mov_b32 v26, 0x3f80
    v_cndmask_b32 v21, v21, v24, vcc
    v_cndmask_b32 v22, v22, v25, vcc
    v_cndmask_b32 v23, v23, v26, vcc
    v_cmp_eq_i32 vcc, -3, v9
    s_nop 1
    v_cndmask_b32 v179, 0, v21, vcc
    v_cmp_eq_i32 vcc, -2, v9
    s_nop 1
    v_cndmask_b32 v178, 0, v21, vcc
    v_cndmask_b32 v179, v179, v22, vcc
    v_cmp_eq_i32 vcc, -1, v9
    s_nop 1
    v_cndmask_b32 v177, 0, v21, vcc
    v_cndmask_b32 v178, v178, v22, vcc
    v_cndmask_b32 v179, v179, v23, vcc
    v_cmp_eq_i32 vcc, 0, v9
    s_nop 1
    v_cndmask_b32 v176, 0, v21, vcc
    v_cndmask_b32 v177, v177, v22, vcc
    v_cndmask_b32 v178, v178, v23, vcc
    v_cmp_eq_i32 vcc, 1, v9
    s_nop 1
    v_cndmask_b32 v176, v176, v22, vcc
    v_cndmask_b32 v177, v177, v23, vcc
    v_cmp_eq_i32 vcc, 2, v9
    s_nop 1
    v_cndmask_b32 v176, v176, v23, vcc
    s_nop 1
    s_setprio 3
    s_waitcnt vmcnt(0)
    ds_read_b64_tr_b16 v[68:69], v11 offset:0
    ds_read_b64_tr_b16 v[70:71], v12 offset:0
    ds_read_b64_tr_b16 v[72:73], v11 offset:8
    ds_read_b64_tr_b16 v[74:75], v12 offset:8
    ds_read_b64_tr_b16 v[76:77], v11 offset:256
    ds_read_b64_tr_b16 v[78:79], v12 offset:256
    ds_read_b64_tr_b16 v[80:81], v11 offset:264
    ds_read_b64_tr_b16 v[82:83], v12 offset:264
    ds_read_b64_tr_b16 v[84:85], v11 offset:512
    ds_read_b64_tr_b16 v[86:87], v12 offset:512
    ds_read_b64_tr_b16 v[88:89], v11 offset:520
    ds_read_b64_tr_b16 v[90:91], v12 offset:520
    ds_read_b64_tr_b16 v[92:93], v11 offset:768
    ds_read_b64_tr_b16 v[94:95], v12 offset:768
    ds_read_b64_tr_b16 v[96:97], v11 offset:776
    ds_read_b64_tr_b16 v[98:99], v12 offset:776
    v_add_u32 v11, 71680, v11
    v_add_u32 v12, 71680, v12
    s_waitcnt lgkmcnt(8)
    v_mfma_f32_16x16x32_bf16 v[36:39], v[68:71], v[28:31], 0
    v_mfma_f32_16x16x32_bf16 v[40:43], v[72:75], v[28:31], 0
    v_mfma_f32_16x16x32_bf16 v[44:47], v[76:79], v[28:31], 0
    v_mfma_f32_16x16x32_bf16 v[48:51], v[80:83], v[28:31], 0
    s_nop 5
    v_cvt_pk_bf16_f32 v52, v36, v37
    v_cvt_pk_bf16_f32 v53, v38, v39
    v_cvt_pk_bf16_f32 v54, v40, v41
    v_cvt_pk_bf16_f32 v55, v42, v43
    v_cvt_pk_bf16_f32 v56, v44, v45
    v_cvt_pk_bf16_f32 v57, v46, v47
    v_cvt_pk_bf16_f32 v58, v48, v49
    v_cvt_pk_bf16_f32 v59, v50, v51
    ds_write_b128 v5, v[52:55] offset:0
    ds_write_b128 v180, v[56:59] offset:512
    s_waitcnt lgkmcnt(2)
    v_mfma_f32_16x16x32_bf16 v[36:39], v[84:87], v[28:31], 0
    v_mfma_f32_16x16x32_bf16 v[40:43], v[88:91], v[28:31], 0
    v_mfma_f32_16x16x32_bf16 v[44:47], v[92:95], v[28:31], 0
    v_mfma_f32_16x16x32_bf16 v[48:51], v[96:99], v[28:31], 0
    s_nop 5
    v_cvt_pk_bf16_f32 v60, v36, v37
    v_cvt_pk_bf16_f32 v61, v38, v39
    v_cvt_pk_bf16_f32 v62, v40, v41
    v_cvt_pk_bf16_f32 v63, v42, v43
    v_cvt_pk_bf16_f32 v64, v44, v45
    v_cvt_pk_bf16_f32 v65, v46, v47
    v_cvt_pk_bf16_f32 v66, v48, v49
    v_cvt_pk_bf16_f32 v67, v50, v51
    ds_write_b128 v5, v[60:63] offset:1024
    ds_write_b128 v180, v[64:67] offset:1536
    s_add_u32 m0, s47, 133120
    s_mov_b32 s58, s41
    buffer_load_dwordx4 v1, s[12:15], s58 offen lds
    s_add_u32 m0, s47, 134144
    s_nop 0
    buffer_load_dwordx4 v2, s[12:15], s58 offen lds
    s_add_u32 m0, s47, 135168
    s_add_u32 s58, s58, s101
    buffer_load_dwordx4 v2, s[12:15], s58 offen lds
    s_add_u32 m0, s47, 136192
    s_add_u32 s58, s58, s101
    buffer_load_dwordx4 v2, s[12:15], s58 offen lds
    s_add_u32 m0, s47, 137216
    s_add_u32 s58, s58, s101
    buffer_load_dwordx4 v3, s[12:15], s58 offen lds
    s_waitcnt lgkmcnt(0)
    s_barrier
    s_mul_i32 s59, s41, 96
    s_add_u32 s59, s59, s94
    s_add_u32 m0, s99, 61440
    s_nop 0
    buffer_load_dwordx4 v16, s[16:19], s59 offen offset:0 lds
    buffer_load_dwordx4 v17, s[16:19], s59 offen offset:1024 lds
    buffer_load_dwordx4 v18, s[16:19], s59 offen offset:2048 lds
    v_mfma_f32_16x16x32_bf16 v[36:39], v[68:71], v[32:35], 0
    v_mfma_f32_16x16x32_bf16 v[40:43], v[72:75], v[32:35], 0
    v_mfma_f32_16x16x32_bf16 v[44:47], v[76:79], v[32:35], 0
    v_mfma_f32_16x16x32_bf16 v[48:51], v[80:83], v[32:35], 0
    s_add_u32 m0, s99, 67584
    s_add_u32 s59, s59, s95
    buffer_load_dwordx4 v16, s[16:19], s59 offen offset:0 lds
    buffer_load_dwordx4 v17, s[16:19], s59 offen offset:1024 lds
    buffer_load_dwordx4 v18, s[16:19], s59 offen offset:2048 lds
    s_nop 5
    v_cvt_pk_bf16_f32 v164, v36, v37
    v_cvt_pk_bf16_f32 v165, v38, v39
    v_cvt_pk_bf16_f32 v166, v40, v41
    v_cvt_pk_bf16_f32 v167, v42, v43
    v_cvt_pk_bf16_f32 v168, v44, v45
    v_cvt_pk_bf16_f32 v169, v46, v47
    v_cvt_pk_bf16_f32 v170, v48, v49
    v_cvt_pk_bf16_f32 v171, v50, v51
    v_mfma_f32_16x16x32_bf16 v[36:39], v[84:87], v[32:35], 0
    v_mfma_f32_16x16x32_bf16 v[40:43], v[88:91], v[32:35], 0
    v_mfma_f32_16x16x32_bf16 v[44:47], v[92:95], v[32:35], 0
    v_mfma_f32_16x16x32_bf16 v[48:51], v[96:99], v[32:35], 0
    s_nop 5
    v_cvt_pk_bf16_f32 v172, v36, v37
    v_cvt_pk_bf16_f32 v173, v38, v39
    v_cvt_pk_bf16_f32 v174, v40, v41
    v_cvt_pk_bf16_f32 v175, v42, v43
    v_cvt_pk_bf16_f32 v200, v44, v45
    v_cvt_pk_bf16_f32 v201, v46, v47
    v_cvt_pk_bf16_f32 v202, v48, v49
    v_cvt_pk_bf16_f32 v203, v50, v51
    s_waitcnt lgkmcnt(0)
    s_barrier
    s_add_u32 m0, s99, 73728
    s_add_u32 s59, s59, s95
    buffer_load_dwordx4 v16, s[16:19], s59 offen offset:0 lds
    buffer_load_dwordx4 v17, s[16:19], s59 offen offset:1024 lds
    buffer_load_dwordx4 v18, s[16:19], s59 offen offset:2048 lds
    v_mfma_f32_16x16x32_bf16 v[36:39], v[68:71], v[176:179], 0
    v_mfma_f32_16x16x32_bf16 v[40:43], v[72:75], v[176:179], 0
    v_mfma_f32_16x16x32_bf16 v[44:47], v[76:79], v[176:179], 0
    v_mfma_f32_16x16x32_bf16 v[48:51], v[80:83], v[176:179], 0
    s_add_u32 m0, s99, 79872
    s_add_u32 s59, s59, s95
    buffer_load_dwordx4 v16, s[16:19], s59 offen offset:0 lds
    buffer_load_dwordx4 v17, s[16:19], s59 offen offset:1024 lds
    buffer_load_dwordx4 v18, s[16:19], s59 offen offset:2048 lds
    s_nop 5
    v_cvt_pk_bf16_f32 v224, v36, v37
    v_cvt_pk_bf16_f32 v225, v38, v39
    v_cvt_pk_bf16_f32 v226, v40, v41
    v_cvt_pk_bf16_f32 v227, v42, v43
    v_cvt_pk_bf16_f32 v228, v44, v45
    v_cvt_pk_bf16_f32 v229, v46, v47
    v_cvt_pk_bf16_f32 v230, v48, v49
    v_cvt_pk_bf16_f32 v231, v50, v51
    s_add_u32 m0, s99, 86016
    s_add_u32 s59, s59, s95
    buffer_load_dwordx4 v16, s[16:19], s59 offen offset:0 lds
    buffer_load_dwordx4 v17, s[16:19], s59 offen offset:1024 lds
    buffer_load_dwordx4 v18, s[16:19], s59 offen offset:2048 lds
    v_mfma_f32_16x16x32_bf16 v[36:39], v[84:87], v[176:179], 0
    v_mfma_f32_16x16x32_bf16 v[40:43], v[88:91], v[176:179], 0
    v_mfma_f32_16x16x32_bf16 v[44:47], v[92:95], v[176:179], 0
    v_mfma_f32_16x16x32_bf16 v[48:51], v[96:99], v[176:179], 0
    s_nop 5
    v_cvt_pk_bf16_f32 v232, v36, v37
    v_cvt_pk_bf16_f32 v233, v38, v39
    v_cvt_pk_bf16_f32 v234, v40, v41
    v_cvt_pk_bf16_f32 v235, v42, v43
    v_cvt_pk_bf16_f32 v236, v44, v45
    v_cvt_pk_bf16_f32 v237, v46, v47
    v_cvt_pk_bf16_f32 v238, v48, v49
    v_cvt_pk_bf16_f32 v239, v50, v51
    s_waitcnt vmcnt(15)
    ds_read_b64_tr_b16 v[100:101], v11 offset:0
    ds_read_b64_tr_b16 v[102:103], v12 offset:0
    ds_read_b64_tr_b16 v[104:105], v11 offset:8
    ds_read_b64_tr_b16 v[106:107], v12 offset:8
    ds_read_b64_tr_b16 v[108:109], v11 offset:256
    ds_read_b64_tr_b16 v[110:111], v12 offset:256
    ds_read_b64_tr_b16 v[112:113], v11 offset:264
    ds_read_b64_tr_b16 v[114:115], v12 offset:264
    ds_read_b64_tr_b16 v[116:117], v11 offset:512
    ds_read_b64_tr_b16 v[118:119], v12 offset:512
    ds_read_b64_tr_b16 v[120:121], v11 offset:520
    ds_read_b64_tr_b16 v[122:123], v12 offset:520
    ds_read_b64_tr_b16 v[124:125], v11 offset:768
    ds_read_b64_tr_b16 v[126:127], v12 offset:768
    ds_read_b64_tr_b16 v[128:129], v11 offset:776
    ds_read_b64_tr_b16 v[130:131], v12 offset:776
    s_waitcnt lgkmcnt(8)
    v_mfma_f32_16x16x32_bf16 v[36:39], v[100:103], v[28:31], 0
    v_mfma_f32_16x16x32_bf16 v[40:43], v[104:107], v[28:31], 0
    v_mfma_f32_16x16x32_bf16 v[44:47], v[108:111], v[28:31], 0
    v_mfma_f32_16x16x32_bf16 v[48:51], v[112:115], v[28:31], 0
    s_nop 5
    v_cvt_pk_bf16_f32 v240, v36, v37
    v_cvt_pk_bf16_f32 v241, v38, v39
    v_cvt_pk_bf16_f32 v242, v40, v41
    v_cvt_pk_bf16_f32 v243, v42, v43
    v_cvt_pk_bf16_f32 v244, v44, v45
    v_cvt_pk_bf16_f32 v245, v46, v47
    v_cvt_pk_bf16_f32 v246, v48, v49
    v_cvt_pk_bf16_f32 v247, v50, v51
    ds_write_b128 v5, v[240:243] offset:20480
    ds_write_b128 v180, v[244:247] offset:20992
    s_waitcnt lgkmcnt(2)
    v_mfma_f32_16x16x32_bf16 v[36:39], v[116:119], v[28:31], 0
    v_mfma_f32_16x16x32_bf16 v[40:43], v[120:123], v[28:31], 0
    v_mfma_f32_16x16x32_bf16 v[44:47], v[124:127], v[28:31], 0
    v_mfma_f32_16x16x32_bf16 v[48:51], v[128:131], v[28:31], 0
    s_nop 5
    v_cvt_pk_bf16_f32 v248, v36, v37
    v_cvt_pk_bf16_f32 v249, v38, v39
    v_cvt_pk_bf16_f32 v250, v40, v41
    v_cvt_pk_bf16_f32 v251, v42, v43
    v_cvt_pk_bf16_f32 v252, v44, v45
    v_cvt_pk_bf16_f32 v253, v46, v47
    v_cvt_pk_bf16_f32 v254, v48, v49
    v_cvt_pk_bf16_f32 v255, v50, v51
    ds_write_b128 v5, v[248:251] offset:21504
    ds_write_b128 v180, v[252:255] offset:22016
    s_add_u32 m0, s47, 133120
    s_mov_b32 s58, s42
    buffer_load_dwordx4 v1, s[12:15], s58 offen lds
    s_add_u32 m0, s47, 134144
    s_nop 0
    buffer_load_dwordx4 v2, s[12:15], s58 offen lds
    s_add_u32 m0, s47, 135168
    s_add_u32 s58, s58, s101
    buffer_load_dwordx4 v2, s[12:15], s58 offen lds
    s_add_u32 m0, s47, 136192
    s_add_u32 s58, s58, s101
    buffer_load_dwordx4 v2, s[12:15], s58 offen lds
    s_add_u32 m0, s47, 137216
    s_add_u32 s58, s58, s101
    buffer_load_dwordx4 v3, s[12:15], s58 offen lds
    s_waitcnt vmcnt(5)
    s_waitcnt lgkmcnt(0)
    s_barrier
    s_mul_i32 s59, s41, 96
    s_add_u32 s59, s59, s96
    s_add_u32 m0, s99, 0
    s_nop 0
    buffer_load_dwordx4 v16, s[16:19], s59 offen offset:0 lds
    buffer_load_dwordx4 v17, s[16:19], s59 offen offset:1024 lds
    buffer_load_dwordx4 v18, s[16:19], s59 offen offset:2048 lds
    s_add_u32 m0, s99, 6144
    s_add_u32 s59, s59, s95
    buffer_load_dwordx4 v16, s[16:19], s59 offen offset:0 lds
    buffer_load_dwordx4 v17, s[16:19], s59 offen offset:1024 lds
    buffer_load_dwordx4 v18, s[16:19], s59 offen offset:2048 lds
    s_add_u32 m0, s99, 12288
    s_add_u32 s59, s59, s95
    buffer_load_dwordx4 v16, s[16:19], s59 offen offset:0 lds
    buffer_load_dwordx4 v17, s[16:19], s59 offen offset:1024 lds
    buffer_load_dwordx4 v18, s[16:19], s59 offen offset:2048 lds
    s_waitcnt vmcnt(9)
    ds_read_b64_tr_b16 v[132:133], v11 offset:0
    ds_read_b64_tr_b16 v[134:135], v12 offset:0
    ds_read_b64_tr_b16 v[136:137], v11 offset:8
    ds_read_b64_tr_b16 v[138:139], v12 offset:8
    ds_read_b64_tr_b16 v[140:141], v11 offset:256
    ds_read_b64_tr_b16 v[142:143], v12 offset:256
    ds_read_b64_tr_b16 v[144:145], v11 offset:264
    ds_read_b64_tr_b16 v[146:147], v12 offset:264
    ds_read_b64_tr_b16 v[148:149], v11 offset:512
    ds_read_b64_tr_b16 v[150:151], v12 offset:512
    ds_read_b64_tr_b16 v[152:153], v11 offset:520
    ds_read_b64_tr_b16 v[154:155], v12 offset:520
    ds_read_b64_tr_b16 v[156:157], v11 offset:768
    ds_read_b64_tr_b16 v[158:159], v12 offset:768
    ds_read_b64_tr_b16 v[160:161], v11 offset:776
    ds_read_b64_tr_b16 v[162:163], v12 offset:776
    s_add_u32 m0, s99, 18432
    s_add_u32 s59, s59, s95
    buffer_load_dwordx4 v16, s[16:19], s59 offen offset:0 lds
    buffer_load_dwordx4 v17, s[16:19], s59 offen offset:1024 lds
    buffer_load_dwordx4 v18, s[16:19], s59 offen offset:2048 lds
    s_waitcnt lgkmcnt(0)
    s_add_u32 m0, s99, 24576
    s_add_u32 s59, s59, s95
    buffer_load_dwordx4 v16, s[16:19], s59 offen offset:0 lds
    buffer_load_dwordx4 v17, s[16:19], s59 offen offset:1024 lds
    buffer_load_dwordx4 v18, s[16:19], s59 offen offset:2048 lds
    v_mfma_f32_16x16x32_bf16 v[36:39], v[132:135], v[28:31], 0
    v_mfma_f32_16x16x32_bf16 v[40:43], v[136:139], v[28:31], 0
    v_mfma_f32_16x16x32_bf16 v[44:47], v[140:143], v[28:31], 0
    v_mfma_f32_16x16x32_bf16 v[48:51], v[144:147], v[28:31], 0
    s_mul_i32 s59, s42, 96
    s_add_u32 s59, s59, s94
    s_add_u32 m0, s99, 30720
    s_nop 0
    buffer_load_dwordx4 v16, s[16:19], s59 offen offset:0 lds
    buffer_load_dwordx4 v17, s[16:19], s59 offen offset:1024 lds
    buffer_load_dwordx4 v18, s[16:19], s59 offen offset:2048 lds
    s_nop 5
    v_cvt_pk_bf16_f32 v52, v36, v37
    v_cvt_pk_bf16_f32 v53, v38, v39
    v_cvt_pk_bf16_f32 v54, v40, v41
    v_cvt_pk_bf16_f32 v55, v42, v43
    v_cvt_pk_bf16_f32 v56, v44, v45
    v_cvt_pk_bf16_f32 v57, v46, v47
    v_cvt_pk_bf16_f32 v58, v48, v49
    v_cvt_pk_bf16_f32 v59, v50, v51
    v_mfma_f32_16x16x32_bf16 v[36:39], v[148:151], v[28:31], 0
    v_mfma_f32_16x16x32_bf16 v[40:43], v[152:155], v[28:31], 0
    v_mfma_f32_16x16x32_bf16 v[44:47], v[156:159], v[28:31], 0
    v_mfma_f32_16x16x32_bf16 v[48:51], v[160:163], v[28:31], 0
    s_nop 5
    v_cvt_pk_bf16_f32 v60, v36, v37
    v_cvt_pk_bf16_f32 v61, v38, v39
    v_cvt_pk_bf16_f32 v62, v40, v41
    v_cvt_pk_bf16_f32 v63, v42, v43
    v_cvt_pk_bf16_f32 v64, v44, v45
    v_cvt_pk_bf16_f32 v65, v46, v47
    v_cvt_pk_bf16_f32 v66, v48, v49
    v_cvt_pk_bf16_f32 v67, v50, v51
    s_waitcnt vmcnt(3)
    s_waitcnt lgkmcnt(0)
    s_barrier
    ds_write_b128 v5, v[52:55] offset:0
    ds_write_b128 v180, v[56:59] offset:512
    ds_write_b128 v5, v[60:63] offset:1024
    ds_write_b128 v180, v[64:67] offset:1536
    s_add_u32 m0, s99, 36864
    s_add_u32 s59, s59, s95
    buffer_load_dwordx4 v16, s[16:19], s59 offen offset:0 lds
    buffer_load_dwordx4 v17, s[16:19], s59 offen offset:1024 lds
    buffer_load_dwordx4 v18, s[16:19], s59 offen offset:2048 lds
    v_mfma_f32_16x16x32_bf16 v[36:39], v[100:103], v[32:35], 0
    v_mfma_f32_16x16x32_bf16 v[40:43], v[104:107], v[32:35], 0
    v_mfma_f32_16x16x32_bf16 v[44:47], v[108:111], v[32:35], 0
    v_mfma_f32_16x16x32_bf16 v[48:51], v[112:115], v[32:35], 0
    s_add_u32 m0, s99, 43008
    s_add_u32 s59, s59, s95
    buffer_load_dwordx4 v16, s[16:19], s59 offen offset:0 lds
    buffer_load_dwordx4 v17, s[16:19], s59 offen offset:1024 lds
    buffer_load_dwordx4 v18, s[16:19], s59 offen offset:2048 lds
    s_nop 5
    v_cvt_pk_bf16_f32 v240, v36, v37
    v_cvt_pk_bf16_f32 v241, v38, v39
    v_cvt_pk_bf16_f32 v242, v40, v41
    v_cvt_pk_bf16_f32 v243, v42, v43
    v_cvt_pk_bf16_f32 v244, v44, v45
    v_cvt_pk_bf16_f32 v245, v46, v47
    v_cvt_pk_bf16_f32 v246, v48, v49
    v_cvt_pk_bf16_f32 v247, v50, v51
    s_add_u32 m0, s99, 49152
    s_add_u32 s59, s59, s95
    buffer_load_dwordx4 v16, s[16:19], s59 offen offset:0 lds
    buffer_load_dwordx4 v17, s[16:19], s59 offen offset:1024 lds
    buffer_load_dwordx4 v18, s[16:19], s59 offen offset:2048 lds
    s_add_u32 m0, s99, 55296
    s_add_u32 s59, s59, s95
    buffer_load_dwordx4 v16, s[16:19], s59 offen offset:0 lds
    buffer_load_dwordx4 v17, s[16:19], s59 offen offset:1024 lds
    buffer_load_dwordx4 v18, s[16:19], s59 offen offset:2048 lds
    s_mul_i32 s59, s42, 96
    s_add_u32 s59, s59, s96
    s_add_u32 m0, s99, 61440
    s_nop 0
    buffer_load_dwordx4 v16, s[16:19], s59 offen offset:0 lds
    buffer_load_dwordx4 v17, s[16:19], s59 offen offset:1024 lds
    buffer_load_dwordx4 v18, s[16:19], s59 offen offset:2048 lds
    s_add_u32 m0, s99, 67584
    s_add_u32 s59, s59, s95
    buffer_load_dwordx4 v16, s[16:19], s59 offen offset:0 lds
    buffer_load_dwordx4 v17, s[16:19], s59 offen offset:1024 lds
    buffer_load_dwordx4 v18, s[16:19], s59 offen offset:2048 lds
    buffer_load_dword v19, v20, s[28:31], 0 offen sc1
    s_waitcnt vmcnt(7)
    s_waitcnt lgkmcnt(0)
    s_barrier
    ds_write_b128 v5, v[164:167] offset:20480
    ds_write_b128 v180, v[168:171] offset:20992
    s_add_u32 m0, s99, 73728
    s_add_u32 s59, s59, s95
    buffer_load_dwordx4 v16, s[16:19], s59 offen offset:0 lds
    buffer_load_dwordx4 v17, s[16:19], s59 offen offset:1024 lds
    buffer_load_dwordx4 v18, s[16:19], s59 offen offset:2048 lds
    v_mfma_f32_16x16x32_bf16 v[36:39], v[116:119], v[32:35], 0
    v_mfma_f32_16x16x32_bf16 v[40:43], v[120:123], v[32:35], 0
    v_mfma_f32_16x16x32_bf16 v[44:47], v[124:127], v[32:35], 0
    v_mfma_f32_16x16x32_bf16 v[48:51], v[128:131], v[32:35], 0
    s_add_u32 m0, s99, 79872
    s_add_u32 s59, s59, s95
    buffer_load_dwordx4 v16, s[16:19], s59 offen offset:0 lds
    buffer_load_dwordx4 v17, s[16:19], s59 offen offset:1024 lds
    buffer_load_dwordx4 v18, s[16:19], s59 offen offset:2048 lds
    s_nop 5
    v_cvt_pk_bf16_f32 v248, v36, v37
    v_cvt_pk_bf16_f32 v249, v38, v39
    v_cvt_pk_bf16_f32 v250, v40, v41
    v_cvt_pk_bf16_f32 v251, v42, v43
    v_cvt_pk_bf16_f32 v252, v44, v45
    v_cvt_pk_bf16_f32 v253, v46, v47
    v_cvt_pk_bf16_f32 v254, v48, v49
    v_cvt_pk_bf16_f32 v255, v50, v51
    s_add_u32 m0, s99, 86016
    s_add_u32 s59, s59, s95
    buffer_load_dwordx4 v16, s[16:19], s59 offen offset:0 lds
    buffer_load_dwordx4 v17, s[16:19], s59 offen offset:1024 lds
    buffer_load_dwordx4 v18, s[16:19], s59 offen offset:2048 lds
    s_waitcnt vmcnt(9)
    v_cmp_eq_u32 vcc, 0x1, v19
    s_cmp_eq_u64 vcc, 3
    s_cbranch_scc0 L_slow
L_ready:
    s_mul_i32 s59, s40, 96
    s_add_u32 s59, s59, s97
    s_add_u32 m0, s99, 0
    s_nop 0
    buffer_load_dwordx4 v16, s[24:27], s59 offen offset:0 sc1 lds
    buffer_load_dwordx4 v16, s[24:27], s59 offen offset:1024 sc1 lds
    buffer_load_dwordx4 v16, s[24:27], s59 offen offset:2048 sc1 lds
    s_add_u32 m0, s99, 6144
    s_add_u32 s59, s59, s98
    buffer_load_dwordx4 v16, s[24:27], s59 offen offset:0 sc1 lds
    buffer_load_dwordx4 v16, s[24:27], s59 offen offset:1024 sc1 lds
    buffer_load_dwordx4 v16, s[24:27], s59 offen offset:2048 sc1 lds
    s_add_u32 m0, s99, 12288
    s_add_u32 s59, s59, s98
    buffer_load_dwordx4 v16, s[24:27], s59 offen offset:0 sc1 lds
    buffer_load_dwordx4 v16, s[24:27], s59 offen offset:1024 sc1 lds
    buffer_load_dwordx4 v16, s[24:27], s59 offen offset:2048 sc1 lds
    s_waitcnt vmcnt(9)
    s_waitcnt lgkmcnt(0)
    s_barrier
    ds_write_b128 v5, v[172:175] offset:21504
    ds_write_b128 v180, v[200:203] offset:22016
    s_add_u32 m0, s99, 18432
    s_add_u32 s59, s59, s98
    buffer_load_dwordx4 v16, s[24:27], s59 offen offset:0 sc1 lds
    buffer_load_dwordx4 v16, s[24:27], s59 offen offset:1024 sc1 lds
    buffer_load_dwordx4 v16, s[24:27], s59 offen offset:2048 sc1 lds
    v_mfma_f32_16x16x32_bf16 v[36:39], v[132:135], v[32:35], 0
    v_mfma_f32_16x16x32_bf16 v[40:43], v[136:139], v[32:35], 0
    v_mfma_f32_16x16x32_bf16 v[44:47], v[140:143], v[32:35], 0
    v_mfma_f32_16x16x32_bf16 v[48:51], v[144:147], v[32:35], 0
    s_add_u32 m0, s99, 24576
    s_add_u32 s59, s59, s98
    buffer_load_dwordx4 v16, s[24:27], s59 offen offset:0 sc1 lds
    buffer_load_dwordx4 v16, s[24:27], s59 offen offset:1024 sc1 lds
    buffer_load_dwordx4 v16, s[24:27], s59 offen offset:2048 sc1 lds
    s_nop 5
    v_cvt_pk_bf16_f32 v52, v36, v37
    v_cvt_pk_bf16_f32 v53, v38, v39
    v_cvt_pk_bf16_f32 v54, v40, v41
    v_cvt_pk_bf16_f32 v55, v42, v43
    v_cvt_pk_bf16_f32 v56, v44, v45
    v_cvt_pk_bf16_f32 v57, v46, v47
    v_cvt_pk_bf16_f32 v58, v48, v49
    v_cvt_pk_bf16_f32 v59, v50, v51
    s_branch L_is3
.p2align 12
L_pg3:
    s_setpc_b64 s[62:63]
L_is3:
    s_mul_i32 s59, s40, 96
    s_add_u32 s59, s59, s97
    s_add_u32 s59, s59, 92160
    s_add_u32 m0, s99, 30720
    s_nop 0
    buffer_load_dwordx4 v16, s[24:27], s59 offen offset:0 sc1 lds
    buffer_load_dwordx4 v16, s[24:27], s59 offen offset:1024 sc1 lds
    buffer_load_dwordx4 v16, s[24:27], s59 offen offset:2048 sc1 lds
    s_add_u32 m0, s99, 36864
    s_add_u32 s59, s59, s98
    buffer_load_dwordx4 v16, s[24:27], s59 offen offset:0 sc1 lds
    buffer_load_dwordx4 v16, s[24:27], s59 offen offset:1024 sc1 lds
    buffer_load_dwordx4 v16, s[24:27], s59 offen offset:2048 sc1 lds
    s_add_u32 m0, s99, 43008
    s_add_u32 s59, s59, s98
    buffer_load_dwordx4 v16, s[24:27], s59 offen offset:0 sc1 lds
    buffer_load_dwordx4 v16, s[24:27], s59 offen offset:1024 sc1 lds
    buffer_load_dwordx4 v16, s[24:27], s59 offen offset:2048 sc1 lds
    s_add_u32 m0, s99, 49152
    s_add_u32 s59, s59, s98
    buffer_load_dwordx4 v16, s[24:27], s59 offen offset:0 sc1 lds
    buffer_load_dwordx4 v16, s[24:27], s59 offen offset:1024 sc1 lds
    buffer_load_dwordx4 v16, s[24:27], s59 offen offset:2048 sc1 lds
    s_waitcnt vmcnt(12)
    s_waitcnt lgkmcnt(0)
    s_barrier
    ds_write_b128 v5, v[240:243] offset:0
    ds_write_b128 v180, v[244:247] offset:512
    s_add_u32 m0, s99, 55296
    s_add_u32 s59, s59, s98
    buffer_load_dwordx4 v16, s[24:27], s59 offen offset:0 sc1 lds
    buffer_load_dwordx4 v16, s[24:27], s59 offen offset:1024 sc1 lds
    buffer_load_dwordx4 v16, s[24:27], s59 offen offset:2048 sc1 lds
    v_mfma_f32_16x16x32_bf16 v[36:39], v[148:151], v[32:35], 0
    v_mfma_f32_16x16x32_bf16 v[40:43], v[152:155], v[32:35], 0
    v_mfma_f32_16x16x32_bf16 v[44:47], v[156:159], v[32:35], 0
    v_mfma_f32_16x16x32_bf16 v[48:51], v[160:163], v[32:35], 0
    s_mul_i32 s59, s41, 96
    s_add_u32 s59, s59, s97
    s_add_u32 m0, s99, 61440
    s_nop 0
    buffer_load_dwordx4 v16, s[24:27], s59 offen offset:0 sc1 lds
    buffer_load_dwordx4 v16, s[24:27], s59 offen offset:1024 sc1 lds
    buffer_load_dwordx4 v16, s[24:27], s59 offen offset:2048 sc1 lds
    s_nop 5
    v_cvt_pk_bf16_f32 v60, v36, v37
    v_cvt_pk_bf16_f32 v61, v38, v39
    v_cvt_pk_bf16_f32 v62, v40, v41
    v_cvt_pk_bf16_f32 v63, v42, v43
    v_cvt_pk_bf16_f32 v64, v44, v45
    v_cvt_pk_bf16_f32 v65, v46, v47
    v_cvt_pk_bf16_f32 v66, v48, v49
    v_cvt_pk_bf16_f32 v67, v50, v51
    s_add_u32 m0, s99, 67584
    s_add_u32 s59, s59, s98
    buffer_load_dwordx4 v16, s[24:27], s59 offen offset:0 sc1 lds
    buffer_load_dwordx4 v16, s[24:27], s59 offen offset:1024 sc1 lds
    buffer_load_dwordx4 v16, s[24:27], s59 offen offset:2048 sc1 lds
    s_add_u32 m0, s99, 73728
    s_add_u32 s59, s59, s98
    buffer_load_dwordx4 v16, s[24:27], s59 offen offset:0 sc1 lds
    buffer_load_dwordx4 v16, s[24:27], s59 offen offset:1024 sc1 lds
    buffer_load_dwordx4 v16, s[24:27], s59 offen offset:2048 sc1 lds
    s_add_u32 m0, s99, 79872
    s_add_u32 s59, s59, s98
    buffer_load_dwordx4 v16, s[24:27], s59 offen offset:0 sc1 lds
    buffer_load_dwordx4 v16, s[24:27], s59 offen offset:1024 sc1 lds
    buffer_load_dwordx4 v16, s[24:27], s59 offen offset:2048 sc1 lds
    s_add_u32 m0, s99, 86016
    s_add_u32 s59, s59, s98
    buffer_load_dwordx4 v16, s[24:27], s59 offen offset:0 sc1 lds
    buffer_load_dwordx4 v16, s[24:27], s59 offen offset:1024 sc1 lds
    buffer_load_dwordx4 v16, s[24:27], s59 offen offset:2048 sc1 lds
    s_waitcnt vmcnt(15)
    s_waitcnt lgkmcnt(0)
    s_barrier
    ds_write_b128 v5, v[248:251] offset:1024
    ds_write_b128 v180, v[252:255] offset:1536
    s_mul_i32 s59, s41, 96
    s_add_u32 s59, s59, s97
    s_add_u32 s59, s59, 92160
    s_add_u32 m0, s99, 0
    s_nop 0
    buffer_load_dwordx4 v16, s[24:27], s59 offen offset:0 sc1 lds
    buffer_load_dwordx4 v16, s[24:27], s59 offen offset:1024 sc1 lds
    buffer_load_dwordx4 v16, s[24:27], s59 offen offset:2048 sc1 lds
    v_mfma_f32_16x16x32_bf16 v[36:39], v[100:103], v[176:179], 0
    v_mfma_f32_16x16x32_bf16 v[40:43], v[104:107], v[176:179], 0
    v_mfma_f32_16x16x32_bf16 v[44:47], v[108:111], v[176:179], 0
    v_mfma_f32_16x16x32_bf16 v[48:51], v[112:115], v[176:179], 0
    s_add_u32 m0, s99, 6144
    s_add_u32 s59, s59, s98
    buffer_load_dwordx4 v16, s[24:27], s59 offen offset:0 sc1 lds
    buffer_load_dwordx4 v16, s[24:27], s59 offen offset:1024 sc1 lds
    buffer_load_dwordx4 v16, s[24:27], s59 offen offset:2048 sc1 lds
    s_nop 5
    v_cvt_pk_bf16_f32 v164, v36, v37
    v_cvt_pk_bf16_f32 v165, v38, v39
    v_cvt_pk_bf16_f32 v166, v40, v41
    v_cvt_pk_bf16_f32 v167, v42, v43
    v_cvt_pk_bf16_f32 v168, v44, v45
    v_cvt_pk_bf16_f32 v169, v46, v47
    v_cvt_pk_bf16_f32 v170, v48, v49
    v_cvt_pk_bf16_f32 v171, v50, v51
    s_add_u32 m0, s99, 12288
    s_add_u32 s59, s59, s98
    buffer_load_dwordx4 v16, s[24:27], s59 offen offset:0 sc1 lds
    buffer_load_dwordx4 v16, s[24:27], s59 offen offset:1024 sc1 lds
    buffer_load_dwordx4 v16, s[24:27], s59 offen offset:2048 sc1 lds
    s_add_u32 m0, s99, 18432
    s_add_u32 s59, s59, s98
    buffer_load_dwordx4 v16, s[24:27], s59 offen offset:0 sc1 lds
    buffer_load_dwordx4 v16, s[24:27], s59 offen offset:1024 sc1 lds
    buffer_load_dwordx4 v16, s[24:27], s59 offen offset:2048 sc1 lds
    s_add_u32 m0, s99, 24576
    s_add_u32 s59, s59, s98
    buffer_load_dwordx4 v16, s[24:27], s59 offen offset:0 sc1 lds
    buffer_load_dwordx4 v16, s[24:27], s59 offen offset:1024 sc1 lds
    buffer_load_dwordx4 v16, s[24:27], s59 offen offset:2048 sc1 lds
    s_waitcnt vmcnt(15)
    s_waitcnt lgkmcnt(0)
    s_barrier
    ds_write_b128 v5, v[52:55] offset:20480
    ds_write_b128 v180, v[56:59] offset:20992
    s_mul_i32 s59, s42, 96
    s_add_u32 s59, s59, s97
    s_add_u32 m0, s99, 30720
    s_nop 0
    buffer_load_dwordx4 v16, s[24:27], s59 offen offset:0 sc1 lds
    buffer_load_dwordx4 v16, s[24:27], s59 offen offset:1024 sc1 lds
    buffer_load_dwordx4 v16, s[24:27], s59 offen offset:2048 sc1 lds
    v_mfma_f32_16x16x32_bf16 v[36:39], v[116:119], v[176:179], 0
    v_mfma_f32_16x16x32_bf16 v[40:43], v[120:123], v[176:179], 0
    v_mfma_f32_16x16x32_bf16 v[44:47], v[124:127], v[176:179], 0
    v_mfma_f32_16x16x32_bf16 v[48:51], v[128:131], v[176:179], 0
    s_add_u32 m0, s99, 36864
    s_add_u32 s59, s59, s98
    buffer_load_dwordx4 v16, s[24:27], s59 offen offset:0 sc1 lds
    buffer_load_dwordx4 v16, s[24:27], s59 offen offset:1024 sc1 lds
    buffer_load_dwordx4 v16, s[24:27], s59 offen offset:2048 sc1 lds
    s_nop 5
    v_cvt_pk_bf16_f32 v172, v36, v37
    v_cvt_pk_bf16_f32 v173, v38, v39
    v_cvt_pk_bf16_f32 v174, v40, v41
    v_cvt_pk_bf16_f32 v175, v42, v43
    v_cvt_pk_bf16_f32 v200, v44, v45
    v_cvt_pk_bf16_f32 v201, v46, v47
    v_cvt_pk_bf16_f32 v202, v48, v49
    v_cvt_pk_bf16_f32 v203, v50, v51
    s_add_u32 m0, s99, 43008
    s_add_u32 s59, s59, s98
    buffer_load_dwordx4 v16, s[24:27], s59 offen offset:0 sc1 lds
    buffer_load_dwordx4 v16, s[24:27], s59 offen offset:1024 sc1 lds
    buffer_load_dwordx4 v16, s[24:27], s59 offen offset:2048 sc1 lds
    s_add_u32 m0, s99, 49152
    s_add_u32 s59, s59, s98
    buffer_load_dwordx4 v16, s[24:27], s59 offen offset:0 sc1 lds
    buffer_load_dwordx4 v16, s[24:27], s59 offen offset:1024 sc1 lds
    buffer_load_dwordx4 v16, s[24:27], s59 offen offset:2048 sc1 lds
    s_add_u32 m0, s99, 55296
    s_add_u32 s59, s59, s98
    buffer_load_dwordx4 v16, s[24:27], s59 offen offset:0 sc1 lds
    buffer_load_dwordx4 v16, s[24:27], s59 offen offset:1024 sc1 lds
    buffer_load_dwordx4 v16, s[24:27], s59 offen offset:2048 sc1 lds
    s_waitcnt vmcnt(15)
    s_waitcnt lgkmcnt(0)
    s_barrier
    ds_write_b128 v5, v[60:63] offset:21504
    ds_write_b128 v180, v[64:67] offset:22016
    s_mul_i32 s59, s42, 96
    s_add_u32 s59, s59, s97
    s_add_u32 s59, s59, 92160
    s_add_u32 m0, s99, 61440
    s_nop 0
    buffer_load_dwordx4 v16, s[24:27], s59 offen offset:0 sc1 lds
    buffer_load_dwordx4 v16, s[24:27], s59 offen offset:1024 sc1 lds
    buffer_load_dwordx4 v16, s[24:27], s59 offen offset:2048 sc1 lds
    v_mfma_f32_16x16x32_bf16 v[36:39], v[132:135], v[176:179], 0
    v_mfma_f32_16x16x32_bf16 v[40:43], v[136:139], v[176:179], 0
    v_mfma_f32_16x16x32_bf16 v[44:47], v[140:143], v[176:179], 0
    v_mfma_f32_16x16x32_bf16 v[48:51], v[144:147], v[176:179], 0
    s_add_u32 m0, s99, 67584
    s_add_u32 s59, s59, s98
    buffer_load_dwordx4 v16, s[24:27], s59 offen offset:0 sc1 lds
    buffer_load_dwordx4 v16, s[24:27], s59 offen offset:1024 sc1 lds
    buffer_load_dwordx4 v16, s[24:27], s59 offen offset:2048 sc1 lds
    s_nop 5
    v_cvt_pk_bf16_f32 v240, v36, v37
    v_cvt_pk_bf16_f32 v241, v38, v39
    v_cvt_pk_bf16_f32 v242, v40, v41
    v_cvt_pk_bf16_f32 v243, v42, v43
    v_cvt_pk_bf16_f32 v244, v44, v45
    v_cvt_pk_bf16_f32 v245, v46, v47
    v_cvt_pk_bf16_f32 v246, v48, v49
    v_cvt_pk_bf16_f32 v247, v50, v51
    s_add_u32 m0, s99, 73728
    s_add_u32 s59, s59, s98
    buffer_load_dwordx4 v16, s[24:27], s59 offen offset:0 sc1 lds
    buffer_load_dwordx4 v16, s[24:27], s59 offen offset:1024 sc1 lds
    buffer_load_dwordx4 v16, s[24:27], s59 offen offset:2048 sc1 lds
    s_add_u32 m0, s99, 79872
    s_add_u32 s59, s59, s98
    buffer_load_dwordx4 v16, s[24:27], s59 offen offset:0 sc1 lds
    buffer_load_dwordx4 v16, s[24:27], s59 offen offset:1024 sc1 lds
    buffer_load_dwordx4 v16, s[24:27], s59 offen offset:2048 sc1 lds
    s_add_u32 m0, s99, 86016
    s_add_u32 s59, s59, s98
    buffer_load_dwordx4 v16, s[24:27], s59 offen offset:0 sc1 lds
    buffer_load_dwordx4 v16, s[24:27], s59 offen offset:1024 sc1 lds
    buffer_load_dwordx4 v16, s[24:27], s59 offen offset:2048 sc1 lds
    s_waitcnt vmcnt(15)
    s_waitcnt lgkmcnt(0)
    s_barrier
    ds_write_b128 v5, v[224:227] offset:0
    ds_write_b128 v180, v[228:231] offset:512
    s_mul_i32 s59, s40, 96
    s_add_u32 s59, s59, s97
    s_add_u32 s59, s59, 184320
    s_add_u32 m0, s99, 0
    s_nop 0
    buffer_load_dwordx4 v16, s[24:27], s59 offen offset:0 sc1 lds
    buffer_load_dwordx4 v16, s[24:27], s59 offen offset:1024 sc1 lds
    buffer_load_dwordx4 v16, s[24:27], s59 offen offset:2048 sc1 lds
    v_mfma_f32_16x16x32_bf16 v[36:39], v[148:151], v[176:179], 0
    v_mfma_f32_16x16x32_bf16 v[40:43], v[152:155], v[176:179], 0
    v_mfma_f32_16x16x32_bf16 v[44:47], v[156:159], v[176:179], 0
    v_mfma_f32_16x16x32_bf16 v[48:51], v[160:163], v[176:179], 0
    s_add_u32 m0, s99, 6144
    s_add_u32 s59, s59, s98
    buffer_load_dwordx4 v16, s[24:27], s59 offen offset:0 sc1 lds
    buffer_load_dwordx4 v16, s[24:27], s59 offen offset:1024 sc1 lds
    buffer_load_dwordx4 v16, s[24:27], s59 offen offset:2048 sc1 lds
    s_nop 5
    v_cvt_pk_bf16_f32 v248, v36, v37
    v_cvt_pk_bf16_f32 v249, v38, v39
    v_cvt_pk_bf16_f32 v250, v40, v41
    v_cvt_pk_bf16_f32 v251, v42, v43
    v_cvt_pk_bf16_f32 v252, v44, v45
    v_cvt_pk_bf16_f32 v253, v46, v47
    v_cvt_pk_bf16_f32 v254, v48, v49
    v_cvt_pk_bf16_f32 v255, v50, v51
    s_add_u32 m0, s99, 12288
    s_add_u32 s59, s59, s98
    buffer_load_dwordx4 v16, s[24:27], s59 offen offset:0 sc1 lds
    buffer_load_dwordx4 v16, s[24:27], s59 offen offset:1024 sc1 lds
    buffer_load_dwordx4 v16, s[24:27], s59 offen offset:2048 sc1 lds
    s_add_u32 m0, s99, 18432
    s_add_u32 s59, s59, s98
    buffer_load_dwordx4 v16, s[24:27], s59 offen offset:0 sc1 lds
    buffer_load_dwordx4 v16, s[24:27], s59 offen offset:1024 sc1 lds
    buffer_load_dwordx4 v16, s[24:27], s59 offen offset:2048 sc1 lds
    s_add_u32 m0, s99, 24576
    s_add_u32 s59, s59, s98
    buffer_load_dwordx4 v16, s[24:27], s59 offen offset:0 sc1 lds
    buffer_load_dwordx4 v16, s[24:27], s59 offen offset:1024 sc1 lds
    buffer_load_dwordx4 v16, s[24:27], s59 offen offset:2048 sc1 lds
    s_waitcnt vmcnt(15)
    s_waitcnt lgkmcnt(0)
    s_barrier
    ds_write_b128 v5, v[232:235] offset:1024
    ds_write_b128 v180, v[236:239] offset:1536
    s_mul_i32 s59, s40, 96
    s_add_u32 s59, s59, s97
    s_add_u32 s59, s59, 276480
    s_add_u32 m0, s99, 30720
    s_nop 0
    buffer_load_dwordx4 v16, s[24:27], s59 offen offset:0 sc1 lds
    buffer_load_dwordx4 v16, s[24:27], s59 offen offset:1024 sc1 lds
    buffer_load_dwordx4 v16, s[24:27], s59 offen offset:2048 sc1 lds
    s_add_u32 m0, s99, 36864
    s_add_u32 s59, s59, s98
    buffer_load_dwordx4 v16, s[24:27], s59 offen offset:0 sc1 lds
    buffer_load_dwordx4 v16, s[24:27], s59 offen offset:1024 sc1 lds
    buffer_load_dwordx4 v16, s[24:27], s59 offen offset:2048 sc1 lds
    s_add_u32 m0, s99, 43008
    s_add_u32 s59, s59, s98
    buffer_load_dwordx4 v16, s[24:27], s59 offen offset:0 sc1 lds
    buffer_load_dwordx4 v16, s[24:27], s59 offen offset:1024 sc1 lds
    buffer_load_dwordx4 v16, s[24:27], s59 offen offset:2048 sc1 lds
    s_add_u32 m0, s99, 49152
    s_add_u32 s59, s59, s98
    buffer_load_dwordx4 v16, s[24:27], s59 offen offset:0 sc1 lds
    buffer_load_dwordx4 v16, s[24:27], s59 offen offset:1024 sc1 lds
    buffer_load_dwordx4 v16, s[24:27], s59 offen offset:2048 sc1 lds
    s_add_u32 m0, s99, 55296
    s_add_u32 s59, s59, s98
    buffer_load_dwordx4 v16, s[24:27], s59 offen offset:0 sc1 lds
    buffer_load_dwordx4 v16, s[24:27], s59 offen offset:1024 sc1 lds
    buffer_load_dwordx4 v16, s[24:27], s59 offen offset:2048 sc1 lds
    s_waitcnt vmcnt(15)
    s_waitcnt lgkmcnt(0)
    s_barrier
    ds_write_b128 v5, v[164:167] offset:20480
    ds_write_b128 v180, v[168:171] offset:20992
    s_and_b32 s48, s99, 1024
    s_sub_u32 s49, s97, s99
    s_add_u32 s49, s49, s48
    s_mul_i32 s59, s41, 3
    s_add_u32 s59, s59, s43
    s_lshl_b32 s59, s59, 5
    s_add_u32 s59, s59, s49
    s_add_u32 m0, s48, 61440
    s_add_u32 s59, s59, 184320
    buffer_load_dwordx4 v16, s[24:27], s59 offen sc1 lds
    s_add_u32 m0, s48, 63488
    s_add_u32 s59, s59, s98
    buffer_load_dwordx4 v16, s[24:27], s59 offen sc1 lds
    s_add_u32 m0, s48, 65536
    s_add_u32 s59, s59, s98
    buffer_load_dwordx4 v16, s[24:27], s59 offen sc1 lds
    s_add_u32 m0, s48, 67584
    s_add_u32 s59, s59, s98
    buffer_load_dwordx4 v16, s[24:27], s59 offen sc1 lds
    s_add_u32 m0, s48, 69632
    s_add_u32 s59, s59, s98
    buffer_load_dwordx4 v16, s[24:27], s59 offen sc1 lds
    s_mul_i32 s59, s41, 3
    s_add_u32 s59, s59, s43
    s_lshl_b32 s59, s59, 5
    s_add_u32 s59, s59, s49
    s_add_u32 m0, s48, 71680
    s_add_u32 s59, s59, 276480
    buffer_load_dwordx4 v16, s[24:27], s59 offen sc1 lds
    s_add_u32 m0, s48, 73728
    s_add_u32 s59, s59, s98
    buffer_load_dwordx4 v16, s[24:27], s59 offen sc1 lds
    s_add_u32 m0, s48, 75776
    s_add_u32 s59, s59, s98
    buffer_load_dwordx4 v16, s[24:27], s59 offen sc1 lds
    s_add_u32 m0, s48, 77824
    s_add_u32 s59, s59, s98
    buffer_load_dwordx4 v16, s[24:27], s59 offen sc1 lds
    s_add_u32 m0, s48, 79872
    s_add_u32 s59, s59, s98
    buffer_load_dwordx4 v16, s[24:27], s59 offen sc1 lds
    s_mul_i32 s59, s42, 3
    s_add_u32 s59, s59, s43
    s_lshl_b32 s59, s59, 5
    s_add_u32 s59, s59, s49
    s_add_u32 m0, s48, 81920
    s_add_u32 s59, s59, 184320
    buffer_load_dwordx4 v16, s[24:27], s59 offen sc1 lds
    s_add_u32 m0, s48, 83968
    s_add_u32 s59, s59, s98
    buffer_load_dwordx4 v16, s[24:27], s59 offen sc1 lds
    s_add_u32 m0, s48, 86016
    s_add_u32 s59, s59, s98
    buffer_load_dwordx4 v16, s[24:27], s59 offen sc1 lds
    s_add_u32 m0, s48, 88064
    s_add_u32 s59, s59, s98
    buffer_load_dwordx4 v16, s[24:27], s59 offen sc1 lds
    s_add_u32 m0, s48, 90112
    s_add_u32 s59, s59, s98
    buffer_load_dwordx4 v16, s[24:27], s59 offen sc1 lds
    s_waitcnt vmcnt(15)
    s_waitcnt lgkmcnt(0)
    s_barrier
    ds_write_b128 v5, v[172:175] offset:21504
    ds_write_b128 v180, v[200:203] offset:22016
    s_mul_i32 s59, s42, 3
    s_add_u32 s59, s59, s43
    s_lshl_b32 s59, s59, 5
    s_add_u32 s59, s59, s49
    s_add_u32 m0, s48, 0
    s_add_u32 s59, s59, 276480
    buffer_load_dwordx4 v16, s[24:27], s59 offen sc1 lds
    s_add_u32 m0, s48, 2048
    s_add_u32 s59, s59, s98
    buffer_load_dwordx4 v16, s[24:27], s59 offen sc1 lds
    s_add_u32 m0, s48, 4096
    s_add_u32 s59, s59, s98
    buffer_load_dwordx4 v16, s[24:27], s59 offen sc1 lds
    s_add_u32 m0, s48, 6144
    s_add_u32 s59, s59, s98
    buffer_load_dwordx4 v16, s[24:27], s59 offen sc1 lds
    s_add_u32 m0, s48, 8192
    s_add_u32 s59, s59, s98
    buffer_load_dwordx4 v16, s[24:27], s59 offen sc1 lds
    s_mul_i32 s59, s41, 3
    s_add_u32 s59, s59, s44
    s_lshl_b32 s59, s59, 5
    s_add_u32 s59, s59, s49
    s_add_u32 m0, s48, 10240
    s_add_u32 s59, s59, 184320
    buffer_load_dwordx4 v16, s[24:27], s59 offen sc1 lds
    s_add_u32 m0, s48, 12288
    s_add_u32 s59, s59, s98
    buffer_load_dwordx4 v16, s[24:27], s59 offen sc1 lds
    s_add_u32 m0, s48, 14336
    s_add_u32 s59, s59, s98
    buffer_load_dwordx4 v16, s[24:27], s59 offen sc1 lds
    s_add_u32 m0, s48, 16384
    s_add_u32 s59, s59, s98
    buffer_load_dwordx4 v16, s[24:27], s59 offen sc1 lds
    s_add_u32 m0, s48, 18432
    s_add_u32 s59, s59, s98
    buffer_load_dwordx4 v16, s[24:27], s59 offen sc1 lds
    s_mul_i32 s59, s41, 3
    s_add_u32 s59, s59, s44
    s_lshl_b32 s59, s59, 5
    s_add_u32 s59, s59, s49
    s_add_u32 m0, s48, 20480
    s_add_u32 s59, s59, 276480
    buffer_load_dwordx4 v16, s[24:27], s59 offen sc1 lds
    s_add_u32 m0, s48, 22528
    s_add_u32 s59, s59, s98
    buffer_load_dwordx4 v16, s[24:27], s59 offen sc1 lds
    s_add_u32 m0, s48, 24576
    s_add_u32 s59, s59, s98
    buffer_load_dwordx4 v16, s[24:27], s59 offen sc1 lds
    s_add_u32 m0, s48, 26624
    s_add_u32 s59, s59, s98
    buffer_load_dwordx4 v16, s[24:27], s59 offen sc1 lds
    s_add_u32 m0, s48, 28672
    s_add_u32 s59, s59, s98
    buffer_load_dwordx4 v16, s[24:27], s59 offen sc1 lds
    s_waitcnt vmcnt(15)
    s_waitcnt lgkmcnt(0)
    s_barrier
    ds_write_b128 v5, v[240:243] offset:0
    ds_write_b128 v180, v[244:247] offset:512
    ds_write_b128 v5, v[248:251] offset:1024
    ds_write_b128 v180, v[252:255] offset:1536
    s_mul_i32 s59, s42, 3
    s_add_u32 s59, s59, s44
    s_lshl_b32 s59, s59, 5
    s_add_u32 s59, s59, s49
    s_add_u32 m0, s48, 30720
    s_add_u32 s59, s59, 184320
    buffer_load_dwordx4 v16, s[24:27], s59 offen sc1 lds
    s_add_u32 m0, s48, 32768
    s_add_u32 s59, s59, s98
    buffer_load_dwordx4 v16, s[24:27], s59 offen sc1 lds
    s_add_u32 m0, s48, 34816
    s_add_u32 s59, s59, s98
    buffer_load_dwordx4 v16, s[24:27], s59 offen sc1 lds
    s_add_u32 m0, s48, 36864
    s_add_u32 s59, s59, s98
    buffer_load_dwordx4 v16, s[24:27], s59 offen sc1 lds
    s_add_u32 m0, s48, 38912
    s_add_u32 s59, s59, s98
    buffer_load_dwordx4 v16, s[24:27], s59 offen sc1 lds
    s_mul_i32 s59, s42, 3
    s_add_u32 s59, s59, s44
    s_lshl_b32 s59, s59, 5
    s_add_u32 s59, s59, s49
    s_add_u32 m0, s48, 40960
    s_add_u32 s59, s59, 276480
    buffer_load_dwordx4 v16, s[24:27], s59 offen sc1 lds
    s_add_u32 m0, s48, 43008
    s_add_u32 s59, s59, s98
    buffer_load_dwordx4 v16, s[24:27], s59 offen sc1 lds
    s_add_u32 m0, s48, 45056
    s_add_u32 s59, s59, s98
    buffer_load_dwordx4 v16, s[24:27], s59 offen sc1 lds
    s_add_u32 m0, s48, 47104
    s_add_u32 s59, s59, s98
    buffer_load_dwordx4 v16, s[24:27], s59 offen sc1 lds
    s_add_u32 m0, s48, 49152
    s_add_u32 s59, s59, s98
    buffer_load_dwordx4 v16, s[24:27], s59 offen sc1 lds
    s_mul_i32 s59, s41, 3
    s_add_u32 s59, s59, s45
    s_lshl_b32 s59, s59, 5
    s_add_u32 s59, s59, s49
    s_add_u32 m0, s48, 51200
    s_add_u32 s59, s59, 184320
    buffer_load_dwordx4 v16, s[24:27], s59 offen sc1 lds
    s_add_u32 m0, s48, 53248
    s_add_u32 s59, s59, s98
    buffer_load_dwordx4 v16, s[24:27], s59 offen sc1 lds
    s_add_u32 m0, s48, 55296
    s_add_u32 s59, s59, s98
    buffer_load_dwordx4 v16, s[24:27], s59 offen sc1 lds
    s_add_u32 m0, s48, 57344
    s_add_u32 s59, s59, s98
    buffer_load_dwordx4 v16, s[24:27], s59 offen sc1 lds
    s_add_u32 m0, s48, 59392
    s_add_u32 s59, s59, s98
    buffer_load_dwordx4 v16, s[24:27], s59 offen sc1 lds
    s_waitcnt vmcnt(15)
    s_waitcnt lgkmcnt(0)
    s_barrier
    s_mul_i32 s59, s41, 3
    s_add_u32 s59, s59, s45
    s_lshl_b32 s59, s59, 5
    s_add_u32 s59, s59, s49
    s_add_u32 m0, s48, 61440
    s_add_u32 s59, s59, 276480
    buffer_load_dwordx4 v16, s[24:27], s59 offen sc1 lds
    s_add_u32 m0, s48, 63488
    s_add_u32 s59, s59, s98
    buffer_load_dwordx4 v16, s[24:27], s59 offen sc1 lds
    s_add_u32 m0, s48, 65536
    s_add_u32 s59, s59, s98
    buffer_load_dwordx4 v16, s[24:27], s59 offen sc1 lds
    s_add_u32 m0, s48, 67584
    s_add_u32 s59, s59, s98
    buffer_load_dwordx4 v16, s[24:27], s59 offen sc1 lds
    s_add_u32 m0, s48, 69632
    s_add_u32 s59, s59, s98
    buffer_load_dwordx4 v16, s[24:27], s59 offen sc1 lds
    s_mul_i32 s59, s42, 3
    s_add_u32 s59, s59, s45
    s_lshl_b32 s59, s59, 5
    s_add_u32 s59, s59, s49
    s_add_u32 m0, s48, 71680
    s_add_u32 s59, s59, 184320
    buffer_load_dwordx4 v16, s[24:27], s59 offen sc1 lds
    s_add_u32 m0, s48, 73728
    s_add_u32 s59, s59, s98
    buffer_load_dwordx4 v16, s[24:27], s59 offen sc1 lds
    s_add_u32 m0, s48, 75776
    s_add_u32 s59, s59, s98
    buffer_load_dwordx4 v16, s[24:27], s59 offen sc1 lds
    s_add_u32 m0, s48, 77824
    s_add_u32 s59, s59, s98
    buffer_load_dwordx4 v16, s[24:27], s59 offen sc1 lds
    s_add_u32 m0, s48, 79872
    s_add_u32 s59, s59, s98
    buffer_load_dwordx4 v16, s[24:27], s59 offen sc1 lds
    s_mul_i32 s59, s42, 3
    s_add_u32 s59, s59, s45
    s_lshl_b32 s59, s59, 5
    s_add_u32 s59, s59, s49
    s_add_u32 m0, s48, 81920
    s_add_u32 s59, s59, 276480
    buffer_load_dwordx4 v16, s[24:27], s59 offen sc1 lds
    s_add_u32 m0, s48, 83968
    s_add_u32 s59, s59, s98
    buffer_load_dwordx4 v16, s[24:27], s59 offen sc1 lds
    s_add_u32 m0, s48, 86016
    s_add_u32 s59, s59, s98
    buffer_load_dwordx4 v16, s[24:27], s59 offen sc1 lds
    s_add_u32 m0, s48, 88064
    s_add_u32 s59, s59, s98
    buffer_load_dwordx4 v16, s[24:27], s59 offen sc1 lds
    s_add_u32 m0, s48, 90112
    s_add_u32 s59, s59, s98
    buffer_load_dwordx4 v16, s[24:27], s59 offen sc1 lds
    s_waitcnt vmcnt(15)
    s_waitcnt lgkmcnt(0)
    s_barrier
    s_waitcnt vmcnt(0)
    s_waitcnt lgkmcnt(0)
    s_barrier
    s_waitcnt lgkmcnt(0)
    ds_read_b128 v[68:71], v7 offset:0
    s_waitcnt lgkmcnt(0)
    buffer_store_dwordx4 v[68:71], v13, s[20:23], s43 offen sc1
    s_barrier
    ds_read_b128 v[72:75], v7 offset:1024
    s_waitcnt lgkmcnt(0)
    buffer_store_dwordx4 v[72:75], v14, s[20:23], s43 offen sc1
    s_barrier
    ds_read_b128 v[76:79], v7 offset:2048
    s_waitcnt lgkmcnt(0)
    buffer_store_dwordx4 v[76:79], v15, s[20:23], s43 offen sc1
L_xout:
    s_barrier
    ds_read_b128 v[80:83], v7 offset:12288
    s_waitcnt lgkmcnt(0)
    buffer_store_dwordx4 v[80:83], v13, s[20:23], s44 offen sc1
    s_barrier
    ds_read_b128 v[84:87], v7 offset:13312
    s_waitcnt lgkmcnt(0)
    buffer_store_dwordx4 v[84:87], v14, s[20:23], s44 offen sc1
    s_barrier
    ds_read_b128 v[88:91], v7 offset:14336
    s_waitcnt lgkmcnt(0)
    buffer_store_dwordx4 v[88:91], v15, s[20:23], s44 offen sc1
    s_barrier
    ds_read_b128 v[92:95], v7 offset:0
    s_waitcnt lgkmcnt(0)
    buffer_store_dwordx4 v[92:95], v13, s[20:23], s45 offen sc1
    s_barrier
    ds_read_b128 v[96:99], v7 offset:1024
    s_waitcnt lgkmcnt(0)
    buffer_store_dwordx4 v[96:99], v14, s[20:23], s45 offen sc1
    s_barrier
    ds_read_b128 v[100:103], v7 offset:2048
    s_waitcnt lgkmcnt(0)
    buffer_store_dwordx4 v[100:103], v15, s[20:23], s45 offen sc1
    s_endpgm
L_noprod0:
    v_bfrev_b32 v18, 2
L_noprod:
    s_waitcnt lgkmcnt(0)
    s_mov_b32 s28, s10
    s_and_b32 s29, s11, 0xffff
    s_mov_b32 s30, 0x100
    s_mov_b32 s31, 0x20000
    v_mov_b32 v19, 1
    s_bfe_u32 s32, s2, 0x20003
    s_lshr_b32 s39, s32, 1
    s_and_b32 s37, s32, 1
    s_xor_b32 s38, s37, s39
    s_lshl_b32 s56, s38, 1
    s_sub_u32 s56, 1, s56
    s_bitcmp1_b32 s2, 5
    s_cselect_b32 s40, 0, 128
    s_cselect_b32 s41, 64, 0
    s_cselect_b32 s42, 128, 64
    s_bfe_u32 s48, s2, 0x10005
    s_bfe_u32 s49, s2, 0x10006
    s_lshr_b32 s50, s2, 7
    s_and_b32 s51, s2, 1
    s_lshl1_add_u32 s50, s51, s50
    s_bfe_u32 s51, s2, 0x20001
    s_lshl_b32 s59, s32, 3
    s_lshr_b32 s57, 0x0c1b0000, s59
    s_and_b32 s57, s57, 0xff
    s_lshr_b32 s58, 0x000c1b00, s59
    s_and_b32 s58, s58, 0xff
    s_mul_i32 s59, s51, 28
    s_add_u32 s57, s57, s59
    s_mul_i32 s59, s50, 28
    s_add_u32 s58, s58, s59
    s_lshl1_add_u32 s57, s57, s49
    s_lshl1_add_u32 s58, s58, s48
    s_mul_i32 s57, s57, 224
    s_add_u32 s57, s57, s58
    s_mul_i32 s33, s57, 192
    s_mov_b32 s57, 86016
    s_cmp_eq_u32 s37, 1
    s_cselect_b32 s35, s57, 384
    s_cselect_b32 s34, 384, s57
    s_branch L_is4
.p2align 12
L_pg4:
    s_setpc_b64 s[62:63]
L_is4:
    s_cselect_b32 s46, s50, s51
    s_cselect_b32 s47, s51, s50
    s_mul_i32 s34, s34, s56
    s_lshl_b32 s57, s32, 3
    s_lshr_b32 s58, 0x00804000, s57
    s_and_b32 s43, s58, 0xff
    s_lshr_b32 s58, 0x40008040, s57
    s_and_b32 s44, s58, 0xff
    s_lshr_b32 s58, 0x80400080, s57
    s_and_b32 s45, s58, 0xff
    s_and_b32 s50, s36, 1
    s_lshr_b32 s51, s36, 1
    v_and_b32 v108, 15, v0
    v_lshrrev_b32 v109, 4, v0
    v_lshrrev_b32 v110, 2, v108
    v_and_b32 v111, 3, v0
    v_lshl_add_u32 v112, v109, 3, v110
    v_mul_u32_u24 v112, 192, v112
    v_lshl_add_u32 v112, v111, 3, v112
    v_and_b32 v113, 1, v109
    v_xor_b32 v113, s51, v113
    v_lshl_add_u32 v112, v113, 5, v112
    v_lshlrev_b32 v113, 4, v0
    s_lshl_b32 s58, s51, 10
    v_add_u32 v113, s58, v113
    v_add_u32 v3, s43, v112
    v_add_u32 v6, 61440, v3
    s_lshl_b32 s58, s43, 5
    v_add_u32 v9, s58, v113
    v_add_u32 v12, 61440, v9
    v_add_u32 v4, s44, v112
    v_add_u32 v7, 61440, v4
    s_lshl_b32 s58, s44, 5
    v_add_u32 v10, s58, v113
    v_add_u32 v13, 61440, v10
    v_add_u32 v5, s45, v112
    v_add_u32 v8, 61440, v5
    s_lshl_b32 s58, s45, 5
    v_add_u32 v11, s58, v113
    v_add_u32 v14, 61440, v11
    v_bfe_u32 v112, v108, 1, 2
    v_xor_b32 v112, v112, v109
    v_lshlrev_b32 v112, 4, v112
    v_and_b32 v113, 7, v108
    v_lshl_add_u32 v112, v113, 6, v112
    v_lshrrev_b32 v114, 3, v108
    v_mul_u32_u24 v114, 3072, v114
    s_mul_i32 s58, s50, 1536
    s_add_u32 s58, s58, 92160
    v_add3_u32 v1, v112, v114, s58
    v_xor_b32 v25, 32, v1
    v_lshrrev_b32 v112, 1, v109
    s_lshl_b32 s58, s51, 1
    v_add_u32 v112, s58, v112
    v_bfe_u32 v115, v108, 1, 2
    v_xor_b32 v112, v112, v115
    v_lshlrev_b32 v112, 4, v112
    v_lshl_add_u32 v112, v113, 6, v112
    v_lshl_add_u32 v112, v114, 1, v112
    v_and_b32 v113, 1, v109
    v_lshl_add_u32 v112, v113, 3, v112
    s_mul_i32 s58, s50, 3072
    s_add_u32 s58, s58, 133120
    v_add_u32 v15, s58, v112
    s_sub_u32 s59, 1, s39
    s_mul_i32 s59, s59, 6
    v_and_b32 v112, 1, v0
    v_add_u32 v112, s59, v112
    v_lshrrev_b32 v113, 1, v112
    v_xor_b32 v113, v113, v109
    v_and_b32 v114, 2, v0
    v_xor_b32 v113, v113, v114
    v_lshlrev_b32 v113, 4, v113
    v_lshl_add_u32 v113, v112, 6, v113
    v_lshrrev_b32 v114, 2, v108
    v_and_b32 v114, 2, v114
    v_xor_b32 v114, v114, v115
    v_lshl_add_u32 v113, v114, 9, v113
    v_add_u32 v2, 98304, v113
    s_cmp_eq_u32 s32, 3
    s_cselect_b32 s58, 0, 8
    v_cmp_gt_u32 vcc, s58, v108
    v_mov_b32 v116, 0x100000
    s_nop 0
    v_cndmask_b32 v2, v116, v2, vcc
    v_xor_b32 v26, 32, v2
    s_lshl_b32 s58, s51, 11
    s_add_u32 s58, s58, 157696
    v_and_b32 v112, 1, v0
    v_lshl_add_u32 v112, v114, 1, v112
    v_lshl_add_u32 v112, v109, 3, v112
    v_lshl_add_u32 v16, v112, 4, s58
    v_mov_b32 v116, 161792
    v_cndmask_b32 v16, v116, v16, vcc
    s_lshl_b32 s46, s43, 5
    s_setprio 2
    s_cmp_eq_u32 s50, 1
    s_cbranch_scc1 L_c1
    s_mov_b32 s47, 0x3f160000
    s_mov_b32 s48, 0x3f779498
    s_mov_b32 s49, 0xbecbe3c8
    s_mov_b32 s56, 0x3f03c3c4
    s_mov_b32 s57, 0xbf4ccccd
    s_mov_b32 s58, 0x3f200000
    s_cmp_lg_u32 s36, 0
    s_cbranch_scc1 L_notouch
    s_call_b64 s[62:63], L_pg1
    s_call_b64 s[62:63], L_pg2
    s_call_b64 s[62:63], L_pg3
    s_call_b64 s[62:63], L_pg4
    s_call_b64 s[62:63], L_pg5
    s_call_b64 s[62:63], L_pg6
    s_call_b64 s[62:63], L_pg7
    s_call_b64 s[62:63], L_pg8
    s_call_b64 s[62:63], L_pg9
    s_call_b64 s[62:63], L_pg10
    s_nop 0
    s_nop 0
L_notouch:
    v_mov_b32 v21, 1
    s_waitcnt vmcnt(0)
    buffer_atomic_add v21, v18, s[28:31], 0 offen sc0 sc1
    v_lshrrev_b32 v18, 4, v18
    v_add_u32 v18, 128, v18
    v_bfrev_b32 v20, 2
    s_barrier
    ds_read_b64_tr_b16 v[108:109], v3 offset:0
    ds_read_b64_tr_b16 v[110:111], v3 offset:768
    ds_read_b128 v[112:115], v1 offset:0
    ds_read_b64_tr_b16 v[116:117], v3 offset:6144
    ds_read_b64_tr_b16 v[118:119], v3 offset:6912
    ds_read_b128 v[120:123], v25 offset:512
    ds_read_b64_tr_b16 v[124:125], v3 offset:12288
    ds_read_b64_tr_b16 v[126:127], v3 offset:13056
    ds_read_b128 v[128:131], v1 offset:1024
    ds_read_b64_tr_b16 v[132:133], v3 offset:18432
    ds_read_b64_tr_b16 v[134:135], v3 offset:19200
    ds_read_b128 v[136:139], v25 offset:1536
    ds_read_b64_tr_b16 v[140:141], v3 offset:24576
    ds_read_b64_tr_b16 v[142:143], v3 offset:25344
    ds_read_b128 v[144:147], v1 offset:2048
    s_waitcnt lgkmcnt(12)
    v_mfma_f32_16x16x32_bf16 v[28:31], v[108:111], v[112:115], 0
    ds_read_b128 v[148:151], v25 offset:2560
    ds_read_b128 v[152:155], v2 offset:0
    s_waitcnt lgkmcnt(11)
    v_mfma_f32_16x16x32_bf16 v[28:31], v[116:119], v[120:123], v[28:31]
    ds_read_b128 v[156:159], v26 offset:512
    ds_read_b128 v[160:163], v2 offset:1024
    s_waitcnt lgkmcnt(10)
    v_mfma_f32_16x16x32_bf16 v[28:31], v[124:127], v[128:131], v[28:31]
    ds_read_b128 v[164:167], v1 offset:3072
    s_waitcnt lgkmcnt(8)
    v_mfma_f32_16x16x32_bf16 v[28:31], v[132:135], v[136:139], v[28:31]
    ds_read_b64_tr_b16 v[168:169], v4 offset:0
    s_waitcnt lgkmcnt(6)
    v_mfma_f32_16x16x32_bf16 v[28:31], v[140:143], v[144:147], v[28:31]
    ds_read_b64_tr_b16 v[170:171], v4 offset:768
    v_mfma_f32_16x16x32_bf16 v[32:35], v[108:111], v[120:123], 0
    ds_read_b64_tr_b16 v[172:173], v4 offset:6144
    v_mfma_f32_16x16x32_bf16 v[32:35], v[116:119], v[128:131], v[32:35]
    ds_read_b64_tr_b16 v[174:175], v4 offset:6912
    v_mfma_f32_16x16x32_bf16 v[32:35], v[124:127], v[136:139], v[32:35]
    ds_read_b64_tr_b16 v[176:177], v4 offset:12288
    v_mfma_f32_16x16x32_bf16 v[32:35], v[132:135], v[144:147], v[32:35]
    ds_read_b64_tr_b16 v[178:179], v4 offset:13056
    s_waitcnt lgkmcnt(9)
    v_mfma_f32_16x16x32_bf16 v[32:35], v[140:143], v[148:151], v[32:35]
    ds_read_b64_tr_b16 v[180:181], v4 offset:18432
    ds_read_b64_tr_b16 v[182:183], v4 offset:19200
    v_mfma_f32_16x16x32_bf16 v[100:103], v[108:111], v[152:155], 0
    ds_read_b64_tr_b16 v[184:185], v4 offset:24576
    ds_read_b64_tr_b16 v[186:187], v4 offset:25344
    s_waitcnt lgkmcnt(10)
    v_mfma_f32_16x16x32_bf16 v[100:103], v[116:119], v[156:159], v[100:103]
    ds_read_b64_tr_b16 v[188:189], v5 offset:0
    ds_read_b64_tr_b16 v[190:191], v5 offset:768
    v_mfma_f32_16x16x32_bf16 v[100:103], v[124:127], v[160:163], v[100:103]
    ds_read_b64_tr_b16 v[192:193], v5 offset:6144
    ds_read_b64_tr_b16 v[194:195], v5 offset:6912
    v_mfma_f32_16x16x32_bf16 v[36:39], v[108:111], v[128:131], 0
    ds_read_b64_tr_b16 v[196:197], v5 offset:12288
    ds_read_b64_tr_b16 v[198:199], v5 offset:13056
    v_mfma_f32_16x16x32_bf16 v[36:39], v[116:119], v[136:139], v[36:39]
    ds_read_b64_tr_b16 v[200:201], v5 offset:18432
    ds_read_b64_tr_b16 v[202:203], v5 offset:19200
    v_mfma_f32_16x16x32_bf16 v[36:39], v[124:127], v[144:147], v[36:39]
    ds_read_b64_tr_b16 v[204:205], v5 offset:24576
    ds_read_b64_tr_b16 v[206:207], v5 offset:25344
    v_mfma_f32_16x16x32_bf16 v[36:39], v[132:135], v[148:151], v[36:39]
    v_mfma_f32_16x16x32_bf16 v[36:39], v[140:143], v[164:167], v[36:39]
    s_waitcnt lgkmcnt(12)
    v_mfma_f32_16x16x32_bf16 v[40:43], v[168:171], v[112:115], 0
    v_mfma_f32_16x16x32_bf16 v[40:43], v[172:175], v[120:123], v[40:43]
    v_mfma_f32_16x16x32_bf16 v[40:43], v[176:179], v[128:131], v[40:43]
    s_waitcnt lgkmcnt(0)
    s_barrier
    v_mfma_f32_16x16x32_bf16 v[40:43], v[180:183], v[136:139], v[40:43]
    ds_read_b64_tr_b16 v[208:209], v3 offset:30720
    v_mfma_f32_16x16x32_bf16 v[40:43], v[184:187], v[144:147], v[40:43]
    ds_read_b64_tr_b16 v[210:211], v3 offset:31488
    v_mfma_f32_16x16x32_bf16 v[44:47], v[168:171], v[120:123], 0
    ds_read_b128 v[212:215], v1 offset:10240
    v_mfma_f32_16x16x32_bf16 v[44:47], v[172:175], v[128:131], v[44:47]
    ds_read_b64_tr_b16 v[216:217], v3 offset:36864
    v_mfma_f32_16x16x32_bf16 v[44:47], v[176:179], v[136:139], v[44:47]
    ds_read_b64_tr_b16 v[218:219], v3 offset:37632
    v_mfma_f32_16x16x32_bf16 v[44:47], v[180:183], v[144:147], v[44:47]
    ds_read_b128 v[220:223], v25 offset:10752
    v_mfma_f32_16x16x32_bf16 v[44:47], v[184:187], v[148:151], v[44:47]
    ds_read_b64_tr_b16 v[224:225], v3 offset:43008
    v_mfma_f32_16x16x32_bf16 v[48:51], v[168:171], v[128:131], 0
    ds_read_b64_tr_b16 v[226:227], v3 offset:43776
    v_mfma_f32_16x16x32_bf16 v[48:51], v[172:175], v[136:139], v[48:51]
    ds_read_b128 v[228:231], v1 offset:11264
    v_mfma_f32_16x16x32_bf16 v[48:51], v[176:179], v[144:147], v[48:51]
    ds_read_b64_tr_b16 v[232:233], v3 offset:49152
    v_mfma_f32_16x16x32_bf16 v[48:51], v[180:183], v[148:151], v[48:51]
    ds_read_b64_tr_b16 v[234:235], v3 offset:49920
    v_mfma_f32_16x16x32_bf16 v[48:51], v[184:187], v[164:167], v[48:51]
    ds_read_b128 v[236:239], v25 offset:11776
    v_mfma_f32_16x16x32_bf16 v[52:55], v[188:191], v[112:115], 0
    ds_read_b64_tr_b16 v[240:241], v3 offset:55296
    v_mfma_f32_16x16x32_bf16 v[52:55], v[192:195], v[120:123], v[52:55]
    ds_read_b64_tr_b16 v[242:243], v3 offset:56064
    v_mfma_f32_16x16x32_bf16 v[52:55], v[196:199], v[128:131], v[52:55]
    ds_read_b128 v[244:247], v1 offset:12288
    v_mfma_f32_16x16x32_bf16 v[52:55], v[200:203], v[136:139], v[52:55]
    ds_read_b128 v[248:251], v25 offset:12800
    v_mfma_f32_16x16x32_bf16 v[52:55], v[204:207], v[144:147], v[52:55]
    ds_read_b128 v[252:255], v2 offset:10240
    v_mfma_f32_16x16x32_bf16 v[56:59], v[188:191], v[120:123], 0
    ds_read_b128 v[152:155], v26 offset:10752
    v_mfma_f32_16x16x32_bf16 v[56:59], v[192:195], v[128:131], v[56:59]
    ds_read_b128 v[156:159], v1 offset:13312
    v_mfma_f32_16x16x32_bf16 v[56:59], v[196:199], v[136:139], v[56:59]
    ds_read_b64_tr_b16 v[160:161], v4 offset:30720
    v_mfma_f32_16x16x32_bf16 v[56:59], v[200:203], v[144:147], v[56:59]
    ds_read_b64_tr_b16 v[162:163], v4 offset:31488
    v_mfma_f32_16x16x32_bf16 v[56:59], v[204:207], v[148:151], v[56:59]
    ds_read_b64_tr_b16 v[108:109], v4 offset:36864
    v_mfma_f32_16x16x32_bf16 v[60:63], v[188:191], v[128:131], 0
    ds_read_b64_tr_b16 v[110:111], v4 offset:37632
    v_mfma_f32_16x16x32_bf16 v[60:63], v[192:195], v[136:139], v[60:63]
    ds_read_b64_tr_b16 v[116:117], v4 offset:43008
    v_mfma_f32_16x16x32_bf16 v[60:63], v[196:199], v[144:147], v[60:63]
    ds_read_b64_tr_b16 v[118:119], v4 offset:43776
    v_mfma_f32_16x16x32_bf16 v[60:63], v[200:203], v[148:151], v[60:63]
    ds_read_b64_tr_b16 v[124:125], v4 offset:49152
    v_mfma_f32_16x16x32_bf16 v[60:63], v[204:207], v[164:167], v[60:63]
    ds_read_b64_tr_b16 v[126:127], v4 offset:49920
    s_waitcnt lgkmcnt(8)
    v_mfma_f32_16x16x32_bf16 v[64:67], v[208:211], v[212:215], 0
    ds_read_b64_tr_b16 v[132:133], v4 offset:55296
    v_mfma_f32_16x16x32_bf16 v[64:67], v[216:219], v[220:223], v[64:67]
    ds_read_b64_tr_b16 v[134:135], v4 offset:56064
    v_mfma_f32_16x16x32_bf16 v[64:67], v[224:227], v[228:231], v[64:67]
    ds_read_b64_tr_b16 v[140:141], v5 offset:30720
    ds_read_b64_tr_b16 v[142:143], v5 offset:31488
    v_mfma_f32_16x16x32_bf16 v[64:67], v[232:235], v[236:239], v[64:67]
    ds_read_b64_tr_b16 v[168:169], v5 offset:36864
    ds_read_b64_tr_b16 v[170:171], v5 offset:37632
    v_mfma_f32_16x16x32_bf16 v[64:67], v[240:243], v[244:247], v[64:67]
    ds_read_b64_tr_b16 v[172:173], v5 offset:43008
    ds_read_b64_tr_b16 v[174:175], v5 offset:43776
    v_mfma_f32_16x16x32_bf16 v[68:71], v[208:211], v[220:223], 0
    ds_read_b64_tr_b16 v[176:177], v5 offset:49152
    ds_read_b64_tr_b16 v[178:179], v5 offset:49920
    v_mfma_f32_16x16x32_bf16 v[68:71], v[216:219], v[228:231], v[68:71]
    ds_read_b64_tr_b16 v[180:181], v5 offset:55296
    ds_read_b64_tr_b16 v[182:183], v5 offset:56064
    v_mfma_f32_16x16x32_bf16 v[68:71], v[224:227], v[236:239], v[68:71]
    v_mfma_f32_16x16x32_bf16 v[68:71], v[232:235], v[244:247], v[68:71]
    v_mfma_f32_16x16x32_bf16 v[68:71], v[240:243], v[248:251], v[68:71]
    v_mfma_f32_16x16x32_bf16 v[104:107], v[208:211], v[252:255], 0
    s_waitcnt vmcnt(0)
    v_cmp_eq_u32 vcc, 89, v21
    s_nop 1
    v_cndmask_b32 v18, v20, v18, vcc
    buffer_store_dword v19, v18, s[28:31], 0 offen sc1
    v_mfma_f32_16x16x32_bf16 v[104:107], v[216:219], v[152:155], v[104:107]
    v_mfma_f32_16x16x32_bf16 v[72:75], v[208:211], v[228:231], 0
    v_mfma_f32_16x16x32_bf16 v[72:75], v[216:219], v[236:239], v[72:75]
    s_waitcnt lgkmcnt(0)
    s_barrier
    v_mfma_f32_16x16x32_bf16 v[72:75], v[224:227], v[244:247], v[72:75]
    ds_read_b64_tr_b16 v[184:185], v6 offset:0
    v_mfma_f32_16x16x32_bf16 v[72:75], v[232:235], v[248:251], v[72:75]
    ds_read_b64_tr_b16 v[186:187], v6 offset:768
    v_mfma_f32_16x16x32_bf16 v[72:75], v[240:243], v[156:159], v[72:75]
    ds_read_b64_tr_b16 v[112:113], v6 offset:6144
    v_mfma_f32_16x16x32_bf16 v[76:79], v[160:163], v[212:215], 0
    ds_read_b128 v[120:123], v1 offset:20480
    v_mfma_f32_16x16x32_bf16 v[76:79], v[108:111], v[220:223], v[76:79]
    ds_read_b64_tr_b16 v[114:115], v6 offset:6912
    v_mfma_f32_16x16x32_bf16 v[76:79], v[116:119], v[228:231], v[76:79]
    ds_read_b128 v[128:131], v25 offset:20992
    v_mfma_f32_16x16x32_bf16 v[76:79], v[124:127], v[236:239], v[76:79]
    ds_read_b64_tr_b16 v[188:189], v6 offset:12288
    v_mfma_f32_16x16x32_bf16 v[76:79], v[132:135], v[244:247], v[76:79]
    ds_read_b64_tr_b16 v[190:191], v6 offset:13056
    v_mfma_f32_16x16x32_bf16 v[80:83], v[160:163], v[220:223], 0
    ds_read_b128 v[136:139], v1 offset:21504
    v_mfma_f32_16x16x32_bf16 v[80:83], v[108:111], v[228:231], v[80:83]
    ds_read_b64_tr_b16 v[192:193], v6 offset:18432
    v_mfma_f32_16x16x32_bf16 v[80:83], v[116:119], v[236:239], v[80:83]
    ds_read_b64_tr_b16 v[194:195], v6 offset:19200
    v_mfma_f32_16x16x32_bf16 v[80:83], v[124:127], v[244:247], v[80:83]
    ds_read_b128 v[144:147], v25 offset:22016
    v_mfma_f32_16x16x32_bf16 v[80:83], v[132:135], v[248:251], v[80:83]
    ds_read_b64_tr_b16 v[196:197], v6 offset:24576
    v_mfma_f32_16x16x32_bf16 v[84:87], v[160:163], v[228:231], 0
    ds_read_b64_tr_b16 v[198:199], v6 offset:25344
    v_mfma_f32_16x16x32_bf16 v[84:87], v[108:111], v[236:239], v[84:87]
    ds_read_b128 v[148:151], v1 offset:22528
    v_mfma_f32_16x16x32_bf16 v[84:87], v[116:119], v[244:247], v[84:87]
    ds_read_b128 v[200:203], v25 offset:23040
    v_mfma_f32_16x16x32_bf16 v[84:87], v[124:127], v[248:251], v[84:87]
    ds_read_b128 v[164:167], v2 offset:20480
    v_mfma_f32_16x16x32_bf16 v[84:87], v[132:135], v[156:159], v[84:87]
    ds_read_b128 v[204:207], v26 offset:20992
    v_mfma_f32_16x16x32_bf16 v[88:91], v[140:143], v[212:215], 0
    ds_read_b64_tr_b16 v[252:253], v7 offset:0
    v_mfma_f32_16x16x32_bf16 v[88:91], v[168:171], v[220:223], v[88:91]
    ds_read_b128 v[152:155], v1 offset:23552
    v_mfma_f32_16x16x32_bf16 v[88:91], v[172:175], v[228:231], v[88:91]
    ds_read_b64_tr_b16 v[254:255], v7 offset:768
    v_mfma_f32_16x16x32_bf16 v[88:91], v[176:179], v[236:239], v[88:91]
    ds_read_b64_tr_b16 v[208:209], v7 offset:6144
    v_mfma_f32_16x16x32_bf16 v[88:91], v[180:183], v[244:247], v[88:91]
    ds_read_b64_tr_b16 v[210:211], v7 offset:6912
    v_mfma_f32_16x16x32_bf16 v[92:95], v[140:143], v[220:223], 0
    ds_read_b64_tr_b16 v[216:217], v7 offset:12288
    v_mfma_f32_16x16x32_bf16 v[92:95], v[168:171], v[228:231], v[92:95]
    ds_read_b64_tr_b16 v[218:219], v7 offset:13056
    v_mfma_f32_16x16x32_bf16 v[92:95], v[172:175], v[236:239], v[92:95]
    ds_read_b64_tr_b16 v[224:225], v7 offset:18432
    v_mfma_f32_16x16x32_bf16 v[92:95], v[176:179], v[244:247], v[92:95]
    ds_read_b64_tr_b16 v[226:227], v7 offset:19200
    v_mfma_f32_16x16x32_bf16 v[92:95], v[180:183], v[248:251], v[92:95]
    ds_read_b64_tr_b16 v[232:233], v7 offset:24576
    v_mfma_f32_16x16x32_bf16 v[96:99], v[140:143], v[228:231], 0
    ds_read_b64_tr_b16 v[234:235], v7 offset:25344
    v_mfma_f32_16x16x32_bf16 v[96:99], v[168:171], v[236:239], v[96:99]
    ds_read_b64_tr_b16 v[240:241], v8 offset:0
    v_mfma_f32_16x16x32_bf16 v[96:99], v[172:175], v[244:247], v[96:99]
    ds_read_b64_tr_b16 v[242:243], v8 offset:768
    v_mfma_f32_16x16x32_bf16 v[96:99], v[176:179], v[248:251], v[96:99]
    ds_read_b64_tr_b16 v[160:161], v8 offset:6144
    v_mfma_f32_16x16x32_bf16 v[96:99], v[180:183], v[156:159], v[96:99]
    ds_read_b64_tr_b16 v[162:163], v8 offset:6912
    s_waitcnt lgkmcnt(8)
    v_mfma_f32_16x16x32_bf16 v[28:31], v[184:187], v[120:123], v[28:31]
    ds_read_b64_tr_b16 v[108:109], v8 offset:12288
    v_mfma_f32_16x16x32_bf16 v[28:31], v[112:115], v[128:131], v[28:31]
    ds_read_b64_tr_b16 v[110:111], v8 offset:13056
    v_mfma_f32_16x16x32_bf16 v[28:31], v[188:191], v[136:139], v[28:31]
    ds_read_b64_tr_b16 v[116:117], v8 offset:18432
    v_mfma_f32_16x16x32_bf16 v[28:31], v[192:195], v[144:147], v[28:31]
    ds_read_b64_tr_b16 v[118:119], v8 offset:19200
    ds_read_b64_tr_b16 v[124:125], v8 offset:24576
    v_mfma_f32_16x16x32_bf16 v[28:31], v[196:199], v[148:151], v[28:31]
    ds_read_b64_tr_b16 v[126:127], v8 offset:25344
    v_mfma_f32_16x16x32_bf16 v[32:35], v[184:187], v[128:131], v[32:35]
    v_mfma_f32_16x16x32_bf16 v[32:35], v[112:115], v[136:139], v[32:35]
    v_mfma_f32_16x16x32_bf16 v[32:35], v[188:191], v[144:147], v[32:35]
    v_mfma_f32_16x16x32_bf16 v[32:35], v[192:195], v[148:151], v[32:35]
    v_mfma_f32_16x16x32_bf16 v[32:35], v[196:199], v[200:203], v[32:35]
    v_mfma_f32_16x16x32_bf16 v[100:103], v[184:187], v[164:167], v[100:103]
    v_mfma_f32_16x16x32_bf16 v[100:103], v[112:115], v[204:207], v[100:103]
    v_mfma_f32_16x16x32_bf16 v[36:39], v[184:187], v[136:139], v[36:39]
    v_mfma_f32_16x16x32_bf16 v[36:39], v[112:115], v[144:147], v[36:39]
    v_mfma_f32_16x16x32_bf16 v[36:39], v[188:191], v[148:151], v[36:39]
    s_waitcnt lgkmcnt(0)
    s_barrier
    v_mfma_f32_16x16x32_bf16 v[36:39], v[192:195], v[200:203], v[36:39]
    v_mfma_f32_16x16x32_bf16 v[36:39], v[196:199], v[152:155], v[36:39]
    v_mfma_f32_16x16x32_bf16 v[40:43], v[252:255], v[120:123], v[40:43]
    v_mfma_f32_16x16x32_bf16 v[40:43], v[208:211], v[128:131], v[40:43]
    v_mfma_f32_16x16x32_bf16 v[40:43], v[216:219], v[136:139], v[40:43]
    v_mfma_f32_16x16x32_bf16 v[40:43], v[224:227], v[144:147], v[40:43]
    v_mfma_f32_16x16x32_bf16 v[40:43], v[232:235], v[148:151], v[40:43]
    ds_read_b64_tr_b16 v[132:133], v3 offset:0
    v_mfma_f32_16x16x32_bf16 v[44:47], v[252:255], v[128:131], v[44:47]
    ds_read_b64_tr_b16 v[134:135], v3 offset:768
    v_mfma_f32_16x16x32_bf16 v[44:47], v[208:211], v[136:139], v[44:47]
    ds_read_b128 v[212:215], v1 offset:30720
    v_mfma_f32_16x16x32_bf16 v[44:47], v[216:219], v[144:147], v[44:47]
    ds_read_b64_tr_b16 v[220:221], v3 offset:6144
    v_mfma_f32_16x16x32_bf16 v[44:47], v[224:227], v[148:151], v[44:47]
    ds_read_b64_tr_b16 v[222:223], v3 offset:6912
    v_mfma_f32_16x16x32_bf16 v[44:47], v[232:235], v[200:203], v[44:47]
    ds_read_b128 v[228:231], v25 offset:31232
    v_mfma_f32_16x16x32_bf16 v[48:51], v[252:255], v[136:139], v[48:51]
    ds_read_b64_tr_b16 v[140:141], v3 offset:12288
    v_mfma_f32_16x16x32_bf16 v[48:51], v[208:211], v[144:147], v[48:51]
    ds_read_b64_tr_b16 v[142:143], v3 offset:13056
    v_mfma_f32_16x16x32_bf16 v[48:51], v[216:219], v[148:151], v[48:51]
    ds_read_b128 v[236:239], v1 offset:31744
    v_mfma_f32_16x16x32_bf16 v[48:51], v[224:227], v[200:203], v[48:51]
    ds_read_b64_tr_b16 v[168:169], v3 offset:18432
    v_mfma_f32_16x16x32_bf16 v[48:51], v[232:235], v[152:155], v[48:51]
    ds_read_b64_tr_b16 v[170:171], v3 offset:19200
    v_mfma_f32_16x16x32_bf16 v[52:55], v[240:243], v[120:123], v[52:55]
    ds_read_b128 v[244:247], v25 offset:32256
    v_mfma_f32_16x16x32_bf16 v[52:55], v[160:163], v[128:131], v[52:55]
    ds_read_b64_tr_b16 v[172:173], v3 offset:24576
    v_mfma_f32_16x16x32_bf16 v[52:55], v[108:111], v[136:139], v[52:55]
    ds_read_b64_tr_b16 v[174:175], v3 offset:25344
    v_mfma_f32_16x16x32_bf16 v[52:55], v[116:119], v[144:147], v[52:55]
    ds_read_b128 v[248:251], v1 offset:32768
    v_mfma_f32_16x16x32_bf16 v[52:55], v[124:127], v[148:151], v[52:55]
    ds_read_b128 v[176:179], v25 offset:33280
    v_mfma_f32_16x16x32_bf16 v[56:59], v[240:243], v[128:131], v[56:59]
    ds_read_b128 v[156:159], v2 offset:30720
    v_mfma_f32_16x16x32_bf16 v[56:59], v[160:163], v[136:139], v[56:59]
    ds_read_b128 v[180:183], v26 offset:31232
    v_mfma_f32_16x16x32_bf16 v[56:59], v[108:111], v[144:147], v[56:59]
    ds_read_b128 v[164:167], v2 offset:31744
    v_mfma_f32_16x16x32_bf16 v[56:59], v[116:119], v[148:151], v[56:59]
    ds_read_b128 v[204:207], v1 offset:33792
    v_mfma_f32_16x16x32_bf16 v[56:59], v[124:127], v[200:203], v[56:59]
    ds_read_b64_tr_b16 v[184:185], v4 offset:0
    v_mfma_f32_16x16x32_bf16 v[60:63], v[240:243], v[136:139], v[60:63]
    ds_read_b64_tr_b16 v[186:187], v4 offset:768
    v_mfma_f32_16x16x32_bf16 v[60:63], v[160:163], v[144:147], v[60:63]
    ds_read_b64_tr_b16 v[112:113], v4 offset:6144
    v_mfma_f32_16x16x32_bf16 v[60:63], v[108:111], v[148:151], v[60:63]
    ds_read_b64_tr_b16 v[114:115], v4 offset:6912
    v_mfma_f32_16x16x32_bf16 v[60:63], v[116:119], v[200:203], v[60:63]
    ds_read_b64_tr_b16 v[188:189], v4 offset:12288
    v_mfma_f32_16x16x32_bf16 v[60:63], v[124:127], v[152:155], v[60:63]
    ds_read_b64_tr_b16 v[190:191], v4 offset:13056
    s_waitcnt lgkmcnt(8)
    v_mfma_f32_16x16x32_bf16 v[64:67], v[132:135], v[212:215], v[64:67]
    ds_read_b64_tr_b16 v[192:193], v4 offset:18432
    v_mfma_f32_16x16x32_bf16 v[64:67], v[220:223], v[228:231], v[64:67]
    ds_read_b64_tr_b16 v[194:195], v4 offset:19200
    v_mfma_f32_16x16x32_bf16 v[64:67], v[140:143], v[236:239], v[64:67]
    ds_read_b64_tr_b16 v[196:197], v4 offset:24576
    v_mfma_f32_16x16x32_bf16 v[64:67], v[168:171], v[244:247], v[64:67]
    ds_read_b64_tr_b16 v[198:199], v4 offset:25344
    ds_read_b64_tr_b16 v[252:253], v5 offset:0
    v_mfma_f32_16x16x32_bf16 v[64:67], v[172:175], v[248:251], v[64:67]
    ds_read_b64_tr_b16 v[254:255], v5 offset:768
    ds_read_b64_tr_b16 v[208:209], v5 offset:6144
    v_mfma_f32_16x16x32_bf16 v[68:71], v[132:135], v[228:231], v[68:71]
    ds_read_b64_tr_b16 v[210:211], v5 offset:6912
    ds_read_b64_tr_b16 v[216:217], v5 offset:12288
    v_mfma_f32_16x16x32_bf16 v[68:71], v[220:223], v[236:239], v[68:71]
    ds_read_b64_tr_b16 v[218:219], v5 offset:13056
    ds_read_b64_tr_b16 v[224:225], v5 offset:18432
    v_mfma_f32_16x16x32_bf16 v[68:71], v[140:143], v[244:247], v[68:71]
    ds_read_b64_tr_b16 v[226:227], v5 offset:19200
    ds_read_b64_tr_b16 v[232:233], v5 offset:24576
    v_mfma_f32_16x16x32_bf16 v[68:71], v[168:171], v[248:251], v[68:71]
    ds_read_b64_tr_b16 v[234:235], v5 offset:25344
    v_mfma_f32_16x16x32_bf16 v[68:71], v[172:175], v[176:179], v[68:71]
    v_mfma_f32_16x16x32_bf16 v[104:107], v[132:135], v[156:159], v[104:107]
    v_mfma_f32_16x16x32_bf16 v[104:107], v[220:223], v[180:183], v[104:107]
    s_waitcnt lgkmcnt(9)
    v_mfma_f32_16x16x32_bf16 v[104:107], v[140:143], v[164:167], v[104:107]
    v_mfma_f32_16x16x32_bf16 v[72:75], v[132:135], v[236:239], v[72:75]
    v_mfma_f32_16x16x32_bf16 v[72:75], v[220:223], v[244:247], v[72:75]
    s_waitcnt lgkmcnt(0)
    s_barrier
    v_mfma_f32_16x16x32_bf16 v[72:75], v[140:143], v[248:251], v[72:75]
    v_mfma_f32_16x16x32_bf16 v[72:75], v[168:171], v[176:179], v[72:75]
    v_mfma_f32_16x16x32_bf16 v[72:75], v[172:175], v[204:207], v[72:75]
    v_mfma_f32_16x16x32_bf16 v[76:79], v[184:187], v[212:215], v[76:79]
    v_mfma_f32_16x16x32_bf16 v[76:79], v[112:115], v[228:231], v[76:79]
    v_mfma_f32_16x16x32_bf16 v[76:79], v[188:191], v[236:239], v[76:79]
    v_mfma_f32_16x16x32_bf16 v[76:79], v[192:195], v[244:247], v[76:79]
    ds_read_b64_tr_b16 v[120:121], v3 offset:30720
    v_mfma_f32_16x16x32_bf16 v[76:79], v[196:199], v[248:251], v[76:79]
    ds_read_b64_tr_b16 v[122:123], v3 offset:31488
    v_mfma_f32_16x16x32_bf16 v[80:83], v[184:187], v[228:231], v[80:83]
    ds_read_b128 v[128:131], v1 offset:0
    v_mfma_f32_16x16x32_bf16 v[80:83], v[112:115], v[236:239], v[80:83]
    ds_read_b64_tr_b16 v[136:137], v3 offset:36864
    v_mfma_f32_16x16x32_bf16 v[80:83], v[188:191], v[244:247], v[80:83]
    ds_read_b64_tr_b16 v[138:139], v3 offset:37632
    v_mfma_f32_16x16x32_bf16 v[80:83], v[192:195], v[248:251], v[80:83]
    ds_read_b128 v[240:243], v25 offset:512
    v_mfma_f32_16x16x32_bf16 v[80:83], v[196:199], v[176:179], v[80:83]
    ds_read_b64_tr_b16 v[144:145], v3 offset:43008
    v_mfma_f32_16x16x32_bf16 v[84:87], v[184:187], v[236:239], v[84:87]
    ds_read_b64_tr_b16 v[146:147], v3 offset:43776
    v_mfma_f32_16x16x32_bf16 v[84:87], v[112:115], v[244:247], v[84:87]
    ds_read_b128 v[160:163], v1 offset:1024
    v_mfma_f32_16x16x32_bf16 v[84:87], v[188:191], v[248:251], v[84:87]
    ds_read_b64_tr_b16 v[148:149], v3 offset:49152
    v_mfma_f32_16x16x32_bf16 v[84:87], v[192:195], v[176:179], v[84:87]
    ds_read_b64_tr_b16 v[150:151], v3 offset:49920
    v_mfma_f32_16x16x32_bf16 v[84:87], v[196:199], v[204:207], v[84:87]
    ds_read_b128 v[108:111], v25 offset:1536
    v_mfma_f32_16x16x32_bf16 v[88:91], v[252:255], v[212:215], v[88:91]
    ds_read_b64_tr_b16 v[200:201], v3 offset:55296
    v_mfma_f32_16x16x32_bf16 v[88:91], v[208:211], v[228:231], v[88:91]
    ds_read_b64_tr_b16 v[202:203], v3 offset:56064
    v_mfma_f32_16x16x32_bf16 v[88:91], v[216:219], v[236:239], v[88:91]
    ds_read_b128 v[116:119], v1 offset:2048
    v_mfma_f32_16x16x32_bf16 v[88:91], v[224:227], v[244:247], v[88:91]
    ds_read_b128 v[152:155], v25 offset:2560
    v_mfma_f32_16x16x32_bf16 v[88:91], v[232:235], v[248:251], v[88:91]
    ds_read_b128 v[124:127], v2 offset:0
    v_mfma_f32_16x16x32_bf16 v[92:95], v[252:255], v[228:231], v[92:95]
    ds_read_b128 v[156:159], v26 offset:512
    v_mfma_f32_16x16x32_bf16 v[92:95], v[208:211], v[236:239], v[92:95]
    ds_read_b128 v[180:183], v2 offset:1024
    v_mfma_f32_16x16x32_bf16 v[92:95], v[216:219], v[244:247], v[92:95]
    ds_read_b128 v[164:167], v1 offset:3072
    v_mfma_f32_16x16x32_bf16 v[92:95], v[224:227], v[248:251], v[92:95]
    ds_read_b64_tr_b16 v[132:133], v4 offset:30720
    v_mfma_f32_16x16x32_bf16 v[92:95], v[232:235], v[176:179], v[92:95]
    ds_read_b64_tr_b16 v[134:135], v4 offset:31488
    v_mfma_f32_16x16x32_bf16 v[96:99], v[252:255], v[236:239], v[96:99]
    ds_read_b64_tr_b16 v[220:221], v4 offset:36864
    v_mfma_f32_16x16x32_bf16 v[96:99], v[208:211], v[244:247], v[96:99]
    ds_read_b64_tr_b16 v[222:223], v4 offset:37632
    v_mfma_f32_16x16x32_bf16 v[96:99], v[216:219], v[248:251], v[96:99]
    ds_read_b64_tr_b16 v[140:141], v4 offset:43008
    v_mfma_f32_16x16x32_bf16 v[96:99], v[224:227], v[176:179], v[96:99]
    ds_read_b64_tr_b16 v[142:143], v4 offset:43776
    v_mfma_f32_16x16x32_bf16 v[96:99], v[232:235], v[204:207], v[96:99]
    ds_read_b64_tr_b16 v[168:169], v4 offset:49152
    s_waitcnt lgkmcnt(8)
    v_mfma_f32_16x16x32_bf16 v[28:31], v[120:123], v[128:131], v[28:31]
    ds_read_b64_tr_b16 v[170:171], v4 offset:49920
    v_mfma_f32_16x16x32_bf16 v[28:31], v[136:139], v[240:243], v[28:31]
    ds_read_b64_tr_b16 v[172:173], v4 offset:55296
    v_mfma_f32_16x16x32_bf16 v[28:31], v[144:147], v[160:163], v[28:31]
    ds_read_b64_tr_b16 v[174:175], v4 offset:56064
    v_mfma_f32_16x16x32_bf16 v[28:31], v[148:151], v[108:111], v[28:31]
    ds_read_b64_tr_b16 v[184:185], v5 offset:30720
    ds_read_b64_tr_b16 v[186:187], v5 offset:31488
    v_mfma_f32_16x16x32_bf16 v[28:31], v[200:203], v[116:119], v[28:31]
    ds_read_b64_tr_b16 v[112:113], v5 offset:36864
    ds_read_b64_tr_b16 v[114:115], v5 offset:37632
    v_mfma_f32_16x16x32_bf16 v[32:35], v[120:123], v[240:243], v[32:35]
    ds_read_b64_tr_b16 v[188:189], v5 offset:43008
    ds_read_b64_tr_b16 v[190:191], v5 offset:43776
    v_mfma_f32_16x16x32_bf16 v[32:35], v[136:139], v[160:163], v[32:35]
    ds_read_b64_tr_b16 v[192:193], v5 offset:49152
    ds_read_b64_tr_b16 v[194:195], v5 offset:49920
    v_mfma_f32_16x16x32_bf16 v[32:35], v[144:147], v[108:111], v[32:35]
    ds_read_b64_tr_b16 v[196:197], v5 offset:55296
    ds_read_b64_tr_b16 v[198:199], v5 offset:56064
    v_mfma_f32_16x16x32_bf16 v[32:35], v[148:151], v[116:119], v[32:35]
    v_mfma_f32_16x16x32_bf16 v[32:35], v[200:203], v[152:155], v[32:35]
    v_mfma_f32_16x16x32_bf16 v[100:103], v[120:123], v[124:127], v[100:103]
    v_mfma_f32_16x16x32_bf16 v[100:103], v[136:139], v[156:159], v[100:103]
    v_mfma_f32_16x16x32_bf16 v[100:103], v[144:147], v[180:183], v[100:103]
    v_mfma_f32_16x16x32_bf16 v[36:39], v[120:123], v[160:163], v[36:39]
    v_mfma_f32_16x16x32_bf16 v[36:39], v[136:139], v[108:111], v[36:39]
    s_waitcnt lgkmcnt(0)
    s_barrier
    v_mfma_f32_16x16x32_bf16 v[36:39], v[144:147], v[116:119], v[36:39]
    v_mfma_f32_16x16x32_bf16 v[36:39], v[148:151], v[152:155], v[36:39]
    v_mfma_f32_16x16x32_bf16 v[36:39], v[200:203], v[164:167], v[36:39]
    v_mfma_f32_16x16x32_bf16 v[40:43], v[132:135], v[128:131], v[40:43]
    v_mfma_f32_16x16x32_bf16 v[40:43], v[220:223], v[240:243], v[40:43]
    v_mfma_f32_16x16x32_bf16 v[40:43], v[140:143], v[160:163], v[40:43]
    v_mfma_f32_16x16x32_bf16 v[40:43], v[168:171], v[108:111], v[40:43]
    s_branch L_is5
.p2align 12
L_pg5:
    s_setpc_b64 s[62:63]
L_is5:
    ds_read_b64_tr_b16 v[212:213], v6 offset:0
    v_mfma_f32_16x16x32_bf16 v[40:43], v[172:175], v[116:119], v[40:43]
    ds_read_b64_tr_b16 v[214:215], v6 offset:768
    v_mfma_f32_16x16x32_bf16 v[44:47], v[132:135], v[240:243], v[44:47]
    ds_read_b128 v[228:231], v1 offset:10240
    v_mfma_f32_16x16x32_bf16 v[44:47], v[220:223], v[160:163], v[44:47]
    ds_read_b64_tr_b16 v[236:237], v6 offset:6144
    v_mfma_f32_16x16x32_bf16 v[44:47], v[140:143], v[108:111], v[44:47]
    ds_read_b64_tr_b16 v[238:239], v6 offset:6912
    v_mfma_f32_16x16x32_bf16 v[44:47], v[168:171], v[116:119], v[44:47]
    ds_read_b128 v[252:255], v25 offset:10752
    v_mfma_f32_16x16x32_bf16 v[44:47], v[172:175], v[152:155], v[44:47]
    ds_read_b64_tr_b16 v[244:245], v6 offset:12288
    v_mfma_f32_16x16x32_bf16 v[48:51], v[132:135], v[160:163], v[48:51]
    ds_read_b64_tr_b16 v[246:247], v6 offset:13056
    v_mfma_f32_16x16x32_bf16 v[48:51], v[220:223], v[108:111], v[48:51]
    ds_read_b128 v[208:211], v1 offset:11264
    v_mfma_f32_16x16x32_bf16 v[48:51], v[140:143], v[116:119], v[48:51]
    ds_read_b64_tr_b16 v[248:249], v6 offset:18432
    v_mfma_f32_16x16x32_bf16 v[48:51], v[168:171], v[152:155], v[48:51]
    ds_read_b64_tr_b16 v[250:251], v6 offset:19200
    v_mfma_f32_16x16x32_bf16 v[48:51], v[172:175], v[164:167], v[48:51]
    ds_read_b128 v[216:219], v25 offset:11776
    v_mfma_f32_16x16x32_bf16 v[52:55], v[184:187], v[128:131], v[52:55]
    ds_read_b64_tr_b16 v[176:177], v6 offset:24576
    v_mfma_f32_16x16x32_bf16 v[52:55], v[112:115], v[240:243], v[52:55]
    ds_read_b64_tr_b16 v[178:179], v6 offset:25344
    v_mfma_f32_16x16x32_bf16 v[52:55], v[188:191], v[160:163], v[52:55]
    ds_read_b128 v[224:227], v1 offset:12288
    v_mfma_f32_16x16x32_bf16 v[52:55], v[192:195], v[108:111], v[52:55]
    ds_read_b128 v[204:207], v25 offset:12800
    v_mfma_f32_16x16x32_bf16 v[52:55], v[196:199], v[116:119], v[52:55]
    ds_read_b128 v[232:235], v2 offset:10240
    v_mfma_f32_16x16x32_bf16 v[56:59], v[184:187], v[240:243], v[56:59]
    ds_read_b128 v[124:127], v26 offset:10752
    v_mfma_f32_16x16x32_bf16 v[56:59], v[112:115], v[160:163], v[56:59]
    ds_read_b128 v[156:159], v1 offset:13312
    v_mfma_f32_16x16x32_bf16 v[56:59], v[188:191], v[108:111], v[56:59]
    ds_read_b64_tr_b16 v[180:181], v7 offset:0
    v_mfma_f32_16x16x32_bf16 v[56:59], v[192:195], v[116:119], v[56:59]
    ds_read_b64_tr_b16 v[182:183], v7 offset:768
    v_mfma_f32_16x16x32_bf16 v[56:59], v[196:199], v[152:155], v[56:59]
    ds_read_b64_tr_b16 v[120:121], v7 offset:6144
    v_mfma_f32_16x16x32_bf16 v[60:63], v[184:187], v[160:163], v[60:63]
    ds_read_b64_tr_b16 v[122:123], v7 offset:6912
    v_mfma_f32_16x16x32_bf16 v[60:63], v[112:115], v[108:111], v[60:63]
    ds_read_b64_tr_b16 v[136:137], v7 offset:12288
    v_mfma_f32_16x16x32_bf16 v[60:63], v[188:191], v[116:119], v[60:63]
    ds_read_b64_tr_b16 v[138:139], v7 offset:13056
    v_mfma_f32_16x16x32_bf16 v[60:63], v[192:195], v[152:155], v[60:63]
    ds_read_b64_tr_b16 v[144:145], v7 offset:18432
    v_mfma_f32_16x16x32_bf16 v[60:63], v[196:199], v[164:167], v[60:63]
    ds_read_b64_tr_b16 v[146:147], v7 offset:19200
    s_waitcnt lgkmcnt(8)
    v_mfma_f32_16x16x32_bf16 v[64:67], v[212:215], v[228:231], v[64:67]
    ds_read_b64_tr_b16 v[148:149], v7 offset:24576
    v_mfma_f32_16x16x32_bf16 v[64:67], v[236:239], v[252:255], v[64:67]
    ds_read_b64_tr_b16 v[150:151], v7 offset:25344
    v_mfma_f32_16x16x32_bf16 v[64:67], v[244:247], v[208:211], v[64:67]
    ds_read_b64_tr_b16 v[200:201], v8 offset:0
    ds_read_b64_tr_b16 v[202:203], v8 offset:768
    v_mfma_f32_16x16x32_bf16 v[64:67], v[248:251], v[216:219], v[64:67]
    ds_read_b64_tr_b16 v[132:133], v8 offset:6144
    ds_read_b64_tr_b16 v[134:135], v8 offset:6912
    v_mfma_f32_16x16x32_bf16 v[64:67], v[176:179], v[224:227], v[64:67]
    ds_read_b64_tr_b16 v[220:221], v8 offset:12288
    ds_read_b64_tr_b16 v[222:223], v8 offset:13056
    v_mfma_f32_16x16x32_bf16 v[68:71], v[212:215], v[252:255], v[68:71]
    ds_read_b64_tr_b16 v[140:141], v8 offset:18432
    ds_read_b64_tr_b16 v[142:143], v8 offset:19200
    v_mfma_f32_16x16x32_bf16 v[68:71], v[236:239], v[208:211], v[68:71]
    ds_read_b64_tr_b16 v[168:169], v8 offset:24576
    ds_read_b64_tr_b16 v[170:171], v8 offset:25344
    v_mfma_f32_16x16x32_bf16 v[68:71], v[244:247], v[216:219], v[68:71]
    v_fmac_f32 v28, s47, v64
    v_fmac_f32 v29, s47, v65
    v_mfma_f32_16x16x32_bf16 v[68:71], v[248:251], v[224:227], v[68:71]
    v_fmac_f32 v30, s47, v66
    v_fmac_f32 v31, s47, v67
    v_mfma_f32_16x16x32_bf16 v[68:71], v[176:179], v[204:207], v[68:71]
    v_fmamk_f32 v64, v64, 0xbf960000, v28
    v_fmamk_f32 v65, v65, 0xbf960000, v29
    v_mfma_f32_16x16x32_bf16 v[104:107], v[212:215], v[232:235], v[104:107]
    v_fmamk_f32 v66, v66, 0xbf960000, v30
    v_fmamk_f32 v67, v67, 0xbf960000, v31
    v_mfma_f32_16x16x32_bf16 v[104:107], v[236:239], v[124:127], v[104:107]
    v_mfma_f32_16x16x32_bf16 v[72:75], v[212:215], v[208:211], v[72:75]
    v_mfma_f32_16x16x32_bf16 v[72:75], v[236:239], v[216:219], v[72:75]
    s_waitcnt lgkmcnt(0)
    s_barrier
    v_mfma_f32_16x16x32_bf16 v[72:75], v[244:247], v[224:227], v[72:75]
    v_fmac_f32 v32, s47, v68
    v_fmac_f32 v33, s47, v69
    v_mfma_f32_16x16x32_bf16 v[72:75], v[248:251], v[204:207], v[72:75]
    v_fmac_f32 v34, s47, v70
    v_fmac_f32 v35, s47, v71
    v_mfma_f32_16x16x32_bf16 v[72:75], v[176:179], v[156:159], v[72:75]
    v_fmamk_f32 v68, v68, 0xbf960000, v32
    v_fmamk_f32 v69, v69, 0xbf960000, v33
    v_mfma_f32_16x16x32_bf16 v[76:79], v[180:183], v[228:231], v[76:79]
    v_fmamk_f32 v70, v70, 0xbf960000, v34
    v_fmamk_f32 v71, v71, 0xbf960000, v35
    v_mfma_f32_16x16x32_bf16 v[76:79], v[120:123], v[252:255], v[76:79]
    v_fmac_f32 v100, s47, v104
    v_fmac_f32 v101, s47, v105
    v_mfma_f32_16x16x32_bf16 v[76:79], v[136:139], v[208:211], v[76:79]
    v_fmac_f32 v102, s47, v106
    v_fmac_f32 v103, s47, v107
    v_mfma_f32_16x16x32_bf16 v[76:79], v[144:147], v[216:219], v[76:79]
    v_fmamk_f32 v104, v104, 0xbf960000, v100
    v_fmamk_f32 v105, v105, 0xbf960000, v101
    v_mfma_f32_16x16x32_bf16 v[76:79], v[148:151], v[224:227], v[76:79]
    v_fmamk_f32 v106, v106, 0xbf960000, v102
    v_fmamk_f32 v107, v107, 0xbf960000, v103
    v_mfma_f32_16x16x32_bf16 v[80:83], v[180:183], v[252:255], v[80:83]
    v_fmac_f32 v36, s47, v72
    v_fmac_f32 v37, s47, v73
    v_mfma_f32_16x16x32_bf16 v[80:83], v[120:123], v[208:211], v[80:83]
    v_fmac_f32 v38, s47, v74
    v_fmac_f32 v39, s47, v75
    v_mfma_f32_16x16x32_bf16 v[80:83], v[136:139], v[216:219], v[80:83]
    v_fmamk_f32 v72, v72, 0xbf960000, v36
    v_fmamk_f32 v73, v73, 0xbf960000, v37
    v_mfma_f32_16x16x32_bf16 v[80:83], v[144:147], v[224:227], v[80:83]
    v_fmamk_f32 v74, v74, 0xbf960000, v38
    v_fmamk_f32 v75, v75, 0xbf960000, v39
    v_mfma_f32_16x16x32_bf16 v[80:83], v[148:151], v[204:207], v[80:83]
    ds_read_b128 v[172:175], v9 offset:0
    v_fmac_f32 v40, s47, v76
    v_mfma_f32_16x16x32_bf16 v[84:87], v[180:183], v[208:211], v[84:87]
    ds_read_b128 v[128:131], v1 offset:20480
    v_fmac_f32 v41, s47, v77
    v_mfma_f32_16x16x32_bf16 v[84:87], v[120:123], v[216:219], v[84:87]
    ds_read_b128 v[240:243], v9 offset:6144
    v_fmac_f32 v42, s47, v78
    v_mfma_f32_16x16x32_bf16 v[84:87], v[136:139], v[224:227], v[84:87]
    ds_read_b128 v[160:163], v25 offset:20992
    v_fmac_f32 v43, s47, v79
    v_mfma_f32_16x16x32_bf16 v[84:87], v[144:147], v[204:207], v[84:87]
    ds_read_b128 v[184:187], v9 offset:12288
    v_fmamk_f32 v76, v76, 0xbf960000, v40
    v_mfma_f32_16x16x32_bf16 v[84:87], v[148:151], v[156:159], v[84:87]
    ds_read_b128 v[108:111], v1 offset:21504
    v_fmamk_f32 v77, v77, 0xbf960000, v41
    v_mfma_f32_16x16x32_bf16 v[88:91], v[200:203], v[228:231], v[88:91]
    ds_read_b128 v[112:115], v9 offset:18432
    v_fmamk_f32 v78, v78, 0xbf960000, v42
    v_mfma_f32_16x16x32_bf16 v[88:91], v[132:135], v[252:255], v[88:91]
    ds_read_b128 v[116:119], v25 offset:22016
    v_fmamk_f32 v79, v79, 0xbf960000, v43
    v_mfma_f32_16x16x32_bf16 v[88:91], v[220:223], v[208:211], v[88:91]
    ds_read_b128 v[188:191], v9 offset:24576
    v_fmac_f32 v44, s47, v80
    v_mfma_f32_16x16x32_bf16 v[88:91], v[140:143], v[216:219], v[88:91]
    ds_read_b128 v[152:155], v1 offset:22528
    v_fmac_f32 v45, s47, v81
    v_mfma_f32_16x16x32_bf16 v[88:91], v[168:171], v[224:227], v[88:91]
    ds_read_b128 v[192:195], v25 offset:23040
    v_fmac_f32 v46, s47, v82
    v_mfma_f32_16x16x32_bf16 v[92:95], v[200:203], v[252:255], v[92:95]
    ds_read_b128 v[164:167], v2 offset:20480
    v_fmac_f32 v47, s47, v83
    v_mfma_f32_16x16x32_bf16 v[92:95], v[132:135], v[208:211], v[92:95]
    ds_read_b128 v[196:199], v26 offset:20992
    v_fmamk_f32 v80, v80, 0xbf960000, v44
    v_mfma_f32_16x16x32_bf16 v[92:95], v[220:223], v[216:219], v[92:95]
    ds_read_b128 v[232:235], v1 offset:23552
    v_fmamk_f32 v81, v81, 0xbf960000, v45
    v_mfma_f32_16x16x32_bf16 v[92:95], v[140:143], v[224:227], v[92:95]
    ds_read_b128 v[124:127], v10 offset:0
    v_fmamk_f32 v82, v82, 0xbf960000, v46
    v_mfma_f32_16x16x32_bf16 v[92:95], v[168:171], v[204:207], v[92:95]
    ds_read_b128 v[212:215], v10 offset:6144
    v_fmamk_f32 v83, v83, 0xbf960000, v47
    v_mfma_f32_16x16x32_bf16 v[96:99], v[200:203], v[208:211], v[96:99]
    ds_read_b128 v[236:239], v10 offset:12288
    v_fmac_f32 v48, s47, v84
    v_mfma_f32_16x16x32_bf16 v[96:99], v[132:135], v[216:219], v[96:99]
    ds_read_b128 v[244:247], v10 offset:18432
    v_fmac_f32 v49, s47, v85
    v_mfma_f32_16x16x32_bf16 v[96:99], v[220:223], v[224:227], v[96:99]
    ds_read_b128 v[248:251], v10 offset:24576
    v_fmac_f32 v50, s47, v86
    v_mfma_f32_16x16x32_bf16 v[96:99], v[140:143], v[204:207], v[96:99]
    ds_read_b128 v[176:179], v11 offset:0
    v_fmac_f32 v51, s47, v87
    v_mfma_f32_16x16x32_bf16 v[96:99], v[168:171], v[156:159], v[96:99]
    ds_read_b128 v[180:183], v11 offset:6144
    v_fmamk_f32 v84, v84, 0xbf960000, v48
    s_waitcnt lgkmcnt(8)
    v_mfma_f32_16x16x32_bf16 v[28:31], v[172:175], v[128:131], v[28:31]
    ds_read_b128 v[120:123], v11 offset:12288
    v_fmamk_f32 v85, v85, 0xbf960000, v49
    v_mfma_f32_16x16x32_bf16 v[28:31], v[240:243], v[160:163], v[28:31]
    ds_read_b128 v[136:139], v11 offset:18432
    v_fmamk_f32 v86, v86, 0xbf960000, v50
    v_mfma_f32_16x16x32_bf16 v[28:31], v[184:187], v[108:111], v[28:31]
    ds_read_b128 v[144:147], v11 offset:24576
    v_fmamk_f32 v87, v87, 0xbf960000, v51
    v_mfma_f32_16x16x32_bf16 v[28:31], v[112:115], v[116:119], v[28:31]
    v_fmac_f32 v52, s47, v88
    v_fmac_f32 v53, s47, v89
    v_mfma_f32_16x16x32_bf16 v[28:31], v[188:191], v[152:155], v[28:31]
    v_fmac_f32 v54, s47, v90
    v_fmac_f32 v55, s47, v91
    v_mfma_f32_16x16x32_bf16 v[32:35], v[172:175], v[160:163], v[32:35]
    v_fmamk_f32 v88, v88, 0xbf960000, v52
    v_fmamk_f32 v89, v89, 0xbf960000, v53
    v_mfma_f32_16x16x32_bf16 v[32:35], v[240:243], v[108:111], v[32:35]
    v_fmamk_f32 v90, v90, 0xbf960000, v54
    v_fmamk_f32 v91, v91, 0xbf960000, v55
    v_mfma_f32_16x16x32_bf16 v[32:35], v[184:187], v[116:119], v[32:35]
    v_fmac_f32 v56, s47, v92
    v_fmac_f32 v57, s47, v93
    v_mfma_f32_16x16x32_bf16 v[32:35], v[112:115], v[152:155], v[32:35]
    v_fmac_f32 v58, s47, v94
    v_fmac_f32 v59, s47, v95
    v_mfma_f32_16x16x32_bf16 v[32:35], v[188:191], v[192:195], v[32:35]
    v_fmamk_f32 v92, v92, 0xbf960000, v56
    v_fmamk_f32 v93, v93, 0xbf960000, v57
    v_mfma_f32_16x16x32_bf16 v[100:103], v[172:175], v[164:167], v[100:103]
    v_fmamk_f32 v94, v94, 0xbf960000, v58
    v_fmamk_f32 v95, v95, 0xbf960000, v59
    v_mfma_f32_16x16x32_bf16 v[100:103], v[240:243], v[196:199], v[100:103]
    v_fmac_f32 v60, s47, v96
    v_fmac_f32 v61, s47, v97
    v_mfma_f32_16x16x32_bf16 v[36:39], v[172:175], v[108:111], v[36:39]
    v_fmac_f32 v62, s47, v98
    v_fmac_f32 v63, s47, v99
    v_mfma_f32_16x16x32_bf16 v[36:39], v[240:243], v[116:119], v[36:39]
    v_fmamk_f32 v96, v96, 0xbf960000, v60
    v_fmamk_f32 v97, v97, 0xbf960000, v61
    v_mfma_f32_16x16x32_bf16 v[36:39], v[184:187], v[152:155], v[36:39]
    s_waitcnt lgkmcnt(0)
    s_barrier
    v_mfma_f32_16x16x32_bf16 v[36:39], v[112:115], v[192:195], v[36:39]
    v_fmamk_f32 v98, v98, 0xbf960000, v62
    v_fmamk_f32 v99, v99, 0xbf960000, v63
    v_mfma_f32_16x16x32_bf16 v[36:39], v[188:191], v[232:235], v[36:39]
    v_mfma_f32_16x16x32_bf16 v[40:43], v[124:127], v[128:131], v[40:43]
    v_mfma_f32_16x16x32_bf16 v[40:43], v[212:215], v[160:163], v[40:43]
    v_mfma_f32_16x16x32_bf16 v[40:43], v[236:239], v[108:111], v[40:43]
    v_mfma_f32_16x16x32_bf16 v[40:43], v[244:247], v[116:119], v[40:43]
    v_mfma_f32_16x16x32_bf16 v[40:43], v[248:251], v[152:155], v[40:43]
    v_mfma_f32_16x16x32_bf16 v[44:47], v[124:127], v[160:163], v[44:47]
    v_mfma_f32_16x16x32_bf16 v[44:47], v[212:215], v[108:111], v[44:47]
    v_mfma_f32_16x16x32_bf16 v[44:47], v[236:239], v[116:119], v[44:47]
    v_mfma_f32_16x16x32_bf16 v[44:47], v[244:247], v[152:155], v[44:47]
    v_mfma_f32_16x16x32_bf16 v[44:47], v[248:251], v[192:195], v[44:47]
    v_mfma_f32_16x16x32_bf16 v[48:51], v[124:127], v[108:111], v[48:51]
    ds_read_b128 v[148:151], v9 offset:30720
    v_mfma_f32_16x16x32_bf16 v[48:51], v[212:215], v[116:119], v[48:51]
    ds_read_b128 v[228:231], v1 offset:30720
    v_mfma_f32_16x16x32_bf16 v[48:51], v[236:239], v[152:155], v[48:51]
    ds_read_b128 v[252:255], v9 offset:36864
    v_mfma_f32_16x16x32_bf16 v[48:51], v[244:247], v[192:195], v[48:51]
    ds_read_b128 v[208:211], v25 offset:31232
    v_mfma_f32_16x16x32_bf16 v[48:51], v[248:251], v[232:235], v[48:51]
    ds_read_b128 v[200:203], v9 offset:43008
    v_mfma_f32_16x16x32_bf16 v[52:55], v[176:179], v[128:131], v[52:55]
    ds_read_b128 v[216:219], v1 offset:31744
    v_mfma_f32_16x16x32_bf16 v[52:55], v[180:183], v[160:163], v[52:55]
    ds_read_b128 v[132:135], v9 offset:49152
    v_mfma_f32_16x16x32_bf16 v[52:55], v[120:123], v[108:111], v[52:55]
    ds_read_b128 v[224:227], v25 offset:32256
    v_mfma_f32_16x16x32_bf16 v[52:55], v[136:139], v[116:119], v[52:55]
    ds_read_b128 v[220:223], v9 offset:55296
    v_mfma_f32_16x16x32_bf16 v[52:55], v[144:147], v[152:155], v[52:55]
    ds_read_b128 v[204:207], v1 offset:32768
    v_mfma_f32_16x16x32_bf16 v[56:59], v[176:179], v[160:163], v[56:59]
    ds_read_b128 v[140:143], v25 offset:33280
    v_mfma_f32_16x16x32_bf16 v[56:59], v[180:183], v[108:111], v[56:59]
    ds_read_b128 v[156:159], v2 offset:30720
    v_mfma_f32_16x16x32_bf16 v[56:59], v[120:123], v[116:119], v[56:59]
    ds_read_b128 v[168:171], v26 offset:31232
    v_mfma_f32_16x16x32_bf16 v[56:59], v[136:139], v[152:155], v[56:59]
    ds_read_b128 v[164:167], v2 offset:31744
    v_mfma_f32_16x16x32_bf16 v[56:59], v[144:147], v[192:195], v[56:59]
    ds_read_b128 v[196:199], v1 offset:33792
    v_mfma_f32_16x16x32_bf16 v[60:63], v[176:179], v[108:111], v[60:63]
    ds_read_b128 v[172:175], v10 offset:30720
    v_mfma_f32_16x16x32_bf16 v[60:63], v[180:183], v[116:119], v[60:63]
    ds_read_b128 v[240:243], v10 offset:36864
    v_mfma_f32_16x16x32_bf16 v[60:63], v[120:123], v[152:155], v[60:63]
    ds_read_b128 v[184:187], v10 offset:43008
    v_mfma_f32_16x16x32_bf16 v[60:63], v[136:139], v[192:195], v[60:63]
    ds_read_b128 v[112:115], v10 offset:49152
    v_mfma_f32_16x16x32_bf16 v[60:63], v[144:147], v[232:235], v[60:63]
    ds_read_b128 v[188:191], v10 offset:55296
    s_waitcnt lgkmcnt(8)
    v_mfma_f32_16x16x32_bf16 v[64:67], v[148:151], v[228:231], v[64:67]
    ds_read_b128 v[124:127], v11 offset:30720
    v_mfma_f32_16x16x32_bf16 v[64:67], v[252:255], v[208:211], v[64:67]
    ds_read_b128 v[212:215], v11 offset:36864
    v_mfma_f32_16x16x32_bf16 v[64:67], v[200:203], v[216:219], v[64:67]
    ds_read_b128 v[236:239], v11 offset:43008
    v_mfma_f32_16x16x32_bf16 v[64:67], v[132:135], v[224:227], v[64:67]
    ds_read_b128 v[244:247], v11 offset:49152
    ds_read_b128 v[248:251], v11 offset:55296
    v_mfma_f32_16x16x32_bf16 v[64:67], v[220:223], v[204:207], v[64:67]
    v_mfma_f32_16x16x32_bf16 v[68:71], v[148:151], v[208:211], v[68:71]
    v_mfma_f32_16x16x32_bf16 v[68:71], v[252:255], v[216:219], v[68:71]
    v_mfma_f32_16x16x32_bf16 v[68:71], v[200:203], v[224:227], v[68:71]
    v_mfma_f32_16x16x32_bf16 v[68:71], v[132:135], v[204:207], v[68:71]
    v_mfma_f32_16x16x32_bf16 v[68:71], v[220:223], v[140:143], v[68:71]
    v_mfma_f32_16x16x32_bf16 v[104:107], v[148:151], v[156:159], v[104:107]
    s_waitcnt lgkmcnt(2)
    v_mfma_f32_16x16x32_bf16 v[104:107], v[252:255], v[168:171], v[104:107]
    v_mfma_f32_16x16x32_bf16 v[104:107], v[200:203], v[164:167], v[104:107]
    v_mfma_f32_16x16x32_bf16 v[72:75], v[148:151], v[216:219], v[72:75]
    v_mfma_f32_16x16x32_bf16 v[72:75], v[252:255], v[224:227], v[72:75]
    s_waitcnt lgkmcnt(0)
    s_barrier
    v_mfma_f32_16x16x32_bf16 v[72:75], v[200:203], v[204:207], v[72:75]
    v_mfma_f32_16x16x32_bf16 v[72:75], v[132:135], v[140:143], v[72:75]
    v_mfma_f32_16x16x32_bf16 v[72:75], v[220:223], v[196:199], v[72:75]
    v_mfma_f32_16x16x32_bf16 v[76:79], v[172:175], v[228:231], v[76:79]
    v_mfma_f32_16x16x32_bf16 v[76:79], v[240:243], v[208:211], v[76:79]
    v_mfma_f32_16x16x32_bf16 v[76:79], v[184:187], v[216:219], v[76:79]
    v_mfma_f32_16x16x32_bf16 v[76:79], v[112:115], v[224:227], v[76:79]
    v_mfma_f32_16x16x32_bf16 v[76:79], v[188:191], v[204:207], v[76:79]
    v_mfma_f32_16x16x32_bf16 v[80:83], v[172:175], v[208:211], v[80:83]
    v_mfma_f32_16x16x32_bf16 v[80:83], v[240:243], v[216:219], v[80:83]
    v_mfma_f32_16x16x32_bf16 v[80:83], v[184:187], v[224:227], v[80:83]
    v_mfma_f32_16x16x32_bf16 v[80:83], v[112:115], v[204:207], v[80:83]
    v_mfma_f32_16x16x32_bf16 v[80:83], v[188:191], v[140:143], v[80:83]
    ds_read_b128 v[128:131], v12 offset:0
    v_mfma_f32_16x16x32_bf16 v[84:87], v[172:175], v[216:219], v[84:87]
    ds_read_b128 v[160:163], v1 offset:0
    v_mfma_f32_16x16x32_bf16 v[84:87], v[240:243], v[224:227], v[84:87]
    ds_read_b128 v[108:111], v12 offset:6144
    v_mfma_f32_16x16x32_bf16 v[84:87], v[184:187], v[204:207], v[84:87]
    ds_read_b128 v[176:179], v25 offset:512
    v_mfma_f32_16x16x32_bf16 v[84:87], v[112:115], v[140:143], v[84:87]
    ds_read_b128 v[116:119], v12 offset:12288
    v_mfma_f32_16x16x32_bf16 v[84:87], v[188:191], v[196:199], v[84:87]
    ds_read_b128 v[180:183], v1 offset:1024
    v_mfma_f32_16x16x32_bf16 v[88:91], v[124:127], v[228:231], v[88:91]
    ds_read_b128 v[152:155], v12 offset:18432
    v_mfma_f32_16x16x32_bf16 v[88:91], v[212:215], v[208:211], v[88:91]
    ds_read_b128 v[120:123], v25 offset:1536
    v_mfma_f32_16x16x32_bf16 v[88:91], v[236:239], v[216:219], v[88:91]
    ds_read_b128 v[192:195], v12 offset:24576
    v_mfma_f32_16x16x32_bf16 v[88:91], v[244:247], v[224:227], v[88:91]
    ds_read_b128 v[136:139], v1 offset:2048
    v_mfma_f32_16x16x32_bf16 v[88:91], v[248:251], v[204:207], v[88:91]
    ds_read_b128 v[232:235], v25 offset:2560
    v_mfma_f32_16x16x32_bf16 v[92:95], v[124:127], v[208:211], v[92:95]
    ds_read_b128 v[144:147], v2 offset:0
    v_mfma_f32_16x16x32_bf16 v[92:95], v[212:215], v[216:219], v[92:95]
    ds_read_b128 v[156:159], v26 offset:512
    v_mfma_f32_16x16x32_bf16 v[92:95], v[236:239], v[224:227], v[92:95]
    ds_read_b128 v[168:171], v2 offset:1024
    v_mfma_f32_16x16x32_bf16 v[92:95], v[244:247], v[204:207], v[92:95]
    ds_read_b128 v[164:167], v1 offset:3072
    v_mfma_f32_16x16x32_bf16 v[92:95], v[248:251], v[140:143], v[92:95]
    ds_read_b128 v[148:151], v13 offset:0
    v_mfma_f32_16x16x32_bf16 v[96:99], v[124:127], v[216:219], v[96:99]
    ds_read_b128 v[252:255], v13 offset:6144
    v_mfma_f32_16x16x32_bf16 v[96:99], v[212:215], v[224:227], v[96:99]
    ds_read_b128 v[200:203], v13 offset:12288
    v_subrev_u32 v3, s46, v9
    v_mfma_f32_16x16x32_bf16 v[96:99], v[236:239], v[204:207], v[96:99]
    ds_read_b128 v[132:135], v13 offset:18432
    v_subrev_u32 v6, s46, v12
    v_mfma_f32_16x16x32_bf16 v[96:99], v[244:247], v[140:143], v[96:99]
    ds_read_b128 v[220:223], v13 offset:24576
    v_mfma_f32_16x16x32_bf16 v[96:99], v[248:251], v[196:199], v[96:99]
    ds_read_b128 v[172:175], v14 offset:0
    s_waitcnt lgkmcnt(8)
    v_mfma_f32_16x16x32_bf16 v[28:31], v[128:131], v[160:163], v[28:31]
    ds_read_b128 v[240:243], v14 offset:6144
    v_mfma_f32_16x16x32_bf16 v[28:31], v[108:111], v[176:179], v[28:31]
    ds_read_b128 v[184:187], v14 offset:12288
    v_mfma_f32_16x16x32_bf16 v[28:31], v[116:119], v[180:183], v[28:31]
    ds_read_b128 v[112:115], v14 offset:18432
    v_mfma_f32_16x16x32_bf16 v[28:31], v[152:155], v[120:123], v[28:31]
    ds_read_b128 v[188:191], v14 offset:24576
    v_mfma_f32_16x16x32_bf16 v[28:31], v[192:195], v[136:139], v[28:31]
    v_mfma_f32_16x16x32_bf16 v[32:35], v[128:131], v[176:179], v[32:35]
    v_mfma_f32_16x16x32_bf16 v[32:35], v[108:111], v[180:183], v[32:35]
    v_mfma_f32_16x16x32_bf16 v[32:35], v[116:119], v[120:123], v[32:35]
    v_mfma_f32_16x16x32_bf16 v[32:35], v[152:155], v[136:139], v[32:35]
    v_mfma_f32_16x16x32_bf16 v[32:35], v[192:195], v[232:235], v[32:35]
    v_mfma_f32_16x16x32_bf16 v[100:103], v[128:131], v[144:147], v[100:103]
    v_mfma_f32_16x16x32_bf16 v[100:103], v[108:111], v[156:159], v[100:103]
    s_waitcnt lgkmcnt(0)
    v_mfma_f32_16x16x32_bf16 v[100:103], v[116:119], v[168:171], v[100:103]
    v_mfma_f32_16x16x32_bf16 v[36:39], v[128:131], v[180:183], v[36:39]
    v_mfma_f32_16x16x32_bf16 v[36:39], v[108:111], v[120:123], v[36:39]
    s_barrier
    v_mfma_f32_16x16x32_bf16 v[36:39], v[116:119], v[136:139], v[36:39]
    v_mfma_f32_16x16x32_bf16 v[36:39], v[152:155], v[232:235], v[36:39]
    v_mfma_f32_16x16x32_bf16 v[36:39], v[192:195], v[164:167], v[36:39]
    v_mfma_f32_16x16x32_bf16 v[40:43], v[148:151], v[160:163], v[40:43]
    v_mfma_f32_16x16x32_bf16 v[40:43], v[252:255], v[176:179], v[40:43]
    v_mfma_f32_16x16x32_bf16 v[40:43], v[200:203], v[180:183], v[40:43]
    v_mfma_f32_16x16x32_bf16 v[40:43], v[132:135], v[120:123], v[40:43]
    v_mfma_f32_16x16x32_bf16 v[40:43], v[220:223], v[136:139], v[40:43]
    v_mfma_f32_16x16x32_bf16 v[44:47], v[148:151], v[176:179], v[44:47]
    v_mfma_f32_16x16x32_bf16 v[44:47], v[252:255], v[180:183], v[44:47]
    v_mfma_f32_16x16x32_bf16 v[44:47], v[200:203], v[120:123], v[44:47]
    v_mfma_f32_16x16x32_bf16 v[44:47], v[132:135], v[136:139], v[44:47]
    v_mfma_f32_16x16x32_bf16 v[44:47], v[220:223], v[232:235], v[44:47]
    ds_read_b128 v[228:231], v9 offset:0
    v_mfma_f32_16x16x32_bf16 v[48:51], v[148:151], v[180:183], v[48:51]
    ds_read_b128 v[208:211], v1 offset:10240
    v_mfma_f32_16x16x32_bf16 v[48:51], v[252:255], v[120:123], v[48:51]
    ds_read_b128 v[216:219], v9 offset:6144
    v_mfma_f32_16x16x32_bf16 v[48:51], v[200:203], v[136:139], v[48:51]
    ds_read_b128 v[124:127], v25 offset:10752
    v_mfma_f32_16x16x32_bf16 v[48:51], v[132:135], v[232:235], v[48:51]
    ds_read_b128 v[224:227], v9 offset:12288
    v_mfma_f32_16x16x32_bf16 v[48:51], v[220:223], v[164:167], v[48:51]
    ds_read_b128 v[212:215], v1 offset:11264
    v_mfma_f32_16x16x32_bf16 v[52:55], v[172:175], v[160:163], v[52:55]
    ds_read_b128 v[204:207], v9 offset:18432
    v_mfma_f32_16x16x32_bf16 v[52:55], v[240:243], v[176:179], v[52:55]
    ds_read_b128 v[236:239], v25 offset:11776
    v_mfma_f32_16x16x32_bf16 v[52:55], v[184:187], v[180:183], v[52:55]
    ds_read_b128 v[140:143], v9 offset:24576
    v_mfma_f32_16x16x32_bf16 v[52:55], v[112:115], v[120:123], v[52:55]
    ds_read_b128 v[244:247], v1 offset:12288
    v_mfma_f32_16x16x32_bf16 v[52:55], v[188:191], v[136:139], v[52:55]
    ds_read_b128 v[196:199], v25 offset:12800
    v_mfma_f32_16x16x32_bf16 v[56:59], v[172:175], v[176:179], v[56:59]
    ds_read_b128 v[248:251], v2 offset:10240
    v_mfma_f32_16x16x32_bf16 v[56:59], v[240:243], v[180:183], v[56:59]
    ds_read_b128 v[144:147], v26 offset:10752
    v_mfma_f32_16x16x32_bf16 v[56:59], v[184:187], v[120:123], v[56:59]
    ds_read_b128 v[156:159], v1 offset:13312
    v_mfma_f32_16x16x32_bf16 v[56:59], v[112:115], v[136:139], v[56:59]
    ds_read_b128 v[168:171], v10 offset:0
    v_mfma_f32_16x16x32_bf16 v[56:59], v[188:191], v[232:235], v[56:59]
    ds_read_b128 v[128:131], v10 offset:6144
    v_mfma_f32_16x16x32_bf16 v[60:63], v[172:175], v[180:183], v[60:63]
    ds_read_b128 v[108:111], v10 offset:12288
    v_mfma_f32_16x16x32_bf16 v[60:63], v[240:243], v[120:123], v[60:63]
    ds_read_b128 v[116:119], v10 offset:18432
    v_mfma_f32_16x16x32_bf16 v[60:63], v[184:187], v[136:139], v[60:63]
    ds_read_b128 v[152:155], v10 offset:24576
    v_mfma_f32_16x16x32_bf16 v[60:63], v[112:115], v[232:235], v[60:63]
    ds_read_b128 v[192:195], v11 offset:0
    v_mfma_f32_16x16x32_bf16 v[60:63], v[188:191], v[164:167], v[60:63]
    ds_read_b128 v[148:151], v11 offset:6144
    s_waitcnt lgkmcnt(8)
    v_mfma_f32_16x16x32_bf16 v[64:67], v[228:231], v[208:211], v[64:67]
    ds_read_b128 v[252:255], v11 offset:12288
    v_mfma_f32_16x16x32_bf16 v[64:67], v[216:219], v[124:127], v[64:67]
    ds_read_b128 v[200:203], v11 offset:18432
    v_mfma_f32_16x16x32_bf16 v[64:67], v[224:227], v[212:215], v[64:67]
    ds_read_b128 v[132:135], v11 offset:24576
    v_mfma_f32_16x16x32_bf16 v[64:67], v[204:207], v[236:239], v[64:67]
    v_mfma_f32_16x16x32_bf16 v[64:67], v[140:143], v[244:247], v[64:67]
    v_mfma_f32_16x16x32_bf16 v[68:71], v[228:231], v[124:127], v[68:71]
    v_mfma_f32_16x16x32_bf16 v[68:71], v[216:219], v[212:215], v[68:71]
    v_mfma_f32_16x16x32_bf16 v[68:71], v[224:227], v[236:239], v[68:71]
    v_mfma_f32_16x16x32_bf16 v[68:71], v[204:207], v[244:247], v[68:71]
    v_mfma_f32_16x16x32_bf16 v[68:71], v[140:143], v[196:199], v[68:71]
    v_mfma_f32_16x16x32_bf16 v[104:107], v[228:231], v[248:251], v[104:107]
    v_mfma_f32_16x16x32_bf16 v[104:107], v[216:219], v[144:147], v[104:107]
    v_mfma_f32_16x16x32_bf16 v[72:75], v[228:231], v[212:215], v[72:75]
    v_mfma_f32_16x16x32_bf16 v[72:75], v[216:219], v[236:239], v[72:75]
    s_waitcnt lgkmcnt(0)
    s_barrier
    v_mfma_f32_16x16x32_bf16 v[72:75], v[224:227], v[244:247], v[72:75]
    v_mfma_f32_16x16x32_bf16 v[72:75], v[204:207], v[196:199], v[72:75]
    v_mfma_f32_16x16x32_bf16 v[72:75], v[140:143], v[156:159], v[72:75]
    v_mfma_f32_16x16x32_bf16 v[76:79], v[168:171], v[208:211], v[76:79]
    v_mfma_f32_16x16x32_bf16 v[76:79], v[128:131], v[124:127], v[76:79]
    v_mfma_f32_16x16x32_bf16 v[76:79], v[108:111], v[212:215], v[76:79]
    v_mfma_f32_16x16x32_bf16 v[76:79], v[116:119], v[236:239], v[76:79]
    v_mfma_f32_16x16x32_bf16 v[76:79], v[152:155], v[244:247], v[76:79]
    v_mfma_f32_16x16x32_bf16 v[80:83], v[168:171], v[124:127], v[80:83]
    v_mfma_f32_16x16x32_bf16 v[80:83], v[128:131], v[212:215], v[80:83]
    v_mfma_f32_16x16x32_bf16 v[80:83], v[108:111], v[236:239], v[80:83]
    v_mfma_f32_16x16x32_bf16 v[80:83], v[116:119], v[244:247], v[80:83]
    v_mfma_f32_16x16x32_bf16 v[80:83], v[152:155], v[196:199], v[80:83]
    ds_read_b128 v[220:223], v9 offset:30720
    v_mfma_f32_16x16x32_bf16 v[84:87], v[168:171], v[212:215], v[84:87]
    ds_read_b128 v[160:163], v1 offset:20480
    v_mfma_f32_16x16x32_bf16 v[84:87], v[128:131], v[236:239], v[84:87]
    ds_read_b128 v[176:179], v9 offset:36864
    v_mfma_f32_16x16x32_bf16 v[84:87], v[108:111], v[244:247], v[84:87]
    ds_read_b128 v[180:183], v25 offset:20992
    v_mfma_f32_16x16x32_bf16 v[84:87], v[116:119], v[196:199], v[84:87]
    ds_read_b128 v[172:175], v9 offset:43008
    v_mfma_f32_16x16x32_bf16 v[84:87], v[152:155], v[156:159], v[84:87]
    ds_read_b128 v[120:123], v1 offset:21504
    v_mfma_f32_16x16x32_bf16 v[88:91], v[192:195], v[208:211], v[88:91]
    ds_read_b128 v[240:243], v9 offset:49152
    v_mfma_f32_16x16x32_bf16 v[88:91], v[148:151], v[124:127], v[88:91]
    ds_read_b128 v[136:139], v25 offset:22016
    v_mfma_f32_16x16x32_bf16 v[88:91], v[252:255], v[212:215], v[88:91]
    ds_read_b128 v[184:187], v9 offset:55296
    v_mfma_f32_16x16x32_bf16 v[88:91], v[200:203], v[236:239], v[88:91]
    ds_read_b128 v[232:235], v1 offset:22528
    v_mfma_f32_16x16x32_bf16 v[88:91], v[132:135], v[244:247], v[88:91]
    ds_read_b128 v[112:115], v25 offset:23040
    v_mfma_f32_16x16x32_bf16 v[92:95], v[192:195], v[124:127], v[92:95]
    ds_read_b128 v[164:167], v2 offset:20480
    v_mfma_f32_16x16x32_bf16 v[92:95], v[148:151], v[212:215], v[92:95]
    ds_read_b128 v[188:191], v26 offset:20992
    v_mfma_f32_16x16x32_bf16 v[92:95], v[252:255], v[236:239], v[92:95]
    ds_read_b128 v[248:251], v1 offset:23552
    v_mfma_f32_16x16x32_bf16 v[92:95], v[200:203], v[244:247], v[92:95]
    ds_read_b128 v[144:147], v10 offset:30720
    v_mfma_f32_16x16x32_bf16 v[92:95], v[132:135], v[196:199], v[92:95]
    ds_read_b128 v[228:231], v10 offset:36864
    v_mfma_f32_16x16x32_bf16 v[96:99], v[192:195], v[212:215], v[96:99]
    ds_read_b128 v[216:219], v10 offset:43008
    v_mfma_f32_16x16x32_bf16 v[96:99], v[148:151], v[236:239], v[96:99]
    ds_read_b128 v[224:227], v10 offset:49152
    v_mfma_f32_16x16x32_bf16 v[96:99], v[252:255], v[244:247], v[96:99]
    ds_read_b128 v[204:207], v10 offset:55296
    v_mfma_f32_16x16x32_bf16 v[96:99], v[200:203], v[196:199], v[96:99]
    ds_read_b128 v[140:143], v11 offset:30720
    v_mfma_f32_16x16x32_bf16 v[96:99], v[132:135], v[156:159], v[96:99]
    ds_read_b128 v[168:171], v11 offset:36864
    s_waitcnt lgkmcnt(8)
    v_mfma_f32_16x16x32_bf16 v[28:31], v[220:223], v[160:163], v[28:31]
    ds_read_b128 v[128:131], v11 offset:43008
    v_mfma_f32_16x16x32_bf16 v[28:31], v[176:179], v[180:183], v[28:31]
    ds_read_b128 v[108:111], v11 offset:49152
    v_mfma_f32_16x16x32_bf16 v[28:31], v[172:175], v[120:123], v[28:31]
    ds_read_b128 v[116:119], v11 offset:55296
    v_mfma_f32_16x16x32_bf16 v[28:31], v[240:243], v[136:139], v[28:31]
    v_mfma_f32_16x16x32_bf16 v[28:31], v[184:187], v[232:235], v[28:31]
    v_mfma_f32_16x16x32_bf16 v[32:35], v[220:223], v[180:183], v[32:35]
    v_mfma_f32_16x16x32_bf16 v[32:35], v[176:179], v[120:123], v[32:35]
    v_mfma_f32_16x16x32_bf16 v[32:35], v[172:175], v[136:139], v[32:35]
    v_mfma_f32_16x16x32_bf16 v[32:35], v[240:243], v[232:235], v[32:35]
    v_mfma_f32_16x16x32_bf16 v[32:35], v[184:187], v[112:115], v[32:35]
    v_mfma_f32_16x16x32_bf16 v[100:103], v[220:223], v[164:167], v[100:103]
    v_mfma_f32_16x16x32_bf16 v[100:103], v[176:179], v[188:191], v[100:103]
    v_mfma_f32_16x16x32_bf16 v[36:39], v[220:223], v[120:123], v[36:39]
    v_mul_f32 v28, s48, v28
    v_mul_f32 v29, s48, v29
    v_mfma_f32_16x16x32_bf16 v[36:39], v[176:179], v[136:139], v[36:39]
    v_mul_f32 v30, s48, v30
    v_mul_f32 v31, s48, v31
    v_mfma_f32_16x16x32_bf16 v[36:39], v[172:175], v[232:235], v[36:39]
    s_branch L_is6
.p2align 12
L_pg6:
    s_setpc_b64 s[62:63]
L_is6:
    s_waitcnt lgkmcnt(0)
    s_barrier
    v_mfma_f32_16x16x32_bf16 v[36:39], v[240:243], v[112:115], v[36:39]
    v_mul_f32 v32, s48, v32
    v_mul_f32 v33, s48, v33
    v_mfma_f32_16x16x32_bf16 v[36:39], v[184:187], v[248:251], v[36:39]
    v_mul_f32 v34, s48, v34
    v_mul_f32 v35, s48, v35
    v_mfma_f32_16x16x32_bf16 v[40:43], v[144:147], v[160:163], v[40:43]
    v_mul_f32 v100, s48, v100
    v_mul_f32 v101, s48, v101
    v_mfma_f32_16x16x32_bf16 v[40:43], v[228:231], v[180:183], v[40:43]
    v_mul_f32 v102, s48, v102
    v_mul_f32 v103, s48, v103
    v_mfma_f32_16x16x32_bf16 v[40:43], v[216:219], v[120:123], v[40:43]
    v_mul_f32 v36, s48, v36
    v_mul_f32 v37, s48, v37
    v_mfma_f32_16x16x32_bf16 v[40:43], v[224:227], v[136:139], v[40:43]
    v_mul_f32 v38, s48, v38
    v_mul_f32 v39, s48, v39
    v_mfma_f32_16x16x32_bf16 v[40:43], v[204:207], v[232:235], v[40:43]
    v_mfma_f32_16x16x32_bf16 v[44:47], v[144:147], v[180:183], v[44:47]
    v_mfma_f32_16x16x32_bf16 v[44:47], v[228:231], v[120:123], v[44:47]
    v_mfma_f32_16x16x32_bf16 v[44:47], v[216:219], v[136:139], v[44:47]
    v_mfma_f32_16x16x32_bf16 v[44:47], v[224:227], v[232:235], v[44:47]
    v_mfma_f32_16x16x32_bf16 v[44:47], v[204:207], v[112:115], v[44:47]
    v_mfma_f32_16x16x32_bf16 v[48:51], v[144:147], v[120:123], v[48:51]
    ds_read_b128 v[152:155], v12 offset:0
    v_mfma_f32_16x16x32_bf16 v[48:51], v[228:231], v[136:139], v[48:51]
    ds_read_b128 v[208:211], v1 offset:30720
    v_mul_f32 v40, s48, v40
    v_mfma_f32_16x16x32_bf16 v[48:51], v[216:219], v[232:235], v[48:51]
    ds_read_b128 v[124:127], v12 offset:6144
    v_mul_f32 v41, s48, v41
    v_mfma_f32_16x16x32_bf16 v[48:51], v[224:227], v[112:115], v[48:51]
    ds_read_b128 v[212:215], v25 offset:31232
    v_mul_f32 v42, s48, v42
    v_mfma_f32_16x16x32_bf16 v[48:51], v[204:207], v[248:251], v[48:51]
    ds_read_b128 v[192:195], v12 offset:12288
    v_mul_f32 v43, s48, v43
    v_mfma_f32_16x16x32_bf16 v[52:55], v[140:143], v[160:163], v[52:55]
    ds_read_b128 v[236:239], v1 offset:31744
    v_mul_f32 v44, s48, v44
    v_mfma_f32_16x16x32_bf16 v[52:55], v[168:171], v[180:183], v[52:55]
    ds_read_b128 v[148:151], v12 offset:18432
    v_mul_f32 v45, s48, v45
    v_mfma_f32_16x16x32_bf16 v[52:55], v[128:131], v[120:123], v[52:55]
    ds_read_b128 v[244:247], v25 offset:32256
    v_mul_f32 v46, s48, v46
    v_mfma_f32_16x16x32_bf16 v[52:55], v[108:111], v[136:139], v[52:55]
    ds_read_b128 v[252:255], v12 offset:24576
    v_mul_f32 v47, s48, v47
    v_mfma_f32_16x16x32_bf16 v[52:55], v[116:119], v[232:235], v[52:55]
    ds_read_b128 v[196:199], v1 offset:32768
    v_mul_f32 v48, s48, v48
    v_mfma_f32_16x16x32_bf16 v[56:59], v[140:143], v[180:183], v[56:59]
    ds_read_b128 v[200:203], v25 offset:33280
    v_mul_f32 v49, s48, v49
    v_mfma_f32_16x16x32_bf16 v[56:59], v[168:171], v[120:123], v[56:59]
    ds_read_b128 v[156:159], v2 offset:30720
    v_mul_f32 v50, s48, v50
    v_mfma_f32_16x16x32_bf16 v[56:59], v[128:131], v[136:139], v[56:59]
    ds_read_b128 v[132:135], v26 offset:31232
    v_mul_f32 v51, s48, v51
    v_mfma_f32_16x16x32_bf16 v[56:59], v[108:111], v[232:235], v[56:59]
    ds_read_b128 v[164:167], v2 offset:31744
    v_mul_f32 v52, s48, v52
    v_mfma_f32_16x16x32_bf16 v[56:59], v[116:119], v[112:115], v[56:59]
    ds_read_b128 v[188:191], v1 offset:33792
    v_mul_f32 v53, s48, v53
    v_mfma_f32_16x16x32_bf16 v[60:63], v[140:143], v[120:123], v[60:63]
    ds_read_b128 v[220:223], v13 offset:0
    v_mul_f32 v54, s48, v54
    v_mfma_f32_16x16x32_bf16 v[60:63], v[168:171], v[136:139], v[60:63]
    ds_read_b128 v[176:179], v13 offset:6144
    v_mul_f32 v55, s48, v55
    v_mfma_f32_16x16x32_bf16 v[60:63], v[128:131], v[232:235], v[60:63]
    ds_read_b128 v[172:175], v13 offset:12288
    v_mul_f32 v56, s48, v56
    v_mfma_f32_16x16x32_bf16 v[60:63], v[108:111], v[112:115], v[60:63]
    ds_read_b128 v[240:243], v13 offset:18432
    v_mul_f32 v57, s48, v57
    v_mfma_f32_16x16x32_bf16 v[60:63], v[116:119], v[248:251], v[60:63]
    ds_read_b128 v[184:187], v13 offset:24576
    v_mul_f32 v58, s48, v58
    s_waitcnt lgkmcnt(8)
    v_mfma_f32_16x16x32_bf16 v[64:67], v[152:155], v[208:211], v[64:67]
    ds_read_b128 v[144:147], v14 offset:0
    v_mul_f32 v59, s48, v59
    v_mfma_f32_16x16x32_bf16 v[64:67], v[124:127], v[212:215], v[64:67]
    ds_read_b128 v[228:231], v14 offset:6144
    v_mfma_f32_16x16x32_bf16 v[64:67], v[192:195], v[236:239], v[64:67]
    ds_read_b128 v[216:219], v14 offset:12288
    v_mul_f32 v60, s48, v60
    v_mfma_f32_16x16x32_bf16 v[64:67], v[148:151], v[244:247], v[64:67]
    ds_read_b128 v[224:227], v14 offset:18432
    ds_read_b128 v[204:207], v14 offset:24576
    v_mfma_f32_16x16x32_bf16 v[64:67], v[252:255], v[196:199], v[64:67]
    v_mul_f32 v61, s48, v61
    v_mul_f32 v62, s48, v62
    v_mfma_f32_16x16x32_bf16 v[68:71], v[152:155], v[212:215], v[68:71]
    v_mul_f32 v63, s48, v63
    v_mfma_f32_16x16x32_bf16 v[68:71], v[124:127], v[236:239], v[68:71]
    v_mfma_f32_16x16x32_bf16 v[68:71], v[192:195], v[244:247], v[68:71]
    v_mfma_f32_16x16x32_bf16 v[68:71], v[148:151], v[196:199], v[68:71]
    v_mfma_f32_16x16x32_bf16 v[68:71], v[252:255], v[200:203], v[68:71]
    v_mfma_f32_16x16x32_bf16 v[104:107], v[152:155], v[156:159], v[104:107]
    v_fmac_f32 v28, s49, v64
    v_fmac_f32 v29, s49, v65
    s_waitcnt lgkmcnt(2)
    v_mfma_f32_16x16x32_bf16 v[104:107], v[124:127], v[132:135], v[104:107]
    v_fmac_f32 v30, s49, v66
    v_fmac_f32 v31, s49, v67
    v_mfma_f32_16x16x32_bf16 v[104:107], v[192:195], v[164:167], v[104:107]
    v_fmamk_f32 v64, v64, 0xbff9a934, v28
    v_fmamk_f32 v65, v65, 0xbff9a934, v29
    v_mfma_f32_16x16x32_bf16 v[72:75], v[152:155], v[236:239], v[72:75]
    v_fmamk_f32 v66, v66, 0xbff9a934, v30
    v_fmamk_f32 v67, v67, 0xbff9a934, v31
    v_mfma_f32_16x16x32_bf16 v[72:75], v[124:127], v[244:247], v[72:75]
    s_waitcnt lgkmcnt(0)
    s_barrier
    v_mfma_f32_16x16x32_bf16 v[72:75], v[192:195], v[196:199], v[72:75]
    v_fmac_f32 v32, s49, v68
    v_fmac_f32 v33, s49, v69
    v_mfma_f32_16x16x32_bf16 v[72:75], v[148:151], v[200:203], v[72:75]
    v_fmac_f32 v34, s49, v70
    v_fmac_f32 v35, s49, v71
    v_mfma_f32_16x16x32_bf16 v[72:75], v[252:255], v[188:191], v[72:75]
    v_fmamk_f32 v68, v68, 0xbff9a934, v32
    v_fmamk_f32 v69, v69, 0xbff9a934, v33
    v_mfma_f32_16x16x32_bf16 v[76:79], v[220:223], v[208:211], v[76:79]
    v_fmamk_f32 v70, v70, 0xbff9a934, v34
    v_fmamk_f32 v71, v71, 0xbff9a934, v35
    v_mfma_f32_16x16x32_bf16 v[76:79], v[176:179], v[212:215], v[76:79]
    v_fmac_f32 v100, s49, v104
    v_fmac_f32 v101, s49, v105
    v_mfma_f32_16x16x32_bf16 v[76:79], v[172:175], v[236:239], v[76:79]
    v_fmac_f32 v102, s49, v106
    v_fmac_f32 v103, s49, v107
    v_mfma_f32_16x16x32_bf16 v[76:79], v[240:243], v[244:247], v[76:79]
    v_fmamk_f32 v104, v104, 0xbff9a934, v100
    v_fmamk_f32 v105, v105, 0xbff9a934, v101
    v_mfma_f32_16x16x32_bf16 v[76:79], v[184:187], v[196:199], v[76:79]
    v_fmamk_f32 v106, v106, 0xbff9a934, v102
    v_fmamk_f32 v107, v107, 0xbff9a934, v103
    v_mfma_f32_16x16x32_bf16 v[80:83], v[220:223], v[212:215], v[80:83]
    v_fmac_f32 v36, s49, v72
    v_fmac_f32 v37, s49, v73
    v_mfma_f32_16x16x32_bf16 v[80:83], v[176:179], v[236:239], v[80:83]
    v_fmac_f32 v38, s49, v74
    v_fmac_f32 v39, s49, v75
    v_mfma_f32_16x16x32_bf16 v[80:83], v[172:175], v[244:247], v[80:83]
    v_fmamk_f32 v72, v72, 0xbff9a934, v36
    v_fmamk_f32 v73, v73, 0xbff9a934, v37
    v_mfma_f32_16x16x32_bf16 v[80:83], v[240:243], v[196:199], v[80:83]
    v_fmamk_f32 v74, v74, 0xbff9a934, v38
    v_fmamk_f32 v75, v75, 0xbff9a934, v39
    v_mfma_f32_16x16x32_bf16 v[80:83], v[184:187], v[200:203], v[80:83]
    ds_read_b128 v[160:163], v9 offset:0
    v_fmac_f32 v40, s49, v76
    v_mfma_f32_16x16x32_bf16 v[84:87], v[220:223], v[236:239], v[84:87]
    ds_read_b128 v[180:183], v1 offset:0
    v_fmac_f32 v41, s49, v77
    v_mfma_f32_16x16x32_bf16 v[84:87], v[176:179], v[244:247], v[84:87]
    ds_read_b128 v[120:123], v9 offset:6144
    v_fmac_f32 v42, s49, v78
    v_mfma_f32_16x16x32_bf16 v[84:87], v[172:175], v[196:199], v[84:87]
    ds_read_b128 v[140:143], v25 offset:512
    v_fmac_f32 v43, s49, v79
    v_mfma_f32_16x16x32_bf16 v[84:87], v[240:243], v[200:203], v[84:87]
    ds_read_b128 v[136:139], v9 offset:12288
    v_fmamk_f32 v76, v76, 0xbff9a934, v40
    v_mfma_f32_16x16x32_bf16 v[84:87], v[184:187], v[188:191], v[84:87]
    ds_read_b128 v[168:171], v1 offset:1024
    v_fmamk_f32 v77, v77, 0xbff9a934, v41
    v_mfma_f32_16x16x32_bf16 v[88:91], v[144:147], v[208:211], v[88:91]
    ds_read_b128 v[232:235], v9 offset:18432
    v_fmamk_f32 v78, v78, 0xbff9a934, v42
    v_mfma_f32_16x16x32_bf16 v[88:91], v[228:231], v[212:215], v[88:91]
    ds_read_b128 v[128:131], v25 offset:1536
    v_fmamk_f32 v79, v79, 0xbff9a934, v43
    v_mfma_f32_16x16x32_bf16 v[88:91], v[216:219], v[236:239], v[88:91]
    ds_read_b128 v[112:115], v9 offset:24576
    v_fmac_f32 v44, s49, v80
    v_mfma_f32_16x16x32_bf16 v[88:91], v[224:227], v[244:247], v[88:91]
    ds_read_b128 v[108:111], v1 offset:2048
    v_fmac_f32 v45, s49, v81
    v_mfma_f32_16x16x32_bf16 v[88:91], v[204:207], v[196:199], v[88:91]
    ds_read_b128 v[248:251], v25 offset:2560
    v_fmac_f32 v46, s49, v82
    v_mfma_f32_16x16x32_bf16 v[92:95], v[144:147], v[212:215], v[92:95]
    ds_read_b128 v[116:119], v2 offset:0
    v_fmac_f32 v47, s49, v83
    v_mfma_f32_16x16x32_bf16 v[92:95], v[228:231], v[236:239], v[92:95]
    ds_read_b128 v[156:159], v26 offset:512
    v_fmamk_f32 v80, v80, 0xbff9a934, v44
    v_mfma_f32_16x16x32_bf16 v[92:95], v[216:219], v[244:247], v[92:95]
    ds_read_b128 v[132:135], v2 offset:1024
    v_fmamk_f32 v81, v81, 0xbff9a934, v45
    v_mfma_f32_16x16x32_bf16 v[92:95], v[224:227], v[196:199], v[92:95]
    ds_read_b128 v[164:167], v1 offset:3072
    v_fmamk_f32 v82, v82, 0xbff9a934, v46
    v_mfma_f32_16x16x32_bf16 v[92:95], v[204:207], v[200:203], v[92:95]
    ds_read_b128 v[152:155], v10 offset:0
    v_fmamk_f32 v83, v83, 0xbff9a934, v47
    v_mfma_f32_16x16x32_bf16 v[96:99], v[144:147], v[236:239], v[96:99]
    ds_read_b128 v[124:127], v10 offset:6144
    v_fmac_f32 v48, s49, v84
    v_mfma_f32_16x16x32_bf16 v[96:99], v[228:231], v[244:247], v[96:99]
    ds_read_b128 v[192:195], v10 offset:12288
    v_fmac_f32 v49, s49, v85
    v_mfma_f32_16x16x32_bf16 v[96:99], v[216:219], v[196:199], v[96:99]
    ds_read_b128 v[148:151], v10 offset:18432
    v_fmac_f32 v50, s49, v86
    v_mfma_f32_16x16x32_bf16 v[96:99], v[224:227], v[200:203], v[96:99]
    ds_read_b128 v[252:255], v10 offset:24576
    v_fmac_f32 v51, s49, v87
    v_mfma_f32_16x16x32_bf16 v[96:99], v[204:207], v[188:191], v[96:99]
    ds_read_b128 v[220:223], v11 offset:0
    v_fmamk_f32 v84, v84, 0xbff9a934, v48
    s_waitcnt lgkmcnt(8)
    v_mfma_f32_16x16x32_bf16 v[28:31], v[160:163], v[180:183], v[28:31]
    ds_read_b128 v[176:179], v11 offset:6144
    v_fmamk_f32 v85, v85, 0xbff9a934, v49
    v_mfma_f32_16x16x32_bf16 v[28:31], v[120:123], v[140:143], v[28:31]
    ds_read_b128 v[172:175], v11 offset:12288
    v_fmamk_f32 v86, v86, 0xbff9a934, v50
    v_mfma_f32_16x16x32_bf16 v[28:31], v[136:139], v[168:171], v[28:31]
    ds_read_b128 v[240:243], v11 offset:18432
    v_fmamk_f32 v87, v87, 0xbff9a934, v51
    v_mfma_f32_16x16x32_bf16 v[28:31], v[232:235], v[128:131], v[28:31]
    ds_read_b128 v[184:187], v11 offset:24576
    v_fmac_f32 v52, s49, v88
    v_mfma_f32_16x16x32_bf16 v[28:31], v[112:115], v[108:111], v[28:31]
    v_fmac_f32 v53, s49, v89
    v_fmac_f32 v54, s49, v90
    v_mfma_f32_16x16x32_bf16 v[32:35], v[160:163], v[140:143], v[32:35]
    v_fmac_f32 v55, s49, v91
    v_fmamk_f32 v88, v88, 0xbff9a934, v52
    v_mfma_f32_16x16x32_bf16 v[32:35], v[120:123], v[168:171], v[32:35]
    v_fmamk_f32 v89, v89, 0xbff9a934, v53
    v_fmamk_f32 v90, v90, 0xbff9a934, v54
    v_mfma_f32_16x16x32_bf16 v[32:35], v[136:139], v[128:131], v[32:35]
    v_fmamk_f32 v91, v91, 0xbff9a934, v55
    v_fmac_f32 v56, s49, v92
    v_mfma_f32_16x16x32_bf16 v[32:35], v[232:235], v[108:111], v[32:35]
    v_fmac_f32 v57, s49, v93
    v_fmac_f32 v58, s49, v94
    v_mfma_f32_16x16x32_bf16 v[32:35], v[112:115], v[248:251], v[32:35]
    v_fmac_f32 v59, s49, v95
    v_fmamk_f32 v92, v92, 0xbff9a934, v56
    v_mfma_f32_16x16x32_bf16 v[100:103], v[160:163], v[116:119], v[100:103]
    v_fmamk_f32 v93, v93, 0xbff9a934, v57
    v_fmamk_f32 v94, v94, 0xbff9a934, v58
    v_mfma_f32_16x16x32_bf16 v[100:103], v[120:123], v[156:159], v[100:103]
    v_fmamk_f32 v95, v95, 0xbff9a934, v59
    v_fmac_f32 v60, s49, v96
    s_waitcnt lgkmcnt(0)
    v_mfma_f32_16x16x32_bf16 v[100:103], v[136:139], v[132:135], v[100:103]
    v_fmac_f32 v61, s49, v97
    v_fmac_f32 v62, s49, v98
    v_mfma_f32_16x16x32_bf16 v[36:39], v[160:163], v[168:171], v[36:39]
    v_fmac_f32 v63, s49, v99
    v_fmamk_f32 v96, v96, 0xbff9a934, v60
    v_mfma_f32_16x16x32_bf16 v[36:39], v[120:123], v[128:131], v[36:39]
    s_barrier
    v_mfma_f32_16x16x32_bf16 v[36:39], v[136:139], v[108:111], v[36:39]
    v_fmamk_f32 v97, v97, 0xbff9a934, v61
    v_fmamk_f32 v98, v98, 0xbff9a934, v62
    v_mfma_f32_16x16x32_bf16 v[36:39], v[232:235], v[248:251], v[36:39]
    v_fmamk_f32 v99, v99, 0xbff9a934, v63
    v_mul_f32 v64, s56, v64
    v_mfma_f32_16x16x32_bf16 v[36:39], v[112:115], v[164:167], v[36:39]
    v_mul_f32 v65, s56, v65
    v_mul_f32 v66, s56, v66
    v_mfma_f32_16x16x32_bf16 v[40:43], v[152:155], v[180:183], v[40:43]
    v_mul_f32 v67, s56, v67
    v_mul_f32 v68, s56, v68
    v_mfma_f32_16x16x32_bf16 v[40:43], v[124:127], v[140:143], v[40:43]
    v_mul_f32 v69, s56, v69
    v_mul_f32 v70, s56, v70
    v_mfma_f32_16x16x32_bf16 v[40:43], v[192:195], v[168:171], v[40:43]
    v_mul_f32 v71, s56, v71
    v_mul_f32 v104, s56, v104
    v_mfma_f32_16x16x32_bf16 v[40:43], v[148:151], v[128:131], v[40:43]
    v_mul_f32 v105, s56, v105
    v_mul_f32 v106, s56, v106
    v_mfma_f32_16x16x32_bf16 v[40:43], v[252:255], v[108:111], v[40:43]
    v_mul_f32 v107, s56, v107
    v_mul_f32 v72, s56, v72
    v_mfma_f32_16x16x32_bf16 v[44:47], v[152:155], v[140:143], v[44:47]
    v_mul_f32 v73, s56, v73
    v_mul_f32 v74, s56, v74
    v_mfma_f32_16x16x32_bf16 v[44:47], v[124:127], v[168:171], v[44:47]
    v_mul_f32 v75, s56, v75
    v_mul_f32 v76, s56, v76
    v_mfma_f32_16x16x32_bf16 v[44:47], v[192:195], v[128:131], v[44:47]
    v_mul_f32 v77, s56, v77
    v_mul_f32 v78, s56, v78
    v_mfma_f32_16x16x32_bf16 v[44:47], v[148:151], v[108:111], v[44:47]
    v_mul_f32 v79, s56, v79
    v_mul_f32 v80, s56, v80
    v_mfma_f32_16x16x32_bf16 v[44:47], v[252:255], v[248:251], v[44:47]
    ds_read_b128 v[208:211], v9 offset:30720
    v_mul_f32 v81, s56, v81
    v_mfma_f32_16x16x32_bf16 v[48:51], v[152:155], v[168:171], v[48:51]
    ds_read_b128 v[212:215], v1 offset:10240
    v_mul_f32 v82, s56, v82
    v_mfma_f32_16x16x32_bf16 v[48:51], v[124:127], v[128:131], v[48:51]
    ds_read_b128 v[236:239], v9 offset:36864
    v_mul_f32 v83, s56, v83
    v_mfma_f32_16x16x32_bf16 v[48:51], v[192:195], v[108:111], v[48:51]
    ds_read_b128 v[144:147], v25 offset:10752
    v_mul_f32 v84, s56, v84
    v_mfma_f32_16x16x32_bf16 v[48:51], v[148:151], v[248:251], v[48:51]
    ds_read_b128 v[244:247], v9 offset:43008
    v_mul_f32 v85, s56, v85
    v_mfma_f32_16x16x32_bf16 v[48:51], v[252:255], v[164:167], v[48:51]
    ds_read_b128 v[228:231], v1 offset:11264
    v_mul_f32 v86, s56, v86
    v_mfma_f32_16x16x32_bf16 v[52:55], v[220:223], v[180:183], v[52:55]
    ds_read_b128 v[196:199], v9 offset:49152
    v_mul_f32 v87, s56, v87
    v_mfma_f32_16x16x32_bf16 v[52:55], v[176:179], v[140:143], v[52:55]
    ds_read_b128 v[216:219], v25 offset:11776
    v_mul_f32 v88, s56, v88
    v_mfma_f32_16x16x32_bf16 v[52:55], v[172:175], v[168:171], v[52:55]
    ds_read_b128 v[200:203], v9 offset:55296
    v_mul_f32 v89, s56, v89
    v_mfma_f32_16x16x32_bf16 v[52:55], v[240:243], v[128:131], v[52:55]
    ds_read_b128 v[224:227], v1 offset:12288
    v_mul_f32 v90, s56, v90
    v_mfma_f32_16x16x32_bf16 v[52:55], v[184:187], v[108:111], v[52:55]
    ds_read_b128 v[188:191], v25 offset:12800
    v_mul_f32 v91, s56, v91
    v_mfma_f32_16x16x32_bf16 v[56:59], v[220:223], v[140:143], v[56:59]
    ds_read_b128 v[204:207], v2 offset:10240
    v_mul_f32 v92, s56, v92
    v_mfma_f32_16x16x32_bf16 v[56:59], v[176:179], v[168:171], v[56:59]
    ds_read_b128 v[116:119], v26 offset:10752
    v_mul_f32 v93, s56, v93
    v_mfma_f32_16x16x32_bf16 v[56:59], v[172:175], v[128:131], v[56:59]
    ds_read_b128 v[156:159], v1 offset:13312
    v_mul_f32 v94, s56, v94
    v_mfma_f32_16x16x32_bf16 v[56:59], v[240:243], v[108:111], v[56:59]
    ds_read_b128 v[132:135], v10 offset:30720
    v_mul_f32 v95, s56, v95
    v_mfma_f32_16x16x32_bf16 v[56:59], v[184:187], v[248:251], v[56:59]
    ds_read_b128 v[160:163], v10 offset:36864
    v_mul_f32 v96, s56, v96
    v_mfma_f32_16x16x32_bf16 v[60:63], v[220:223], v[168:171], v[60:63]
    ds_read_b128 v[120:123], v10 offset:43008
    v_mul_f32 v97, s56, v97
    v_mfma_f32_16x16x32_bf16 v[60:63], v[176:179], v[128:131], v[60:63]
    ds_read_b128 v[136:139], v10 offset:49152
    v_mul_f32 v98, s56, v98
    v_mfma_f32_16x16x32_bf16 v[60:63], v[172:175], v[108:111], v[60:63]
    ds_read_b128 v[232:235], v10 offset:55296
    v_mul_f32 v99, s56, v99
    v_mfma_f32_16x16x32_bf16 v[60:63], v[240:243], v[248:251], v[60:63]
    ds_read_b128 v[112:115], v11 offset:30720
    v_mfma_f32_16x16x32_bf16 v[60:63], v[184:187], v[164:167], v[60:63]
    ds_read_b128 v[152:155], v11 offset:36864
    s_waitcnt lgkmcnt(8)
    v_mfma_f32_16x16x32_bf16 v[64:67], v[208:211], v[212:215], v[64:67]
    ds_read_b128 v[124:127], v11 offset:43008
    v_mfma_f32_16x16x32_bf16 v[64:67], v[236:239], v[144:147], v[64:67]
    ds_read_b128 v[192:195], v11 offset:49152
    v_mfma_f32_16x16x32_bf16 v[64:67], v[244:247], v[228:231], v[64:67]
    ds_read_b128 v[148:151], v11 offset:55296
    v_mfma_f32_16x16x32_bf16 v[64:67], v[196:199], v[216:219], v[64:67]
    v_mfma_f32_16x16x32_bf16 v[64:67], v[200:203], v[224:227], v[64:67]
    v_mfma_f32_16x16x32_bf16 v[68:71], v[208:211], v[144:147], v[68:71]
    v_mfma_f32_16x16x32_bf16 v[68:71], v[236:239], v[228:231], v[68:71]
    v_mfma_f32_16x16x32_bf16 v[68:71], v[244:247], v[216:219], v[68:71]
    v_mfma_f32_16x16x32_bf16 v[68:71], v[196:199], v[224:227], v[68:71]
    v_mfma_f32_16x16x32_bf16 v[68:71], v[200:203], v[188:191], v[68:71]
    v_mfma_f32_16x16x32_bf16 v[104:107], v[208:211], v[204:207], v[104:107]
    v_mfma_f32_16x16x32_bf16 v[104:107], v[236:239], v[116:119], v[104:107]
    v_mfma_f32_16x16x32_bf16 v[72:75], v[208:211], v[228:231], v[72:75]
    v_mfma_f32_16x16x32_bf16 v[72:75], v[236:239], v[216:219], v[72:75]
    s_waitcnt lgkmcnt(0)
    s_barrier
    v_mfma_f32_16x16x32_bf16 v[72:75], v[244:247], v[224:227], v[72:75]
    v_mfma_f32_16x16x32_bf16 v[72:75], v[196:199], v[188:191], v[72:75]
    v_mfma_f32_16x16x32_bf16 v[72:75], v[200:203], v[156:159], v[72:75]
    v_mfma_f32_16x16x32_bf16 v[76:79], v[132:135], v[212:215], v[76:79]
    v_mfma_f32_16x16x32_bf16 v[76:79], v[160:163], v[144:147], v[76:79]
    v_mfma_f32_16x16x32_bf16 v[76:79], v[120:123], v[228:231], v[76:79]
    v_mfma_f32_16x16x32_bf16 v[76:79], v[136:139], v[216:219], v[76:79]
    v_mfma_f32_16x16x32_bf16 v[76:79], v[232:235], v[224:227], v[76:79]
    v_mfma_f32_16x16x32_bf16 v[80:83], v[132:135], v[144:147], v[80:83]
    v_mfma_f32_16x16x32_bf16 v[80:83], v[160:163], v[228:231], v[80:83]
    v_mfma_f32_16x16x32_bf16 v[80:83], v[120:123], v[216:219], v[80:83]
    v_mfma_f32_16x16x32_bf16 v[80:83], v[136:139], v[224:227], v[80:83]
    v_mfma_f32_16x16x32_bf16 v[80:83], v[232:235], v[188:191], v[80:83]
    v_mfma_f32_16x16x32_bf16 v[84:87], v[132:135], v[228:231], v[84:87]
    v_mfma_f32_16x16x32_bf16 v[84:87], v[160:163], v[216:219], v[84:87]
    v_mfma_f32_16x16x32_bf16 v[84:87], v[120:123], v[224:227], v[84:87]
    v_mfma_f32_16x16x32_bf16 v[84:87], v[136:139], v[188:191], v[84:87]
    v_mfma_f32_16x16x32_bf16 v[84:87], v[232:235], v[156:159], v[84:87]
    v_mfma_f32_16x16x32_bf16 v[88:91], v[112:115], v[212:215], v[88:91]
    ds_read_b128 v[252:255], v6 offset:0
    v_mfma_f32_16x16x32_bf16 v[88:91], v[152:155], v[144:147], v[88:91]
    ds_read_b128 v[180:183], v1 offset:20480
    v_mfma_f32_16x16x32_bf16 v[88:91], v[124:127], v[228:231], v[88:91]
    ds_read_b128 v[140:143], v6 offset:2048
    v_mfma_f32_16x16x32_bf16 v[88:91], v[192:195], v[216:219], v[88:91]
    ds_read_b128 v[168:171], v25 offset:20992
    v_mfma_f32_16x16x32_bf16 v[88:91], v[148:151], v[224:227], v[88:91]
    ds_read_b128 v[220:223], v6 offset:4096
    v_mfma_f32_16x16x32_bf16 v[92:95], v[112:115], v[144:147], v[92:95]
    ds_read_b128 v[128:131], v1 offset:21504
    v_mfma_f32_16x16x32_bf16 v[92:95], v[152:155], v[228:231], v[92:95]
    ds_read_b128 v[176:179], v6 offset:6144
    v_mfma_f32_16x16x32_bf16 v[92:95], v[124:127], v[216:219], v[92:95]
    ds_read_b128 v[108:111], v25 offset:22016
    v_mfma_f32_16x16x32_bf16 v[92:95], v[192:195], v[224:227], v[92:95]
    ds_read_b128 v[172:175], v6 offset:8192
    ds_read_b128 v[248:251], v1 offset:22528
    v_mfma_f32_16x16x32_bf16 v[92:95], v[148:151], v[188:191], v[92:95]
    ds_read_b128 v[240:243], v25 offset:23040
    v_mfma_f32_16x16x32_bf16 v[96:99], v[112:115], v[228:231], v[96:99]
    ds_read_b128 v[164:167], v2 offset:20480
    v_mfma_f32_16x16x32_bf16 v[96:99], v[152:155], v[216:219], v[96:99]
    ds_read_b128 v[184:187], v26 offset:20992
    v_mfma_f32_16x16x32_bf16 v[96:99], v[124:127], v[224:227], v[96:99]
    v_mfma_f32_16x16x32_bf16 v[96:99], v[192:195], v[188:191], v[96:99]
    ds_read_b128 v[204:207], v6 offset:10240
    v_mfma_f32_16x16x32_bf16 v[96:99], v[148:151], v[156:159], v[96:99]
    ds_read_b128 v[116:119], v6 offset:12288
    s_waitcnt lgkmcnt(8)
    v_mfma_f32_16x16x32_bf16 v[28:31], v[252:255], v[180:183], v[28:31]
    ds_read_b128 v[208:211], v6 offset:14336
    v_mfma_f32_16x16x32_bf16 v[28:31], v[140:143], v[168:171], v[28:31]
    ds_read_b128 v[236:239], v6 offset:16384
    v_mfma_f32_16x16x32_bf16 v[28:31], v[220:223], v[128:131], v[28:31]
    ds_read_b128 v[244:247], v6 offset:18432
    s_waitcnt lgkmcnt(7)
    v_mfma_f32_16x16x32_bf16 v[28:31], v[176:179], v[108:111], v[28:31]
    ds_read_b128 v[196:199], v6 offset:20480
    ds_read_b128 v[200:203], v6 offset:22528
    v_mfma_f32_16x16x32_bf16 v[28:31], v[172:175], v[248:251], v[28:31]
    ds_read_b128 v[132:135], v6 offset:24576
    ds_read_b128 v[160:163], v6 offset:26624
    v_mfma_f32_16x16x32_bf16 v[32:35], v[252:255], v[168:171], v[32:35]
    ds_read_b128 v[120:123], v6 offset:28672
    ds_read_b128 v[136:139], v1 offset:23552
    v_mfma_f32_16x16x32_bf16 v[32:35], v[140:143], v[128:131], v[32:35]
    ds_read_b128 v[232:235], v1 offset:30720
    v_mfma_f32_16x16x32_bf16 v[32:35], v[220:223], v[108:111], v[32:35]
    ds_read_b128 v[212:215], v25 offset:31232
    v_mfma_f32_16x16x32_bf16 v[32:35], v[176:179], v[248:251], v[32:35]
    ds_read_b128 v[144:147], v1 offset:31744
    v_mfma_f32_16x16x32_bf16 v[32:35], v[172:175], v[240:243], v[32:35]
    ds_read_b128 v[228:231], v25 offset:32256
    s_waitcnt lgkmcnt(11)
    v_mfma_f32_16x16x32_bf16 v[100:103], v[252:255], v[164:167], v[100:103]
    ds_read_b128 v[112:115], v1 offset:32768
    v_mfma_f32_16x16x32_bf16 v[100:103], v[140:143], v[184:187], v[100:103]
    ds_read_b128 v[216:219], v25 offset:33280
    v_mfma_f32_16x16x32_bf16 v[36:39], v[252:255], v[128:131], v[36:39]
    ds_read_b128 v[152:155], v2 offset:30720
    v_mfma_f32_16x16x32_bf16 v[36:39], v[140:143], v[108:111], v[36:39]
    ds_read_b128 v[224:227], v26 offset:31232
    v_mfma_f32_16x16x32_bf16 v[36:39], v[220:223], v[248:251], v[36:39]
    s_waitcnt lgkmcnt(8)
    s_barrier
    v_mfma_f32_16x16x32_bf16 v[36:39], v[176:179], v[240:243], v[36:39]
    ds_read_b128 v[124:127], v2 offset:31744
    v_mfma_f32_16x16x32_bf16 v[36:39], v[172:175], v[136:139], v[36:39]
    s_waitcnt lgkmcnt(6)
    v_mfma_f32_16x16x32_bf16 v[64:67], v[204:207], v[232:235], v[64:67]
    v_mfma_f32_16x16x32_bf16 v[64:67], v[116:119], v[212:215], v[64:67]
    v_mfma_f32_16x16x32_bf16 v[64:67], v[208:211], v[144:147], v[64:67]
    ds_read_b128 v[188:191], v1 offset:33792
    s_waitcnt lgkmcnt(4)
    v_mfma_f32_16x16x32_bf16 v[64:67], v[236:239], v[228:231], v[64:67]
    ds_read_b128 v[192:195], v1 offset:0
    v_mfma_f32_16x16x32_bf16 v[64:67], v[244:247], v[112:115], v[64:67]
    ds_read_b128 v[156:159], v25 offset:512
    v_mfma_f32_16x16x32_bf16 v[68:71], v[204:207], v[212:215], v[68:71]
    ds_read_b128 v[148:151], v1 offset:1024
    v_mfma_f32_16x16x32_bf16 v[68:71], v[116:119], v[144:147], v[68:71]
    ds_read_b128 v[164:167], v25 offset:1536
    v_mfma_f32_16x16x32_bf16 v[68:71], v[208:211], v[228:231], v[68:71]
    ds_read_b128 v[184:187], v1 offset:2048
    v_mfma_f32_16x16x32_bf16 v[68:71], v[236:239], v[112:115], v[68:71]
    ds_read_b128 v[252:255], v25 offset:2560
    v_mfma_f32_16x16x32_bf16 v[68:71], v[244:247], v[216:219], v[68:71]
    ds_read_b128 v[140:143], v2 offset:0
    s_waitcnt lgkmcnt(8)
    v_mfma_f32_16x16x32_bf16 v[104:107], v[204:207], v[152:155], v[104:107]
    ds_read_b128 v[220:223], v26 offset:512
    v_mfma_f32_16x16x32_bf16 v[104:107], v[116:119], v[224:227], v[104:107]
    ds_read_b128 v[176:179], v2 offset:1024
    v_mfma_f32_16x16x32_bf16 v[104:107], v[208:211], v[124:127], v[104:107]
    ds_read_b128 v[172:175], v1 offset:3072
    v_mfma_f32_16x16x32_bf16 v[72:75], v[204:207], v[144:147], v[72:75]
    ds_read_b128 v[152:155], v2 offset:10240
    v_mfma_f32_16x16x32_bf16 v[72:75], v[116:119], v[228:231], v[72:75]
    ds_read_b128 v[224:227], v26 offset:10752
    v_mfma_f32_16x16x32_bf16 v[72:75], v[208:211], v[112:115], v[72:75]
    ds_read_b128 v[124:127], v1 offset:10240
    v_mfma_f32_16x16x32_bf16 v[72:75], v[236:239], v[216:219], v[72:75]
    ds_read_b128 v[204:207], v3 offset:0
    s_waitcnt lgkmcnt(8)
    v_mfma_f32_16x16x32_bf16 v[72:75], v[244:247], v[188:191], v[72:75]
    ds_read_b128 v[116:119], v3 offset:2048
    v_mfma_f32_16x16x32_bf16 v[28:31], v[196:199], v[192:195], v[28:31]
    ds_read_b128 v[208:211], v25 offset:10752
    v_mfma_f32_16x16x32_bf16 v[28:31], v[200:203], v[156:159], v[28:31]
    ds_read_b128 v[236:239], v1 offset:11264
    v_mfma_f32_16x16x32_bf16 v[28:31], v[132:135], v[148:151], v[28:31]
    ds_read_b128 v[244:247], v3 offset:4096
    v_mfma_f32_16x16x32_bf16 v[28:31], v[160:163], v[164:167], v[28:31]
    v_mfma_f32_16x16x32_bf16 v[28:31], v[120:123], v[184:187], v[28:31]
    v_mfma_f32_16x16x32_bf16 v[32:35], v[196:199], v[156:159], v[32:35]
    v_mfma_f32_16x16x32_bf16 v[32:35], v[200:203], v[148:151], v[32:35]
    v_mfma_f32_16x16x32_bf16 v[32:35], v[132:135], v[164:167], v[32:35]
    v_mfma_f32_16x16x32_bf16 v[32:35], v[160:163], v[184:187], v[32:35]
    v_mfma_f32_16x16x32_bf16 v[32:35], v[120:123], v[252:255], v[32:35]
    s_waitcnt lgkmcnt(1)
    v_mfma_f32_16x16x32_bf16 v[100:103], v[196:199], v[140:143], v[100:103]
    ds_read_b128 v[140:143], v3 offset:6144
    v_mfma_f32_16x16x32_bf16 v[100:103], v[200:203], v[220:223], v[100:103]
    ds_read_b128 v[220:223], v25 offset:11776
    v_mfma_f32_16x16x32_bf16 v[100:103], v[132:135], v[176:179], v[100:103]
    ds_read_b128 v[176:179], v3 offset:8192
    v_mfma_f32_16x16x32_bf16 v[36:39], v[196:199], v[148:151], v[36:39]
    ds_read_b128 v[196:199], v1 offset:12288
    v_mfma_f32_16x16x32_bf16 v[36:39], v[200:203], v[164:167], v[36:39]
    ds_read_b128 v[200:203], v25 offset:12800
    v_mfma_f32_16x16x32_bf16 v[36:39], v[132:135], v[184:187], v[36:39]
    ds_read_b128 v[132:135], v1 offset:13312
    v_mfma_f32_16x16x32_bf16 v[36:39], v[160:163], v[252:255], v[36:39]
    ds_read_b128 v[160:163], v3 offset:10240
    v_mfma_f32_16x16x32_bf16 v[36:39], v[120:123], v[172:175], v[36:39]
    ds_read_b128 v[120:123], v3 offset:12288
    v_mfma_f32_16x16x32_bf16 v[104:107], v[204:207], v[152:155], v[104:107]
    ds_read_b128 v[152:155], v3 offset:14336
    v_mfma_f32_16x16x32_bf16 v[104:107], v[116:119], v[224:227], v[104:107]
    ds_read_b128 v[224:227], v3 offset:16384
    v_mfma_f32_16x16x32_bf16 v[64:67], v[204:207], v[124:127], v[64:67]
    v_mfma_f32_16x16x32_bf16 v[64:67], v[116:119], v[208:211], v[64:67]
    s_waitcnt lgkmcnt(6)
    v_mfma_f32_16x16x32_bf16 v[64:67], v[244:247], v[236:239], v[64:67]
    v_mfma_f32_16x16x32_bf16 v[64:67], v[140:143], v[220:223], v[64:67]
    v_mfma_f32_16x16x32_bf16 v[64:67], v[176:179], v[196:199], v[64:67]
    v_mfma_f32_16x16x32_bf16 v[68:71], v[204:207], v[208:211], v[68:71]
    v_mfma_f32_16x16x32_bf16 v[68:71], v[116:119], v[236:239], v[68:71]
    v_fmac_f32 v100, s57, v104
    v_fmac_f32 v101, s57, v105
    v_mfma_f32_16x16x32_bf16 v[68:71], v[244:247], v[220:223], v[68:71]
    v_fmac_f32 v102, s57, v106
    v_fmac_f32 v103, s57, v107
    v_mfma_f32_16x16x32_bf16 v[68:71], v[140:143], v[196:199], v[68:71]
    v_fmac_f32 v104, s58, v100
    v_fmac_f32 v105, s58, v101
    s_waitcnt lgkmcnt(0)
    v_mfma_f32_16x16x32_bf16 v[68:71], v[176:179], v[200:203], v[68:71]
    v_fmac_f32 v106, s58, v102
    v_fmac_f32 v107, s58, v103
    v_mfma_f32_16x16x32_bf16 v[72:75], v[204:207], v[236:239], v[72:75]
    ds_read_b128 v[204:207], v3 offset:18432
    ds_write_b128 v16, v[100:103] offset:0
    v_mfma_f32_16x16x32_bf16 v[72:75], v[116:119], v[220:223], v[72:75]
    s_barrier
    v_mfma_f32_16x16x32_bf16 v[72:75], v[244:247], v[196:199], v[72:75]
    ds_read_b128 v[116:119], v3 offset:20480
    ds_write_b128 v16, v[104:107] offset:512
    v_mfma_f32_16x16x32_bf16 v[72:75], v[140:143], v[200:203], v[72:75]
    ds_read_b128 v[244:247], v3 offset:22528
    v_fmac_f32 v28, s57, v64
    v_mfma_f32_16x16x32_bf16 v[72:75], v[176:179], v[132:135], v[72:75]
    ds_read_b128 v[140:143], v3 offset:24576
    v_fmac_f32 v29, s57, v65
    v_mfma_f32_16x16x32_bf16 v[40:43], v[160:163], v[180:183], v[40:43]
    ds_read_b128 v[176:179], v3 offset:26624
    v_fmac_f32 v30, s57, v66
    v_mfma_f32_16x16x32_bf16 v[40:43], v[120:123], v[168:171], v[40:43]
    v_fmac_f32 v31, s57, v67
    v_fmac_f32 v64, s58, v28
    v_mfma_f32_16x16x32_bf16 v[40:43], v[152:155], v[128:131], v[40:43]
    v_fmac_f32 v65, s58, v29
    v_fmac_f32 v66, s58, v30
    v_mfma_f32_16x16x32_bf16 v[40:43], v[224:227], v[108:111], v[40:43]
    s_branch L_is7
.p2align 12
L_pg7:
    s_setpc_b64 s[62:63]
L_is7:
    v_fmac_f32 v67, s58, v31
    v_cvt_pk_bf16_f32 v28, v28, v29
    s_waitcnt lgkmcnt(5)
    v_mfma_f32_16x16x32_bf16 v[40:43], v[204:207], v[248:251], v[40:43]
    v_cvt_pk_bf16_f32 v29, v30, v31
    ds_write_b64 v15, v[28:29] offset:0
    v_mfma_f32_16x16x32_bf16 v[44:47], v[160:163], v[168:171], v[44:47]
    v_cvt_pk_bf16_f32 v64, v64, v65
    v_cvt_pk_bf16_f32 v65, v66, v67
    v_mfma_f32_16x16x32_bf16 v[44:47], v[120:123], v[128:131], v[44:47]
    ds_write_b64 v15, v[64:65] offset:512
    v_fmac_f32 v32, s57, v68
    v_mfma_f32_16x16x32_bf16 v[44:47], v[152:155], v[108:111], v[44:47]
    v_fmac_f32 v33, s57, v69
    v_fmac_f32 v34, s57, v70
    v_mfma_f32_16x16x32_bf16 v[44:47], v[224:227], v[248:251], v[44:47]
    v_fmac_f32 v35, s57, v71
    v_fmac_f32 v68, s58, v32
    v_mfma_f32_16x16x32_bf16 v[44:47], v[204:207], v[240:243], v[44:47]
    v_fmac_f32 v69, s58, v33
    v_fmac_f32 v70, s58, v34
    v_mfma_f32_16x16x32_bf16 v[48:51], v[160:163], v[128:131], v[48:51]
    ds_read_b128 v[160:163], v3 offset:28672
    v_fmac_f32 v71, s58, v35
    v_mfma_f32_16x16x32_bf16 v[48:51], v[120:123], v[108:111], v[48:51]
    ds_read_b128 v[120:123], v3 offset:30720
    v_cvt_pk_bf16_f32 v32, v32, v33
    v_mfma_f32_16x16x32_bf16 v[48:51], v[152:155], v[248:251], v[48:51]
    ds_read_b128 v[152:155], v3 offset:32768
    v_cvt_pk_bf16_f32 v33, v34, v35
    v_mfma_f32_16x16x32_bf16 v[48:51], v[224:227], v[240:243], v[48:51]
    s_waitcnt lgkmcnt(3)
    s_barrier
    v_mfma_f32_16x16x32_bf16 v[48:51], v[204:207], v[136:139], v[48:51]
    ds_read_b128 v[224:227], v3 offset:34816
    ds_write_b64 v15, v[32:33] offset:1024
    v_mfma_f32_16x16x32_bf16 v[76:79], v[116:119], v[232:235], v[76:79]
    ds_read_b128 v[204:207], v3 offset:36864
    v_cvt_pk_bf16_f32 v68, v68, v69
    v_mfma_f32_16x16x32_bf16 v[76:79], v[244:247], v[212:215], v[76:79]
    v_cvt_pk_bf16_f32 v69, v70, v71
    ds_write_b64 v15, v[68:69] offset:1536
    v_mfma_f32_16x16x32_bf16 v[76:79], v[140:143], v[144:147], v[76:79]
    v_fmac_f32 v36, s57, v72
    v_fmac_f32 v37, s57, v73
    v_mfma_f32_16x16x32_bf16 v[76:79], v[176:179], v[228:231], v[76:79]
    v_fmac_f32 v38, s57, v74
    v_fmac_f32 v39, s57, v75
    s_waitcnt lgkmcnt(6)
    v_mfma_f32_16x16x32_bf16 v[76:79], v[160:163], v[112:115], v[76:79]
    v_fmac_f32 v72, s58, v36
    v_fmac_f32 v73, s58, v37
    v_mfma_f32_16x16x32_bf16 v[80:83], v[116:119], v[212:215], v[80:83]
    v_fmac_f32 v74, s58, v38
    v_fmac_f32 v75, s58, v39
    v_mfma_f32_16x16x32_bf16 v[80:83], v[244:247], v[144:147], v[80:83]
    s_waitcnt lgkmcnt(0)
    s_barrier
    v_mfma_f32_16x16x32_bf16 v[80:83], v[140:143], v[228:231], v[80:83]
    v_cvt_pk_bf16_f32 v36, v36, v37
    v_cvt_pk_bf16_f32 v37, v38, v39
    v_mfma_f32_16x16x32_bf16 v[80:83], v[176:179], v[112:115], v[80:83]
    ds_write_b64 v15, v[36:37] offset:2048
    v_cvt_pk_bf16_f32 v72, v72, v73
    v_mfma_f32_16x16x32_bf16 v[80:83], v[160:163], v[216:219], v[80:83]
    v_cvt_pk_bf16_f32 v73, v74, v75
    ds_write_b64 v15, v[72:73] offset:2560
    v_mfma_f32_16x16x32_bf16 v[84:87], v[116:119], v[144:147], v[84:87]
    ds_read_b128 v[116:119], v3 offset:38912
    v_mfma_f32_16x16x32_bf16 v[84:87], v[244:247], v[228:231], v[84:87]
    ds_read_b128 v[244:247], v3 offset:40960
    v_mfma_f32_16x16x32_bf16 v[84:87], v[140:143], v[112:115], v[84:87]
    ds_read_b128 v[140:143], v3 offset:43008
    v_mfma_f32_16x16x32_bf16 v[84:87], v[176:179], v[216:219], v[84:87]
    ds_read_b128 v[176:179], v3 offset:45056
    v_mfma_f32_16x16x32_bf16 v[84:87], v[160:163], v[188:191], v[84:87]
    s_waitcnt lgkmcnt(4)
    s_barrier
    v_mfma_f32_16x16x32_bf16 v[40:43], v[120:123], v[192:195], v[40:43]
    ds_read_b128 v[160:163], v3 offset:47104
    v_mfma_f32_16x16x32_bf16 v[40:43], v[152:155], v[156:159], v[40:43]
    v_mfma_f32_16x16x32_bf16 v[40:43], v[224:227], v[148:151], v[40:43]
    v_mfma_f32_16x16x32_bf16 v[40:43], v[204:207], v[164:167], v[40:43]
    s_waitcnt lgkmcnt(4)
    v_mfma_f32_16x16x32_bf16 v[40:43], v[116:119], v[184:187], v[40:43]
    v_mfma_f32_16x16x32_bf16 v[44:47], v[120:123], v[156:159], v[44:47]
    v_mfma_f32_16x16x32_bf16 v[44:47], v[152:155], v[148:151], v[44:47]
    v_mfma_f32_16x16x32_bf16 v[44:47], v[224:227], v[164:167], v[44:47]
    v_mfma_f32_16x16x32_bf16 v[44:47], v[204:207], v[184:187], v[44:47]
    v_mfma_f32_16x16x32_bf16 v[44:47], v[116:119], v[252:255], v[44:47]
    v_mfma_f32_16x16x32_bf16 v[48:51], v[120:123], v[148:151], v[48:51]
    ds_read_b128 v[120:123], v3 offset:49152
    v_mfma_f32_16x16x32_bf16 v[48:51], v[152:155], v[164:167], v[48:51]
    ds_read_b128 v[152:155], v3 offset:51200
    v_mfma_f32_16x16x32_bf16 v[48:51], v[224:227], v[184:187], v[48:51]
    ds_read_b128 v[224:227], v3 offset:53248
    v_mfma_f32_16x16x32_bf16 v[48:51], v[204:207], v[252:255], v[48:51]
    ds_read_b128 v[204:207], v3 offset:55296
    v_mfma_f32_16x16x32_bf16 v[48:51], v[116:119], v[172:175], v[48:51]
    ds_read_b128 v[116:119], v3 offset:57344
    s_waitcnt lgkmcnt(5)
    v_mfma_f32_16x16x32_bf16 v[76:79], v[244:247], v[124:127], v[76:79]
    v_mfma_f32_16x16x32_bf16 v[76:79], v[140:143], v[208:211], v[76:79]
    v_mfma_f32_16x16x32_bf16 v[76:79], v[176:179], v[236:239], v[76:79]
    v_mfma_f32_16x16x32_bf16 v[76:79], v[160:163], v[220:223], v[76:79]
    s_waitcnt lgkmcnt(4)
    v_mfma_f32_16x16x32_bf16 v[76:79], v[120:123], v[196:199], v[76:79]
    v_mfma_f32_16x16x32_bf16 v[80:83], v[244:247], v[208:211], v[80:83]
    v_mfma_f32_16x16x32_bf16 v[80:83], v[140:143], v[236:239], v[80:83]
    v_mfma_f32_16x16x32_bf16 v[80:83], v[176:179], v[220:223], v[80:83]
    v_mfma_f32_16x16x32_bf16 v[80:83], v[160:163], v[196:199], v[80:83]
    v_mfma_f32_16x16x32_bf16 v[80:83], v[120:123], v[200:203], v[80:83]
    v_mfma_f32_16x16x32_bf16 v[84:87], v[244:247], v[236:239], v[84:87]
    ds_read_b128 v[244:247], v3 offset:59392
    v_mfma_f32_16x16x32_bf16 v[84:87], v[140:143], v[220:223], v[84:87]
    ds_read_b128 v[140:143], v6 offset:0
    v_fmac_f32 v40, s57, v76
    v_mfma_f32_16x16x32_bf16 v[84:87], v[176:179], v[196:199], v[84:87]
    ds_read_b128 v[176:179], v6 offset:2048
    v_fmac_f32 v41, s57, v77
    v_mfma_f32_16x16x32_bf16 v[84:87], v[160:163], v[200:203], v[84:87]
    ds_read_b128 v[160:163], v6 offset:4096
    v_fmac_f32 v42, s57, v78
    v_mfma_f32_16x16x32_bf16 v[84:87], v[120:123], v[132:135], v[84:87]
    ds_read_b128 v[120:123], v6 offset:6144
    v_fmac_f32 v43, s57, v79
    s_waitcnt lgkmcnt(5)
    v_mfma_f32_16x16x32_bf16 v[52:55], v[152:155], v[180:183], v[52:55]
    ds_read_b128 v[180:183], v6 offset:8192
    v_fmac_f32 v76, s58, v40
    v_mfma_f32_16x16x32_bf16 v[52:55], v[224:227], v[168:171], v[52:55]
    v_fmac_f32 v77, s58, v41
    v_fmac_f32 v78, s58, v42
    v_mfma_f32_16x16x32_bf16 v[52:55], v[204:207], v[128:131], v[52:55]
    v_fmac_f32 v79, s58, v43
    v_cvt_pk_bf16_f32 v40, v40, v41
    v_mfma_f32_16x16x32_bf16 v[52:55], v[116:119], v[108:111], v[52:55]
    v_cvt_pk_bf16_f32 v41, v42, v43
    ds_write_b64 v15, v[40:41] offset:12288
    s_waitcnt lgkmcnt(6)
    v_mfma_f32_16x16x32_bf16 v[52:55], v[244:247], v[248:251], v[52:55]
    v_cvt_pk_bf16_f32 v76, v76, v77
    v_cvt_pk_bf16_f32 v77, v78, v79
    v_mfma_f32_16x16x32_bf16 v[56:59], v[152:155], v[168:171], v[56:59]
    ds_write_b64 v15, v[76:77] offset:12800
    v_fmac_f32 v44, s57, v80
    v_mfma_f32_16x16x32_bf16 v[56:59], v[224:227], v[128:131], v[56:59]
    v_fmac_f32 v45, s57, v81
    v_fmac_f32 v46, s57, v82
    v_mfma_f32_16x16x32_bf16 v[56:59], v[204:207], v[108:111], v[56:59]
    v_fmac_f32 v47, s57, v83
    v_fmac_f32 v80, s58, v44
    v_mfma_f32_16x16x32_bf16 v[56:59], v[116:119], v[248:251], v[56:59]
    v_fmac_f32 v81, s58, v45
    v_fmac_f32 v82, s58, v46
    v_mfma_f32_16x16x32_bf16 v[56:59], v[244:247], v[240:243], v[56:59]
    s_waitcnt lgkmcnt(0)
    s_barrier
    v_mfma_f32_16x16x32_bf16 v[60:63], v[152:155], v[128:131], v[60:63]
    ds_read_b128 v[168:171], v6 offset:10240
    v_fmac_f32 v83, s58, v47
    v_mfma_f32_16x16x32_bf16 v[60:63], v[224:227], v[108:111], v[60:63]
    ds_read_b128 v[128:131], v6 offset:12288
    v_cvt_pk_bf16_f32 v44, v44, v45
    v_mfma_f32_16x16x32_bf16 v[60:63], v[204:207], v[248:251], v[60:63]
    ds_read_b128 v[152:155], v6 offset:14336
    v_cvt_pk_bf16_f32 v45, v46, v47
    v_mfma_f32_16x16x32_bf16 v[60:63], v[116:119], v[240:243], v[60:63]
    ds_read_b128 v[108:111], v6 offset:16384
    ds_write_b64 v15, v[44:45] offset:13312
    v_mfma_f32_16x16x32_bf16 v[60:63], v[244:247], v[136:139], v[60:63]
    ds_read_b128 v[224:227], v6 offset:18432
    v_cvt_pk_bf16_f32 v80, v80, v81
    v_mfma_f32_16x16x32_bf16 v[88:91], v[140:143], v[232:235], v[88:91]
    ds_read_b128 v[248:251], v6 offset:20480
    v_cvt_pk_bf16_f32 v81, v82, v83
    v_mfma_f32_16x16x32_bf16 v[88:91], v[176:179], v[212:215], v[88:91]
    ds_read_b128 v[204:207], v6 offset:22528
    ds_write_b64 v15, v[80:81] offset:13824
    v_mfma_f32_16x16x32_bf16 v[88:91], v[160:163], v[144:147], v[88:91]
    ds_read_b128 v[240:243], v6 offset:24576
    v_fmac_f32 v48, s57, v84
    v_mfma_f32_16x16x32_bf16 v[88:91], v[120:123], v[228:231], v[88:91]
    ds_read_b128 v[116:119], v6 offset:26624
    v_fmac_f32 v49, s57, v85
    v_mfma_f32_16x16x32_bf16 v[88:91], v[180:183], v[112:115], v[88:91]
    ds_read_b128 v[136:139], v6 offset:28672
    v_fmac_f32 v50, s57, v86
    v_mfma_f32_16x16x32_bf16 v[92:95], v[140:143], v[212:215], v[92:95]
    v_fmac_f32 v51, s57, v87
    v_fmac_f32 v84, s58, v48
    v_mfma_f32_16x16x32_bf16 v[92:95], v[176:179], v[144:147], v[92:95]
    s_waitcnt lgkmcnt(3)
    s_barrier
    v_mfma_f32_16x16x32_bf16 v[92:95], v[160:163], v[228:231], v[92:95]
    v_fmac_f32 v85, s58, v49
    v_fmac_f32 v86, s58, v50
    v_mfma_f32_16x16x32_bf16 v[92:95], v[120:123], v[112:115], v[92:95]
    v_fmac_f32 v87, s58, v51
    v_cvt_pk_bf16_f32 v48, v48, v49
    v_mfma_f32_16x16x32_bf16 v[92:95], v[180:183], v[216:219], v[92:95]
    v_cvt_pk_bf16_f32 v49, v50, v51
    ds_write_b64 v15, v[48:49] offset:14336
    v_mfma_f32_16x16x32_bf16 v[96:99], v[140:143], v[144:147], v[96:99]
    v_cvt_pk_bf16_f32 v84, v84, v85
    v_cvt_pk_bf16_f32 v85, v86, v87
    v_mfma_f32_16x16x32_bf16 v[96:99], v[176:179], v[228:231], v[96:99]
    ds_write_b64 v15, v[84:85] offset:14848
    v_mfma_f32_16x16x32_bf16 v[96:99], v[160:163], v[112:115], v[96:99]
    v_mfma_f32_16x16x32_bf16 v[96:99], v[120:123], v[216:219], v[96:99]
    v_mfma_f32_16x16x32_bf16 v[96:99], v[180:183], v[188:191], v[96:99]
    v_mfma_f32_16x16x32_bf16 v[52:55], v[168:171], v[192:195], v[52:55]
    s_waitcnt lgkmcnt(0)
    s_barrier
    v_mfma_f32_16x16x32_bf16 v[52:55], v[128:131], v[156:159], v[52:55]
    v_mfma_f32_16x16x32_bf16 v[52:55], v[152:155], v[148:151], v[52:55]
    v_mfma_f32_16x16x32_bf16 v[52:55], v[108:111], v[164:167], v[52:55]
    v_mfma_f32_16x16x32_bf16 v[52:55], v[224:227], v[184:187], v[52:55]
    v_mfma_f32_16x16x32_bf16 v[88:91], v[248:251], v[124:127], v[88:91]
    v_mfma_f32_16x16x32_bf16 v[88:91], v[204:207], v[208:211], v[88:91]
    v_mfma_f32_16x16x32_bf16 v[88:91], v[240:243], v[236:239], v[88:91]
    v_mfma_f32_16x16x32_bf16 v[88:91], v[116:119], v[220:223], v[88:91]
    v_mfma_f32_16x16x32_bf16 v[88:91], v[136:139], v[196:199], v[88:91]
    v_mfma_f32_16x16x32_bf16 v[56:59], v[168:171], v[156:159], v[56:59]
    v_mfma_f32_16x16x32_bf16 v[56:59], v[128:131], v[148:151], v[56:59]
    v_mfma_f32_16x16x32_bf16 v[56:59], v[152:155], v[164:167], v[56:59]
    v_mfma_f32_16x16x32_bf16 v[56:59], v[108:111], v[184:187], v[56:59]
    v_mfma_f32_16x16x32_bf16 v[56:59], v[224:227], v[252:255], v[56:59]
    v_mfma_f32_16x16x32_bf16 v[92:95], v[248:251], v[208:211], v[92:95]
    v_mfma_f32_16x16x32_bf16 v[92:95], v[204:207], v[236:239], v[92:95]
    v_mfma_f32_16x16x32_bf16 v[92:95], v[240:243], v[220:223], v[92:95]
    v_fmac_f32 v52, s57, v88
    v_fmac_f32 v53, s57, v89
    v_mfma_f32_16x16x32_bf16 v[92:95], v[116:119], v[196:199], v[92:95]
    v_fmac_f32 v54, s57, v90
    v_fmac_f32 v55, s57, v91
    v_mfma_f32_16x16x32_bf16 v[92:95], v[136:139], v[200:203], v[92:95]
    v_fmac_f32 v88, s58, v52
    v_fmac_f32 v89, s58, v53
    v_mfma_f32_16x16x32_bf16 v[60:63], v[168:171], v[148:151], v[60:63]
    v_fmac_f32 v90, s58, v54
    v_fmac_f32 v91, s58, v55
    v_mfma_f32_16x16x32_bf16 v[60:63], v[128:131], v[164:167], v[60:63]
    v_cvt_pk_bf16_f32 v52, v52, v53
    v_cvt_pk_bf16_f32 v53, v54, v55
    v_mfma_f32_16x16x32_bf16 v[60:63], v[152:155], v[184:187], v[60:63]
    ds_write_b64 v15, v[52:53] offset:0
    v_cvt_pk_bf16_f32 v88, v88, v89
    v_mfma_f32_16x16x32_bf16 v[60:63], v[108:111], v[252:255], v[60:63]
    v_cvt_pk_bf16_f32 v89, v90, v91
    ds_write_b64 v15, v[88:89] offset:512
    v_mfma_f32_16x16x32_bf16 v[60:63], v[224:227], v[172:175], v[60:63]
    v_fmac_f32 v56, s57, v92
    v_fmac_f32 v57, s57, v93
    v_mfma_f32_16x16x32_bf16 v[96:99], v[248:251], v[236:239], v[96:99]
    v_fmac_f32 v58, s57, v94
    v_fmac_f32 v59, s57, v95
    v_mfma_f32_16x16x32_bf16 v[96:99], v[204:207], v[220:223], v[96:99]
    v_fmac_f32 v92, s58, v56
    v_fmac_f32 v93, s58, v57
    v_mfma_f32_16x16x32_bf16 v[96:99], v[240:243], v[196:199], v[96:99]
    v_fmac_f32 v94, s58, v58
    v_fmac_f32 v95, s58, v59
    v_mfma_f32_16x16x32_bf16 v[96:99], v[116:119], v[200:203], v[96:99]
    s_waitcnt lgkmcnt(0)
    s_barrier
    v_mfma_f32_16x16x32_bf16 v[96:99], v[136:139], v[132:135], v[96:99]
    v_cvt_pk_bf16_f32 v56, v56, v57
    v_cvt_pk_bf16_f32 v57, v58, v59
    ds_write_b64 v15, v[56:57] offset:1024
    v_cvt_pk_bf16_f32 v92, v92, v93
    v_cvt_pk_bf16_f32 v93, v94, v95
    ds_write_b64 v15, v[92:93] offset:1536
    s_nop 2
    v_fmac_f32 v60, s57, v96
    v_fmac_f32 v61, s57, v97
    v_fmac_f32 v62, s57, v98
    v_fmac_f32 v63, s57, v99
    v_fmac_f32 v96, s58, v60
    v_fmac_f32 v97, s58, v61
    v_fmac_f32 v98, s58, v62
    v_fmac_f32 v99, s58, v63
    v_cvt_pk_bf16_f32 v60, v60, v61
    v_cvt_pk_bf16_f32 v61, v62, v63
    s_waitcnt lgkmcnt(0)
    s_barrier
    ds_write_b64 v15, v[60:61] offset:2048
    v_cvt_pk_bf16_f32 v96, v96, v97
    v_cvt_pk_bf16_f32 v97, v98, v99
    ds_write_b64 v15, v[96:97] offset:2560
    s_waitcnt lgkmcnt(0)
    s_endpgm
L_c1:
    s_mov_b32 s16, s6
    s_and_b32 s17, s7, 0xffff
    s_mov_b32 s18, 0x70800
    s_mov_b32 s19, 0x20000
    v_lshlrev_b32 v22, 4, v0
    v_and_b32 v23, 32, v0
    v_xor_b32 v23, v23, v22
    v_xor_b32 v24, 32, v22
    s_mov_b32 s47, 0x3f160000
    s_mov_b32 s48, 0x3f779498
    s_mov_b32 s49, 0xbecbe3c8
    s_mov_b32 s56, 0x3f03c3c4
    s_mov_b32 s57, 0xbf4ccccd
    s_mov_b32 s58, 0x3f200000
    s_waitcnt vmcnt(15)
    s_barrier
    ds_read_b64_tr_b16 v[108:109], v3 offset:0
    ds_read_b64_tr_b16 v[110:111], v3 offset:768
    ds_read_b128 v[112:115], v25 offset:0
    ds_read_b64_tr_b16 v[116:117], v3 offset:6144
    ds_read_b64_tr_b16 v[118:119], v3 offset:6912
    ds_read_b128 v[120:123], v1 offset:512
    ds_read_b64_tr_b16 v[124:125], v3 offset:12288
    ds_read_b64_tr_b16 v[126:127], v3 offset:13056
    ds_read_b128 v[128:131], v25 offset:1024
    ds_read_b64_tr_b16 v[132:133], v3 offset:18432
    ds_read_b64_tr_b16 v[134:135], v3 offset:19200
    ds_read_b128 v[136:139], v1 offset:1536
    ds_read_b64_tr_b16 v[140:141], v3 offset:24576
    ds_read_b64_tr_b16 v[142:143], v3 offset:25344
    ds_read_b128 v[144:147], v25 offset:2048
    s_waitcnt lgkmcnt(12)
    v_mfma_f32_16x16x32_bf16 v[28:31], v[108:111], v[112:115], 0
    ds_read_b128 v[148:151], v1 offset:2560
    ds_read_b128 v[152:155], v26 offset:1536
    s_waitcnt lgkmcnt(11)
    v_mfma_f32_16x16x32_bf16 v[28:31], v[116:119], v[120:123], v[28:31]
    ds_read_b128 v[156:159], v2 offset:2048
    s_waitcnt lgkmcnt(9)
    v_mfma_f32_16x16x32_bf16 v[28:31], v[124:127], v[128:131], v[28:31]
    ds_read_b128 v[160:163], v25 offset:3072
    s_waitcnt lgkmcnt(7)
    v_mfma_f32_16x16x32_bf16 v[28:31], v[132:135], v[136:139], v[28:31]
    ds_read_b64_tr_b16 v[164:165], v4 offset:0
    s_waitcnt lgkmcnt(5)
    v_mfma_f32_16x16x32_bf16 v[28:31], v[140:143], v[144:147], v[28:31]
    ds_read_b64_tr_b16 v[166:167], v4 offset:768
    v_mfma_f32_16x16x32_bf16 v[32:35], v[108:111], v[120:123], 0
    ds_read_b64_tr_b16 v[168:169], v4 offset:6144
    v_mfma_f32_16x16x32_bf16 v[32:35], v[116:119], v[128:131], v[32:35]
    ds_read_b64_tr_b16 v[170:171], v4 offset:6912
    v_mfma_f32_16x16x32_bf16 v[32:35], v[124:127], v[136:139], v[32:35]
    ds_read_b64_tr_b16 v[172:173], v4 offset:12288
    v_mfma_f32_16x16x32_bf16 v[32:35], v[132:135], v[144:147], v[32:35]
    ds_read_b64_tr_b16 v[174:175], v4 offset:13056
    s_waitcnt lgkmcnt(8)
    v_mfma_f32_16x16x32_bf16 v[32:35], v[140:143], v[148:151], v[32:35]
    ds_read_b64_tr_b16 v[176:177], v4 offset:18432
    ds_read_b64_tr_b16 v[178:179], v4 offset:19200
    v_mfma_f32_16x16x32_bf16 v[100:103], v[132:135], v[152:155], 0
    ds_read_b64_tr_b16 v[180:181], v4 offset:24576
    ds_read_b64_tr_b16 v[182:183], v4 offset:25344
    s_waitcnt lgkmcnt(10)
    v_mfma_f32_16x16x32_bf16 v[100:103], v[140:143], v[156:159], v[100:103]
    ds_read_b64_tr_b16 v[184:185], v5 offset:0
    ds_read_b64_tr_b16 v[186:187], v5 offset:768
    v_mfma_f32_16x16x32_bf16 v[36:39], v[108:111], v[128:131], 0
    ds_read_b64_tr_b16 v[188:189], v5 offset:6144
    ds_read_b64_tr_b16 v[190:191], v5 offset:6912
    v_mfma_f32_16x16x32_bf16 v[36:39], v[116:119], v[136:139], v[36:39]
    ds_read_b64_tr_b16 v[192:193], v5 offset:12288
    ds_read_b64_tr_b16 v[194:195], v5 offset:13056
    v_mfma_f32_16x16x32_bf16 v[36:39], v[124:127], v[144:147], v[36:39]
    ds_read_b64_tr_b16 v[196:197], v5 offset:18432
    ds_read_b64_tr_b16 v[198:199], v5 offset:19200
    v_mfma_f32_16x16x32_bf16 v[36:39], v[132:135], v[148:151], v[36:39]
    ds_read_b64_tr_b16 v[200:201], v5 offset:24576
    ds_read_b64_tr_b16 v[202:203], v5 offset:25344
    v_mfma_f32_16x16x32_bf16 v[36:39], v[140:143], v[160:163], v[36:39]
    s_waitcnt lgkmcnt(14)
    v_mfma_f32_16x16x32_bf16 v[40:43], v[164:167], v[112:115], 0
    v_mfma_f32_16x16x32_bf16 v[40:43], v[168:171], v[120:123], v[40:43]
    v_mfma_f32_16x16x32_bf16 v[40:43], v[172:175], v[128:131], v[40:43]
    s_waitcnt lgkmcnt(8)
    v_mfma_f32_16x16x32_bf16 v[40:43], v[176:179], v[136:139], v[40:43]
    s_waitcnt lgkmcnt(0)
    s_waitcnt vmcnt(0)
    s_barrier
    v_mfma_f32_16x16x32_bf16 v[40:43], v[180:183], v[144:147], v[40:43]
    ds_read_b64_tr_b16 v[204:205], v3 offset:30720
    v_mfma_f32_16x16x32_bf16 v[44:47], v[164:167], v[120:123], 0
    ds_read_b64_tr_b16 v[206:207], v3 offset:31488
    v_mfma_f32_16x16x32_bf16 v[44:47], v[168:171], v[128:131], v[44:47]
    ds_read_b128 v[208:211], v25 offset:10240
    v_mfma_f32_16x16x32_bf16 v[44:47], v[172:175], v[136:139], v[44:47]
    ds_read_b64_tr_b16 v[212:213], v3 offset:36864
    v_mfma_f32_16x16x32_bf16 v[44:47], v[176:179], v[144:147], v[44:47]
    ds_read_b64_tr_b16 v[214:215], v3 offset:37632
    v_mfma_f32_16x16x32_bf16 v[44:47], v[180:183], v[148:151], v[44:47]
    ds_read_b128 v[216:219], v1 offset:10752
    v_mfma_f32_16x16x32_bf16 v[48:51], v[164:167], v[128:131], 0
    ds_read_b64_tr_b16 v[220:221], v3 offset:43008
    v_mfma_f32_16x16x32_bf16 v[48:51], v[168:171], v[136:139], v[48:51]
    ds_read_b64_tr_b16 v[222:223], v3 offset:43776
    v_mfma_f32_16x16x32_bf16 v[48:51], v[172:175], v[144:147], v[48:51]
    ds_read_b128 v[224:227], v25 offset:11264
    v_mfma_f32_16x16x32_bf16 v[48:51], v[176:179], v[148:151], v[48:51]
    ds_read_b64_tr_b16 v[228:229], v3 offset:49152
    v_mfma_f32_16x16x32_bf16 v[48:51], v[180:183], v[160:163], v[48:51]
    ds_read_b64_tr_b16 v[230:231], v3 offset:49920
    v_mfma_f32_16x16x32_bf16 v[52:55], v[184:187], v[112:115], 0
    ds_read_b128 v[232:235], v1 offset:11776
    v_mfma_f32_16x16x32_bf16 v[52:55], v[188:191], v[120:123], v[52:55]
    ds_read_b64_tr_b16 v[236:237], v3 offset:55296
    v_mfma_f32_16x16x32_bf16 v[52:55], v[192:195], v[128:131], v[52:55]
    ds_read_b64_tr_b16 v[238:239], v3 offset:56064
    v_mfma_f32_16x16x32_bf16 v[52:55], v[196:199], v[136:139], v[52:55]
    ds_read_b128 v[240:243], v25 offset:12288
    v_mfma_f32_16x16x32_bf16 v[52:55], v[200:203], v[144:147], v[52:55]
    ds_read_b128 v[244:247], v1 offset:12800
    v_mfma_f32_16x16x32_bf16 v[56:59], v[184:187], v[120:123], 0
    ds_read_b128 v[248:251], v2 offset:11264
    v_mfma_f32_16x16x32_bf16 v[56:59], v[188:191], v[128:131], v[56:59]
    ds_read_b128 v[252:255], v26 offset:11776
    v_mfma_f32_16x16x32_bf16 v[56:59], v[192:195], v[136:139], v[56:59]
    ds_read_b128 v[152:155], v2 offset:12288
    v_mfma_f32_16x16x32_bf16 v[56:59], v[196:199], v[144:147], v[56:59]
    ds_read_b128 v[156:159], v25 offset:13312
    v_mfma_f32_16x16x32_bf16 v[56:59], v[200:203], v[148:151], v[56:59]
    ds_read_b64_tr_b16 v[108:109], v4 offset:30720
    v_mfma_f32_16x16x32_bf16 v[60:63], v[184:187], v[128:131], 0
    ds_read_b64_tr_b16 v[110:111], v4 offset:31488
    v_mfma_f32_16x16x32_bf16 v[60:63], v[188:191], v[136:139], v[60:63]
    ds_read_b64_tr_b16 v[116:117], v4 offset:36864
    v_mfma_f32_16x16x32_bf16 v[60:63], v[192:195], v[144:147], v[60:63]
    ds_read_b64_tr_b16 v[118:119], v4 offset:37632
    v_mfma_f32_16x16x32_bf16 v[60:63], v[196:199], v[148:151], v[60:63]
    ds_read_b64_tr_b16 v[124:125], v4 offset:43008
    v_mfma_f32_16x16x32_bf16 v[60:63], v[200:203], v[160:163], v[60:63]
    ds_read_b64_tr_b16 v[126:127], v4 offset:43776
    s_waitcnt lgkmcnt(8)
    v_mfma_f32_16x16x32_bf16 v[64:67], v[204:207], v[208:211], 0
    ds_read_b64_tr_b16 v[132:133], v4 offset:49152
    v_mfma_f32_16x16x32_bf16 v[64:67], v[212:215], v[216:219], v[64:67]
    ds_read_b64_tr_b16 v[134:135], v4 offset:49920
    v_mfma_f32_16x16x32_bf16 v[64:67], v[220:223], v[224:227], v[64:67]
    ds_read_b64_tr_b16 v[140:141], v4 offset:55296
    v_mfma_f32_16x16x32_bf16 v[64:67], v[228:231], v[232:235], v[64:67]
    ds_read_b64_tr_b16 v[142:143], v4 offset:56064
    ds_read_b64_tr_b16 v[164:165], v5 offset:30720
    v_mfma_f32_16x16x32_bf16 v[64:67], v[236:239], v[240:243], v[64:67]
    ds_read_b64_tr_b16 v[166:167], v5 offset:31488
    ds_read_b64_tr_b16 v[168:169], v5 offset:36864
    v_mfma_f32_16x16x32_bf16 v[68:71], v[204:207], v[216:219], 0
    ds_read_b64_tr_b16 v[170:171], v5 offset:37632
    ds_read_b64_tr_b16 v[172:173], v5 offset:43008
    v_mfma_f32_16x16x32_bf16 v[68:71], v[212:215], v[224:227], v[68:71]
    ds_read_b64_tr_b16 v[174:175], v5 offset:43776
    ds_read_b64_tr_b16 v[176:177], v5 offset:49152
    v_mfma_f32_16x16x32_bf16 v[68:71], v[220:223], v[232:235], v[68:71]
    ds_read_b64_tr_b16 v[178:179], v5 offset:49920
    ds_read_b64_tr_b16 v[180:181], v5 offset:55296
    v_mfma_f32_16x16x32_bf16 v[68:71], v[228:231], v[240:243], v[68:71]
    ds_read_b64_tr_b16 v[182:183], v5 offset:56064
    v_mfma_f32_16x16x32_bf16 v[68:71], v[236:239], v[244:247], v[68:71]
    v_mfma_f32_16x16x32_bf16 v[104:107], v[220:223], v[248:251], 0
    v_mfma_f32_16x16x32_bf16 v[104:107], v[228:231], v[252:255], v[104:107]
    s_waitcnt lgkmcnt(9)
    v_mfma_f32_16x16x32_bf16 v[104:107], v[236:239], v[152:155], v[104:107]
    v_mfma_f32_16x16x32_bf16 v[72:75], v[204:207], v[224:227], 0
    v_mfma_f32_16x16x32_bf16 v[72:75], v[212:215], v[232:235], v[72:75]
    s_waitcnt lgkmcnt(0)
    s_barrier
    v_mfma_f32_16x16x32_bf16 v[72:75], v[220:223], v[240:243], v[72:75]
    ds_read_b64_tr_b16 v[112:113], v6 offset:0
    v_mfma_f32_16x16x32_bf16 v[72:75], v[228:231], v[244:247], v[72:75]
    ds_read_b64_tr_b16 v[114:115], v6 offset:768
    v_mfma_f32_16x16x32_bf16 v[72:75], v[236:239], v[156:159], v[72:75]
    ds_read_b64_tr_b16 v[120:121], v6 offset:6144
    v_mfma_f32_16x16x32_bf16 v[76:79], v[108:111], v[208:211], 0
    ds_read_b128 v[128:131], v25 offset:20480
    v_mfma_f32_16x16x32_bf16 v[76:79], v[116:119], v[216:219], v[76:79]
    ds_read_b64_tr_b16 v[122:123], v6 offset:6912
    v_mfma_f32_16x16x32_bf16 v[76:79], v[124:127], v[224:227], v[76:79]
    ds_read_b128 v[184:187], v1 offset:20992
    v_mfma_f32_16x16x32_bf16 v[76:79], v[132:135], v[232:235], v[76:79]
    ds_read_b64_tr_b16 v[136:137], v6 offset:12288
    v_mfma_f32_16x16x32_bf16 v[76:79], v[140:143], v[240:243], v[76:79]
    ds_read_b64_tr_b16 v[138:139], v6 offset:13056
    v_mfma_f32_16x16x32_bf16 v[80:83], v[108:111], v[216:219], 0
    ds_read_b128 v[188:191], v25 offset:21504
    v_mfma_f32_16x16x32_bf16 v[80:83], v[116:119], v[224:227], v[80:83]
    ds_read_b64_tr_b16 v[144:145], v6 offset:18432
    v_mfma_f32_16x16x32_bf16 v[80:83], v[124:127], v[232:235], v[80:83]
    ds_read_b64_tr_b16 v[146:147], v6 offset:19200
    v_mfma_f32_16x16x32_bf16 v[80:83], v[132:135], v[240:243], v[80:83]
    ds_read_b128 v[192:195], v1 offset:22016
    v_mfma_f32_16x16x32_bf16 v[80:83], v[140:143], v[244:247], v[80:83]
    ds_read_b64_tr_b16 v[148:149], v6 offset:24576
    v_mfma_f32_16x16x32_bf16 v[84:87], v[108:111], v[224:227], 0
    ds_read_b64_tr_b16 v[150:151], v6 offset:25344
    v_mfma_f32_16x16x32_bf16 v[84:87], v[116:119], v[232:235], v[84:87]
    ds_read_b128 v[196:199], v25 offset:22528
    v_mfma_f32_16x16x32_bf16 v[84:87], v[124:127], v[240:243], v[84:87]
    ds_read_b128 v[160:163], v1 offset:23040
    v_mfma_f32_16x16x32_bf16 v[84:87], v[132:135], v[244:247], v[84:87]
    ds_read_b128 v[200:203], v2 offset:21504
    v_mfma_f32_16x16x32_bf16 v[84:87], v[140:143], v[156:159], v[84:87]
    ds_read_b128 v[248:251], v26 offset:22016
    v_mfma_f32_16x16x32_bf16 v[88:91], v[164:167], v[208:211], 0
    ds_read_b128 v[252:255], v2 offset:22528
    v_mfma_f32_16x16x32_bf16 v[88:91], v[168:171], v[216:219], v[88:91]
    ds_read_b64_tr_b16 v[152:153], v7 offset:0
    v_mfma_f32_16x16x32_bf16 v[88:91], v[172:175], v[224:227], v[88:91]
    ds_read_b128 v[204:207], v25 offset:23552
    v_mfma_f32_16x16x32_bf16 v[88:91], v[176:179], v[232:235], v[88:91]
    ds_read_b64_tr_b16 v[154:155], v7 offset:768
    v_mfma_f32_16x16x32_bf16 v[88:91], v[180:183], v[240:243], v[88:91]
    ds_read_b64_tr_b16 v[212:213], v7 offset:6144
    v_mfma_f32_16x16x32_bf16 v[92:95], v[164:167], v[216:219], 0
    ds_read_b64_tr_b16 v[214:215], v7 offset:6912
    v_mfma_f32_16x16x32_bf16 v[92:95], v[168:171], v[224:227], v[92:95]
    ds_read_b64_tr_b16 v[220:221], v7 offset:12288
    v_mfma_f32_16x16x32_bf16 v[92:95], v[172:175], v[232:235], v[92:95]
    ds_read_b64_tr_b16 v[222:223], v7 offset:13056
    v_mfma_f32_16x16x32_bf16 v[92:95], v[176:179], v[240:243], v[92:95]
    ds_read_b64_tr_b16 v[228:229], v7 offset:18432
    v_mfma_f32_16x16x32_bf16 v[92:95], v[180:183], v[244:247], v[92:95]
    ds_read_b64_tr_b16 v[230:231], v7 offset:19200
    v_mfma_f32_16x16x32_bf16 v[96:99], v[164:167], v[224:227], 0
    ds_read_b64_tr_b16 v[236:237], v7 offset:24576
    v_mfma_f32_16x16x32_bf16 v[96:99], v[168:171], v[232:235], v[96:99]
    ds_read_b64_tr_b16 v[238:239], v7 offset:25344
    v_mfma_f32_16x16x32_bf16 v[96:99], v[172:175], v[240:243], v[96:99]
    ds_read_b64_tr_b16 v[108:109], v8 offset:0
    v_mfma_f32_16x16x32_bf16 v[96:99], v[176:179], v[244:247], v[96:99]
    ds_read_b64_tr_b16 v[110:111], v8 offset:768
    v_mfma_f32_16x16x32_bf16 v[96:99], v[180:183], v[156:159], v[96:99]
    ds_read_b64_tr_b16 v[116:117], v8 offset:6144
    s_waitcnt lgkmcnt(8)
    v_mfma_f32_16x16x32_bf16 v[28:31], v[112:115], v[128:131], v[28:31]
    ds_read_b64_tr_b16 v[118:119], v8 offset:6912
    v_mfma_f32_16x16x32_bf16 v[28:31], v[120:123], v[184:187], v[28:31]
    ds_read_b64_tr_b16 v[124:125], v8 offset:12288
    v_mfma_f32_16x16x32_bf16 v[28:31], v[136:139], v[188:191], v[28:31]
    ds_read_b64_tr_b16 v[126:127], v8 offset:13056
    v_mfma_f32_16x16x32_bf16 v[28:31], v[144:147], v[192:195], v[28:31]
    ds_read_b64_tr_b16 v[132:133], v8 offset:18432
    ds_read_b64_tr_b16 v[134:135], v8 offset:19200
    v_mfma_f32_16x16x32_bf16 v[28:31], v[148:151], v[196:199], v[28:31]
    ds_read_b64_tr_b16 v[140:141], v8 offset:24576
    ds_read_b64_tr_b16 v[142:143], v8 offset:25344
    v_mfma_f32_16x16x32_bf16 v[32:35], v[112:115], v[184:187], v[32:35]
    v_mfma_f32_16x16x32_bf16 v[32:35], v[120:123], v[188:191], v[32:35]
    v_mfma_f32_16x16x32_bf16 v[32:35], v[136:139], v[192:195], v[32:35]
    v_mfma_f32_16x16x32_bf16 v[32:35], v[144:147], v[196:199], v[32:35]
    v_mfma_f32_16x16x32_bf16 v[32:35], v[148:151], v[160:163], v[32:35]
    v_mfma_f32_16x16x32_bf16 v[100:103], v[136:139], v[200:203], v[100:103]
    v_mfma_f32_16x16x32_bf16 v[100:103], v[144:147], v[248:251], v[100:103]
    v_mfma_f32_16x16x32_bf16 v[100:103], v[148:151], v[252:255], v[100:103]
    v_mfma_f32_16x16x32_bf16 v[36:39], v[112:115], v[188:191], v[36:39]
    v_mfma_f32_16x16x32_bf16 v[36:39], v[120:123], v[192:195], v[36:39]
    s_waitcnt lgkmcnt(0)
    s_barrier
    v_mfma_f32_16x16x32_bf16 v[36:39], v[136:139], v[196:199], v[36:39]
    v_mfma_f32_16x16x32_bf16 v[36:39], v[144:147], v[160:163], v[36:39]
    v_mfma_f32_16x16x32_bf16 v[36:39], v[148:151], v[204:207], v[36:39]
    v_mfma_f32_16x16x32_bf16 v[40:43], v[152:155], v[128:131], v[40:43]
    v_mfma_f32_16x16x32_bf16 v[40:43], v[212:215], v[184:187], v[40:43]
    v_mfma_f32_16x16x32_bf16 v[40:43], v[220:223], v[188:191], v[40:43]
    v_mfma_f32_16x16x32_bf16 v[40:43], v[228:231], v[192:195], v[40:43]
    ds_read_b64_tr_b16 v[208:209], v3 offset:0
    v_mfma_f32_16x16x32_bf16 v[40:43], v[236:239], v[196:199], v[40:43]
    ds_read_b64_tr_b16 v[210:211], v3 offset:768
    v_mfma_f32_16x16x32_bf16 v[44:47], v[152:155], v[184:187], v[44:47]
    ds_read_b128 v[216:219], v25 offset:30720
    v_mfma_f32_16x16x32_bf16 v[44:47], v[212:215], v[188:191], v[44:47]
    s_branch L_is8
.p2align 12
L_pg8:
    s_setpc_b64 s[62:63]
L_is8:
    ds_read_b64_tr_b16 v[224:225], v3 offset:6144
    v_mfma_f32_16x16x32_bf16 v[44:47], v[220:223], v[192:195], v[44:47]
    ds_read_b64_tr_b16 v[226:227], v3 offset:6912
    v_mfma_f32_16x16x32_bf16 v[44:47], v[228:231], v[196:199], v[44:47]
    ds_read_b128 v[164:167], v1 offset:31232
    v_mfma_f32_16x16x32_bf16 v[44:47], v[236:239], v[160:163], v[44:47]
    ds_read_b64_tr_b16 v[232:233], v3 offset:12288
    v_mfma_f32_16x16x32_bf16 v[48:51], v[152:155], v[188:191], v[48:51]
    ds_read_b64_tr_b16 v[234:235], v3 offset:13056
    v_mfma_f32_16x16x32_bf16 v[48:51], v[212:215], v[192:195], v[48:51]
    ds_read_b128 v[168:171], v25 offset:31744
    v_mfma_f32_16x16x32_bf16 v[48:51], v[220:223], v[196:199], v[48:51]
    ds_read_b64_tr_b16 v[240:241], v3 offset:18432
    v_mfma_f32_16x16x32_bf16 v[48:51], v[228:231], v[160:163], v[48:51]
    ds_read_b64_tr_b16 v[242:243], v3 offset:19200
    v_mfma_f32_16x16x32_bf16 v[48:51], v[236:239], v[204:207], v[48:51]
    ds_read_b128 v[172:175], v1 offset:32256
    v_mfma_f32_16x16x32_bf16 v[52:55], v[108:111], v[128:131], v[52:55]
    ds_read_b64_tr_b16 v[244:245], v3 offset:24576
    v_mfma_f32_16x16x32_bf16 v[52:55], v[116:119], v[184:187], v[52:55]
    ds_read_b64_tr_b16 v[246:247], v3 offset:25344
    v_mfma_f32_16x16x32_bf16 v[52:55], v[124:127], v[188:191], v[52:55]
    ds_read_b128 v[176:179], v25 offset:32768
    v_mfma_f32_16x16x32_bf16 v[52:55], v[132:135], v[192:195], v[52:55]
    ds_read_b128 v[156:159], v1 offset:33280
    v_mfma_f32_16x16x32_bf16 v[52:55], v[140:143], v[196:199], v[52:55]
    ds_read_b128 v[180:183], v26 offset:32256
    v_mfma_f32_16x16x32_bf16 v[56:59], v[108:111], v[184:187], v[56:59]
    ds_read_b128 v[200:203], v2 offset:32768
    v_mfma_f32_16x16x32_bf16 v[56:59], v[116:119], v[188:191], v[56:59]
    ds_read_b128 v[248:251], v25 offset:33792
    v_mfma_f32_16x16x32_bf16 v[56:59], v[124:127], v[192:195], v[56:59]
    ds_read_b64_tr_b16 v[252:253], v4 offset:0
    v_mfma_f32_16x16x32_bf16 v[56:59], v[132:135], v[196:199], v[56:59]
    ds_read_b64_tr_b16 v[254:255], v4 offset:768
    v_mfma_f32_16x16x32_bf16 v[56:59], v[140:143], v[160:163], v[56:59]
    ds_read_b64_tr_b16 v[112:113], v4 offset:6144
    v_mfma_f32_16x16x32_bf16 v[60:63], v[108:111], v[188:191], v[60:63]
    ds_read_b64_tr_b16 v[114:115], v4 offset:6912
    v_mfma_f32_16x16x32_bf16 v[60:63], v[116:119], v[192:195], v[60:63]
    ds_read_b64_tr_b16 v[120:121], v4 offset:12288
    v_mfma_f32_16x16x32_bf16 v[60:63], v[124:127], v[196:199], v[60:63]
    ds_read_b64_tr_b16 v[122:123], v4 offset:13056
    v_mfma_f32_16x16x32_bf16 v[60:63], v[132:135], v[160:163], v[60:63]
    ds_read_b64_tr_b16 v[136:137], v4 offset:18432
    v_mfma_f32_16x16x32_bf16 v[60:63], v[140:143], v[204:207], v[60:63]
    ds_read_b64_tr_b16 v[138:139], v4 offset:19200
    s_waitcnt lgkmcnt(8)
    v_mfma_f32_16x16x32_bf16 v[64:67], v[208:211], v[216:219], v[64:67]
    ds_read_b64_tr_b16 v[144:145], v4 offset:24576
    v_mfma_f32_16x16x32_bf16 v[64:67], v[224:227], v[164:167], v[64:67]
    ds_read_b64_tr_b16 v[146:147], v4 offset:25344
    v_mfma_f32_16x16x32_bf16 v[64:67], v[232:235], v[168:171], v[64:67]
    ds_read_b64_tr_b16 v[148:149], v5 offset:0
    ds_read_b64_tr_b16 v[150:151], v5 offset:768
    v_mfma_f32_16x16x32_bf16 v[64:67], v[240:243], v[172:175], v[64:67]
    ds_read_b64_tr_b16 v[152:153], v5 offset:6144
    ds_read_b64_tr_b16 v[154:155], v5 offset:6912
    v_mfma_f32_16x16x32_bf16 v[64:67], v[244:247], v[176:179], v[64:67]
    ds_read_b64_tr_b16 v[212:213], v5 offset:12288
    ds_read_b64_tr_b16 v[214:215], v5 offset:13056
    v_mfma_f32_16x16x32_bf16 v[68:71], v[208:211], v[164:167], v[68:71]
    ds_read_b64_tr_b16 v[220:221], v5 offset:18432
    ds_read_b64_tr_b16 v[222:223], v5 offset:19200
    v_mfma_f32_16x16x32_bf16 v[68:71], v[224:227], v[168:171], v[68:71]
    ds_read_b64_tr_b16 v[228:229], v5 offset:24576
    ds_read_b64_tr_b16 v[230:231], v5 offset:25344
    v_mfma_f32_16x16x32_bf16 v[68:71], v[232:235], v[172:175], v[68:71]
    v_mfma_f32_16x16x32_bf16 v[68:71], v[240:243], v[176:179], v[68:71]
    v_mfma_f32_16x16x32_bf16 v[68:71], v[244:247], v[156:159], v[68:71]
    v_mfma_f32_16x16x32_bf16 v[104:107], v[240:243], v[180:183], v[104:107]
    v_mfma_f32_16x16x32_bf16 v[104:107], v[244:247], v[200:203], v[104:107]
    v_mfma_f32_16x16x32_bf16 v[72:75], v[208:211], v[168:171], v[72:75]
    v_mfma_f32_16x16x32_bf16 v[72:75], v[224:227], v[172:175], v[72:75]
    s_waitcnt lgkmcnt(0)
    s_barrier
    v_mfma_f32_16x16x32_bf16 v[72:75], v[232:235], v[176:179], v[72:75]
    v_mfma_f32_16x16x32_bf16 v[72:75], v[240:243], v[156:159], v[72:75]
    v_mfma_f32_16x16x32_bf16 v[72:75], v[244:247], v[248:251], v[72:75]
    v_mfma_f32_16x16x32_bf16 v[76:79], v[252:255], v[216:219], v[76:79]
    v_mfma_f32_16x16x32_bf16 v[76:79], v[112:115], v[164:167], v[76:79]
    v_mfma_f32_16x16x32_bf16 v[76:79], v[120:123], v[168:171], v[76:79]
    v_mfma_f32_16x16x32_bf16 v[76:79], v[136:139], v[172:175], v[76:79]
    ds_read_b64_tr_b16 v[236:237], v3 offset:30720
    v_mfma_f32_16x16x32_bf16 v[76:79], v[144:147], v[176:179], v[76:79]
    ds_read_b64_tr_b16 v[238:239], v3 offset:31488
    v_mfma_f32_16x16x32_bf16 v[80:83], v[252:255], v[164:167], v[80:83]
    ds_read_b128 v[128:131], v25 offset:0
    v_mfma_f32_16x16x32_bf16 v[80:83], v[112:115], v[168:171], v[80:83]
    ds_read_b64_tr_b16 v[184:185], v3 offset:36864
    v_mfma_f32_16x16x32_bf16 v[80:83], v[120:123], v[172:175], v[80:83]
    ds_read_b64_tr_b16 v[186:187], v3 offset:37632
    v_mfma_f32_16x16x32_bf16 v[80:83], v[136:139], v[176:179], v[80:83]
    ds_read_b128 v[188:191], v1 offset:512
    v_mfma_f32_16x16x32_bf16 v[80:83], v[144:147], v[156:159], v[80:83]
    ds_read_b64_tr_b16 v[108:109], v3 offset:43008
    v_mfma_f32_16x16x32_bf16 v[84:87], v[252:255], v[168:171], v[84:87]
    ds_read_b64_tr_b16 v[110:111], v3 offset:43776
    v_mfma_f32_16x16x32_bf16 v[84:87], v[112:115], v[172:175], v[84:87]
    ds_read_b128 v[192:195], v25 offset:1024
    v_mfma_f32_16x16x32_bf16 v[84:87], v[120:123], v[176:179], v[84:87]
    ds_read_b64_tr_b16 v[116:117], v3 offset:49152
    v_mfma_f32_16x16x32_bf16 v[84:87], v[136:139], v[156:159], v[84:87]
    ds_read_b64_tr_b16 v[118:119], v3 offset:49920
    v_mfma_f32_16x16x32_bf16 v[84:87], v[144:147], v[248:251], v[84:87]
    ds_read_b128 v[196:199], v1 offset:1536
    v_mfma_f32_16x16x32_bf16 v[88:91], v[148:151], v[216:219], v[88:91]
    ds_read_b64_tr_b16 v[124:125], v3 offset:55296
    v_mfma_f32_16x16x32_bf16 v[88:91], v[152:155], v[164:167], v[88:91]
    ds_read_b64_tr_b16 v[126:127], v3 offset:56064
    v_mfma_f32_16x16x32_bf16 v[88:91], v[212:215], v[168:171], v[88:91]
    ds_read_b128 v[160:163], v25 offset:2048
    v_mfma_f32_16x16x32_bf16 v[88:91], v[220:223], v[172:175], v[88:91]
    ds_read_b128 v[132:135], v1 offset:2560
    v_mfma_f32_16x16x32_bf16 v[88:91], v[228:231], v[176:179], v[88:91]
    ds_read_b128 v[204:207], v26 offset:1536
    v_mfma_f32_16x16x32_bf16 v[92:95], v[148:151], v[164:167], v[92:95]
    ds_read_b128 v[140:143], v2 offset:2048
    v_mfma_f32_16x16x32_bf16 v[92:95], v[152:155], v[168:171], v[92:95]
    ds_read_b128 v[180:183], v25 offset:3072
    v_mfma_f32_16x16x32_bf16 v[92:95], v[212:215], v[172:175], v[92:95]
    ds_read_b64_tr_b16 v[200:201], v4 offset:30720
    v_mfma_f32_16x16x32_bf16 v[92:95], v[220:223], v[176:179], v[92:95]
    ds_read_b64_tr_b16 v[202:203], v4 offset:31488
    v_mfma_f32_16x16x32_bf16 v[92:95], v[228:231], v[156:159], v[92:95]
    ds_read_b64_tr_b16 v[208:209], v4 offset:36864
    v_mfma_f32_16x16x32_bf16 v[96:99], v[148:151], v[168:171], v[96:99]
    ds_read_b64_tr_b16 v[210:211], v4 offset:37632
    v_mfma_f32_16x16x32_bf16 v[96:99], v[152:155], v[172:175], v[96:99]
    ds_read_b64_tr_b16 v[224:225], v4 offset:43008
    v_mfma_f32_16x16x32_bf16 v[96:99], v[212:215], v[176:179], v[96:99]
    ds_read_b64_tr_b16 v[226:227], v4 offset:43776
    v_mfma_f32_16x16x32_bf16 v[96:99], v[220:223], v[156:159], v[96:99]
    ds_read_b64_tr_b16 v[232:233], v4 offset:49152
    v_mfma_f32_16x16x32_bf16 v[96:99], v[228:231], v[248:251], v[96:99]
    ds_read_b64_tr_b16 v[234:235], v4 offset:49920
    s_waitcnt lgkmcnt(8)
    v_mfma_f32_16x16x32_bf16 v[28:31], v[236:239], v[128:131], v[28:31]
    ds_read_b64_tr_b16 v[240:241], v4 offset:55296
    v_mfma_f32_16x16x32_bf16 v[28:31], v[184:187], v[188:191], v[28:31]
    ds_read_b64_tr_b16 v[242:243], v4 offset:56064
    v_mfma_f32_16x16x32_bf16 v[28:31], v[108:111], v[192:195], v[28:31]
    ds_read_b64_tr_b16 v[244:245], v5 offset:30720
    v_mfma_f32_16x16x32_bf16 v[28:31], v[116:119], v[196:199], v[28:31]
    ds_read_b64_tr_b16 v[246:247], v5 offset:31488
    ds_read_b64_tr_b16 v[252:253], v5 offset:36864
    v_mfma_f32_16x16x32_bf16 v[28:31], v[124:127], v[160:163], v[28:31]
    ds_read_b64_tr_b16 v[254:255], v5 offset:37632
    ds_read_b64_tr_b16 v[112:113], v5 offset:43008
    v_mfma_f32_16x16x32_bf16 v[32:35], v[236:239], v[188:191], v[32:35]
    ds_read_b64_tr_b16 v[114:115], v5 offset:43776
    ds_read_b64_tr_b16 v[120:121], v5 offset:49152
    v_mfma_f32_16x16x32_bf16 v[32:35], v[184:187], v[192:195], v[32:35]
    ds_read_b64_tr_b16 v[122:123], v5 offset:49920
    ds_read_b64_tr_b16 v[136:137], v5 offset:55296
    v_mfma_f32_16x16x32_bf16 v[32:35], v[108:111], v[196:199], v[32:35]
    ds_read_b64_tr_b16 v[138:139], v5 offset:56064
    v_mfma_f32_16x16x32_bf16 v[32:35], v[116:119], v[160:163], v[32:35]
    v_mfma_f32_16x16x32_bf16 v[32:35], v[124:127], v[132:135], v[32:35]
    v_mfma_f32_16x16x32_bf16 v[100:103], v[116:119], v[204:207], v[100:103]
    v_mfma_f32_16x16x32_bf16 v[100:103], v[124:127], v[140:143], v[100:103]
    v_mfma_f32_16x16x32_bf16 v[36:39], v[236:239], v[192:195], v[36:39]
    v_mfma_f32_16x16x32_bf16 v[36:39], v[184:187], v[196:199], v[36:39]
    v_mfma_f32_16x16x32_bf16 v[36:39], v[108:111], v[160:163], v[36:39]
    s_waitcnt lgkmcnt(0)
    s_barrier
    v_mfma_f32_16x16x32_bf16 v[36:39], v[116:119], v[132:135], v[36:39]
    v_mfma_f32_16x16x32_bf16 v[36:39], v[124:127], v[180:183], v[36:39]
    v_mfma_f32_16x16x32_bf16 v[40:43], v[200:203], v[128:131], v[40:43]
    v_mfma_f32_16x16x32_bf16 v[40:43], v[208:211], v[188:191], v[40:43]
    v_mfma_f32_16x16x32_bf16 v[40:43], v[224:227], v[192:195], v[40:43]
    v_mfma_f32_16x16x32_bf16 v[40:43], v[232:235], v[196:199], v[40:43]
    v_mfma_f32_16x16x32_bf16 v[40:43], v[240:243], v[160:163], v[40:43]
    ds_read_b64_tr_b16 v[144:145], v6 offset:0
    v_mfma_f32_16x16x32_bf16 v[44:47], v[200:203], v[188:191], v[44:47]
    ds_read_b64_tr_b16 v[146:147], v6 offset:768
    v_mfma_f32_16x16x32_bf16 v[44:47], v[208:211], v[192:195], v[44:47]
    ds_read_b128 v[216:219], v25 offset:10240
    v_mfma_f32_16x16x32_bf16 v[44:47], v[224:227], v[196:199], v[44:47]
    ds_read_b64_tr_b16 v[164:165], v6 offset:6144
    v_mfma_f32_16x16x32_bf16 v[44:47], v[232:235], v[160:163], v[44:47]
    ds_read_b64_tr_b16 v[166:167], v6 offset:6912
    v_mfma_f32_16x16x32_bf16 v[44:47], v[240:243], v[132:135], v[44:47]
    ds_read_b128 v[168:171], v1 offset:10752
    v_mfma_f32_16x16x32_bf16 v[48:51], v[200:203], v[192:195], v[48:51]
    ds_read_b64_tr_b16 v[148:149], v6 offset:12288
    v_mfma_f32_16x16x32_bf16 v[48:51], v[208:211], v[196:199], v[48:51]
    ds_read_b64_tr_b16 v[150:151], v6 offset:13056
    v_mfma_f32_16x16x32_bf16 v[48:51], v[224:227], v[160:163], v[48:51]
    ds_read_b128 v[172:175], v25 offset:11264
    v_mfma_f32_16x16x32_bf16 v[48:51], v[232:235], v[132:135], v[48:51]
    ds_read_b64_tr_b16 v[152:153], v6 offset:18432
    v_mfma_f32_16x16x32_bf16 v[48:51], v[240:243], v[180:183], v[48:51]
    ds_read_b64_tr_b16 v[154:155], v6 offset:19200
    v_mfma_f32_16x16x32_bf16 v[52:55], v[244:247], v[128:131], v[52:55]
    ds_read_b128 v[176:179], v1 offset:11776
    v_mfma_f32_16x16x32_bf16 v[52:55], v[252:255], v[188:191], v[52:55]
    ds_read_b64_tr_b16 v[212:213], v6 offset:24576
    v_mfma_f32_16x16x32_bf16 v[52:55], v[112:115], v[192:195], v[52:55]
    ds_read_b64_tr_b16 v[214:215], v6 offset:25344
    v_mfma_f32_16x16x32_bf16 v[52:55], v[120:123], v[196:199], v[52:55]
    ds_read_b128 v[156:159], v25 offset:12288
    v_mfma_f32_16x16x32_bf16 v[52:55], v[136:139], v[160:163], v[52:55]
    ds_read_b128 v[220:223], v1 offset:12800
    v_mfma_f32_16x16x32_bf16 v[56:59], v[244:247], v[188:191], v[56:59]
    ds_read_b128 v[248:251], v2 offset:11264
    v_mfma_f32_16x16x32_bf16 v[56:59], v[252:255], v[192:195], v[56:59]
    ds_read_b128 v[228:231], v26 offset:11776
    v_mfma_f32_16x16x32_bf16 v[56:59], v[112:115], v[196:199], v[56:59]
    ds_read_b128 v[204:207], v2 offset:12288
    v_mfma_f32_16x16x32_bf16 v[56:59], v[120:123], v[160:163], v[56:59]
    ds_read_b128 v[140:143], v25 offset:13312
    v_mfma_f32_16x16x32_bf16 v[56:59], v[136:139], v[132:135], v[56:59]
    ds_read_b64_tr_b16 v[236:237], v7 offset:0
    v_mfma_f32_16x16x32_bf16 v[60:63], v[244:247], v[192:195], v[60:63]
    ds_read_b64_tr_b16 v[238:239], v7 offset:768
    v_mfma_f32_16x16x32_bf16 v[60:63], v[252:255], v[196:199], v[60:63]
    ds_read_b64_tr_b16 v[184:185], v7 offset:6144
    v_mfma_f32_16x16x32_bf16 v[60:63], v[112:115], v[160:163], v[60:63]
    ds_read_b64_tr_b16 v[186:187], v7 offset:6912
    v_mfma_f32_16x16x32_bf16 v[60:63], v[120:123], v[132:135], v[60:63]
    ds_read_b64_tr_b16 v[108:109], v7 offset:12288
    v_mfma_f32_16x16x32_bf16 v[60:63], v[136:139], v[180:183], v[60:63]
    ds_read_b64_tr_b16 v[110:111], v7 offset:13056
    s_waitcnt lgkmcnt(8)
    v_mfma_f32_16x16x32_bf16 v[64:67], v[144:147], v[216:219], v[64:67]
    ds_read_b64_tr_b16 v[116:117], v7 offset:18432
    v_mfma_f32_16x16x32_bf16 v[64:67], v[164:167], v[168:171], v[64:67]
    ds_read_b64_tr_b16 v[118:119], v7 offset:19200
    v_mfma_f32_16x16x32_bf16 v[64:67], v[148:151], v[172:175], v[64:67]
    ds_read_b64_tr_b16 v[124:125], v7 offset:24576
    v_mfma_f32_16x16x32_bf16 v[64:67], v[152:155], v[176:179], v[64:67]
    ds_read_b64_tr_b16 v[126:127], v7 offset:25344
    ds_read_b64_tr_b16 v[200:201], v8 offset:0
    v_mfma_f32_16x16x32_bf16 v[64:67], v[212:215], v[156:159], v[64:67]
    ds_read_b64_tr_b16 v[202:203], v8 offset:768
    ds_read_b64_tr_b16 v[208:209], v8 offset:6144
    v_mfma_f32_16x16x32_bf16 v[68:71], v[144:147], v[168:171], v[68:71]
    ds_read_b64_tr_b16 v[210:211], v8 offset:6912
    ds_read_b64_tr_b16 v[224:225], v8 offset:12288
    v_mfma_f32_16x16x32_bf16 v[68:71], v[164:167], v[172:175], v[68:71]
    ds_read_b64_tr_b16 v[226:227], v8 offset:13056
    ds_read_b64_tr_b16 v[232:233], v8 offset:18432
    v_mfma_f32_16x16x32_bf16 v[68:71], v[148:151], v[176:179], v[68:71]
    ds_read_b64_tr_b16 v[234:235], v8 offset:19200
    ds_read_b64_tr_b16 v[240:241], v8 offset:24576
    v_mfma_f32_16x16x32_bf16 v[68:71], v[152:155], v[156:159], v[68:71]
    ds_read_b64_tr_b16 v[242:243], v8 offset:25344
    v_fmac_f32 v28, s47, v64
    v_mfma_f32_16x16x32_bf16 v[68:71], v[212:215], v[220:223], v[68:71]
    v_fmac_f32 v29, s47, v65
    v_fmac_f32 v30, s47, v66
    v_mfma_f32_16x16x32_bf16 v[104:107], v[148:151], v[248:251], v[104:107]
    v_fmac_f32 v31, s47, v67
    v_fmamk_f32 v64, v64, 0xbf960000, v28
    v_mfma_f32_16x16x32_bf16 v[104:107], v[152:155], v[228:231], v[104:107]
    v_fmamk_f32 v65, v65, 0xbf960000, v29
    v_fmamk_f32 v66, v66, 0xbf960000, v30
    s_waitcnt lgkmcnt(9)
    v_mfma_f32_16x16x32_bf16 v[104:107], v[212:215], v[204:207], v[104:107]
    v_fmamk_f32 v67, v67, 0xbf960000, v31
    v_fmac_f32 v32, s47, v68
    v_mfma_f32_16x16x32_bf16 v[72:75], v[144:147], v[172:175], v[72:75]
    v_fmac_f32 v33, s47, v69
    v_fmac_f32 v34, s47, v70
    v_mfma_f32_16x16x32_bf16 v[72:75], v[164:167], v[176:179], v[72:75]
    s_waitcnt lgkmcnt(0)
    s_barrier
    v_mfma_f32_16x16x32_bf16 v[72:75], v[148:151], v[156:159], v[72:75]
    v_fmac_f32 v35, s47, v71
    v_fmamk_f32 v68, v68, 0xbf960000, v32
    v_mfma_f32_16x16x32_bf16 v[72:75], v[152:155], v[220:223], v[72:75]
    v_fmamk_f32 v69, v69, 0xbf960000, v33
    v_fmamk_f32 v70, v70, 0xbf960000, v34
    v_mfma_f32_16x16x32_bf16 v[72:75], v[212:215], v[140:143], v[72:75]
    v_fmamk_f32 v71, v71, 0xbf960000, v35
    v_fmac_f32 v100, s47, v104
    v_mfma_f32_16x16x32_bf16 v[76:79], v[236:239], v[216:219], v[76:79]
    v_fmac_f32 v101, s47, v105
    v_fmac_f32 v102, s47, v106
    v_mfma_f32_16x16x32_bf16 v[76:79], v[184:187], v[168:171], v[76:79]
    v_fmac_f32 v103, s47, v107
    v_fmamk_f32 v104, v104, 0xbf960000, v100
    v_mfma_f32_16x16x32_bf16 v[76:79], v[108:111], v[172:175], v[76:79]
    v_fmamk_f32 v105, v105, 0xbf960000, v101
    v_fmamk_f32 v106, v106, 0xbf960000, v102
    v_mfma_f32_16x16x32_bf16 v[76:79], v[116:119], v[176:179], v[76:79]
    v_fmamk_f32 v107, v107, 0xbf960000, v103
    v_fmac_f32 v36, s47, v72
    v_mfma_f32_16x16x32_bf16 v[76:79], v[124:127], v[156:159], v[76:79]
    v_fmac_f32 v37, s47, v73
    v_fmac_f32 v38, s47, v74
    v_mfma_f32_16x16x32_bf16 v[80:83], v[236:239], v[168:171], v[80:83]
    v_fmac_f32 v39, s47, v75
    v_fmamk_f32 v72, v72, 0xbf960000, v36
    v_mfma_f32_16x16x32_bf16 v[80:83], v[184:187], v[172:175], v[80:83]
    v_fmamk_f32 v73, v73, 0xbf960000, v37
    v_fmamk_f32 v74, v74, 0xbf960000, v38
    v_mfma_f32_16x16x32_bf16 v[80:83], v[108:111], v[176:179], v[80:83]
    v_fmamk_f32 v75, v75, 0xbf960000, v39
    v_fmac_f32 v40, s47, v76
    v_mfma_f32_16x16x32_bf16 v[80:83], v[116:119], v[156:159], v[80:83]
    v_fmac_f32 v41, s47, v77
    v_fmac_f32 v42, s47, v78
    v_mfma_f32_16x16x32_bf16 v[80:83], v[124:127], v[220:223], v[80:83]
    ds_read_b128 v[128:131], v9 offset:0
    v_fmac_f32 v43, s47, v79
    v_mfma_f32_16x16x32_bf16 v[84:87], v[236:239], v[172:175], v[84:87]
    ds_read_b128 v[188:191], v25 offset:20480
    v_fmamk_f32 v76, v76, 0xbf960000, v40
    v_mfma_f32_16x16x32_bf16 v[84:87], v[184:187], v[176:179], v[84:87]
    ds_read_b128 v[192:195], v9 offset:6144
    v_fmamk_f32 v77, v77, 0xbf960000, v41
    v_mfma_f32_16x16x32_bf16 v[84:87], v[108:111], v[156:159], v[84:87]
    ds_read_b128 v[244:247], v1 offset:20992
    v_fmamk_f32 v78, v78, 0xbf960000, v42
    v_mfma_f32_16x16x32_bf16 v[84:87], v[116:119], v[220:223], v[84:87]
    ds_read_b128 v[196:199], v9 offset:12288
    v_fmamk_f32 v79, v79, 0xbf960000, v43
    v_mfma_f32_16x16x32_bf16 v[84:87], v[124:127], v[140:143], v[84:87]
    ds_read_b128 v[252:255], v25 offset:21504
    v_fmac_f32 v44, s47, v80
    v_mfma_f32_16x16x32_bf16 v[88:91], v[200:203], v[216:219], v[88:91]
    ds_read_b128 v[160:163], v9 offset:18432
    v_fmac_f32 v45, s47, v81
    v_mfma_f32_16x16x32_bf16 v[88:91], v[208:211], v[168:171], v[88:91]
    ds_read_b128 v[112:115], v1 offset:22016
    v_fmac_f32 v46, s47, v82
    v_mfma_f32_16x16x32_bf16 v[88:91], v[224:227], v[172:175], v[88:91]
    ds_read_b128 v[132:135], v9 offset:24576
    v_fmac_f32 v47, s47, v83
    v_mfma_f32_16x16x32_bf16 v[88:91], v[232:235], v[176:179], v[88:91]
    ds_read_b128 v[120:123], v25 offset:22528
    v_fmamk_f32 v80, v80, 0xbf960000, v44
    v_mfma_f32_16x16x32_bf16 v[88:91], v[240:243], v[156:159], v[88:91]
    ds_read_b128 v[180:183], v1 offset:23040
    v_fmamk_f32 v81, v81, 0xbf960000, v45
    v_mfma_f32_16x16x32_bf16 v[92:95], v[200:203], v[168:171], v[92:95]
    ds_read_b128 v[136:139], v2 offset:21504
    v_fmamk_f32 v82, v82, 0xbf960000, v46
    v_mfma_f32_16x16x32_bf16 v[92:95], v[208:211], v[172:175], v[92:95]
    ds_read_b128 v[248:251], v26 offset:22016
    v_fmamk_f32 v83, v83, 0xbf960000, v47
    v_mfma_f32_16x16x32_bf16 v[92:95], v[224:227], v[176:179], v[92:95]
    ds_read_b128 v[228:231], v2 offset:22528
    v_fmac_f32 v48, s47, v84
    v_mfma_f32_16x16x32_bf16 v[92:95], v[232:235], v[156:159], v[92:95]
    ds_read_b128 v[204:207], v25 offset:23552
    v_fmac_f32 v49, s47, v85
    v_mfma_f32_16x16x32_bf16 v[92:95], v[240:243], v[220:223], v[92:95]
    ds_read_b128 v[144:147], v10 offset:0
    v_fmac_f32 v50, s47, v86
    v_mfma_f32_16x16x32_bf16 v[96:99], v[200:203], v[172:175], v[96:99]
    ds_read_b128 v[164:167], v10 offset:6144
    v_fmac_f32 v51, s47, v87
    v_mfma_f32_16x16x32_bf16 v[96:99], v[208:211], v[176:179], v[96:99]
    ds_read_b128 v[148:151], v10 offset:12288
    v_fmamk_f32 v84, v84, 0xbf960000, v48
    v_mfma_f32_16x16x32_bf16 v[96:99], v[224:227], v[156:159], v[96:99]
    ds_read_b128 v[152:155], v10 offset:18432
    v_fmamk_f32 v85, v85, 0xbf960000, v49
    v_mfma_f32_16x16x32_bf16 v[96:99], v[232:235], v[220:223], v[96:99]
    ds_read_b128 v[212:215], v10 offset:24576
    v_fmamk_f32 v86, v86, 0xbf960000, v50
    v_mfma_f32_16x16x32_bf16 v[96:99], v[240:243], v[140:143], v[96:99]
    ds_read_b128 v[236:239], v11 offset:0
    v_fmamk_f32 v87, v87, 0xbf960000, v51
    s_waitcnt lgkmcnt(8)
    v_mfma_f32_16x16x32_bf16 v[28:31], v[128:131], v[188:191], v[28:31]
    ds_read_b128 v[184:187], v11 offset:6144
    v_fmac_f32 v52, s47, v88
    v_mfma_f32_16x16x32_bf16 v[28:31], v[192:195], v[244:247], v[28:31]
    ds_read_b128 v[108:111], v11 offset:12288
    v_fmac_f32 v53, s47, v89
    v_mfma_f32_16x16x32_bf16 v[28:31], v[196:199], v[252:255], v[28:31]
    ds_read_b128 v[116:119], v11 offset:18432
    v_fmac_f32 v54, s47, v90
    v_mfma_f32_16x16x32_bf16 v[28:31], v[160:163], v[112:115], v[28:31]
    ds_read_b128 v[124:127], v11 offset:24576
    v_fmac_f32 v55, s47, v91
    v_mfma_f32_16x16x32_bf16 v[28:31], v[132:135], v[120:123], v[28:31]
    v_fmamk_f32 v88, v88, 0xbf960000, v52
    v_fmamk_f32 v89, v89, 0xbf960000, v53
    v_mfma_f32_16x16x32_bf16 v[32:35], v[128:131], v[244:247], v[32:35]
    v_fmamk_f32 v90, v90, 0xbf960000, v54
    v_fmamk_f32 v91, v91, 0xbf960000, v55
    v_mfma_f32_16x16x32_bf16 v[32:35], v[192:195], v[252:255], v[32:35]
    v_fmac_f32 v56, s47, v92
    v_fmac_f32 v57, s47, v93
    v_mfma_f32_16x16x32_bf16 v[32:35], v[196:199], v[112:115], v[32:35]
    v_fmac_f32 v58, s47, v94
    v_fmac_f32 v59, s47, v95
    v_mfma_f32_16x16x32_bf16 v[32:35], v[160:163], v[120:123], v[32:35]
    v_fmamk_f32 v92, v92, 0xbf960000, v56
    v_fmamk_f32 v93, v93, 0xbf960000, v57
    v_mfma_f32_16x16x32_bf16 v[32:35], v[132:135], v[180:183], v[32:35]
    v_fmamk_f32 v94, v94, 0xbf960000, v58
    v_fmamk_f32 v95, v95, 0xbf960000, v59
    v_mfma_f32_16x16x32_bf16 v[100:103], v[196:199], v[136:139], v[100:103]
    v_fmac_f32 v60, s47, v96
    v_fmac_f32 v61, s47, v97
    v_mfma_f32_16x16x32_bf16 v[100:103], v[160:163], v[248:251], v[100:103]
    v_fmac_f32 v62, s47, v98
    v_fmac_f32 v63, s47, v99
    s_waitcnt lgkmcnt(0)
    v_mfma_f32_16x16x32_bf16 v[100:103], v[132:135], v[228:231], v[100:103]
    v_fmamk_f32 v96, v96, 0xbf960000, v60
    v_fmamk_f32 v97, v97, 0xbf960000, v61
    v_mfma_f32_16x16x32_bf16 v[36:39], v[128:131], v[252:255], v[36:39]
    v_fmamk_f32 v98, v98, 0xbf960000, v62
    v_fmamk_f32 v99, v99, 0xbf960000, v63
    v_mfma_f32_16x16x32_bf16 v[36:39], v[192:195], v[112:115], v[36:39]
    s_barrier
    v_mfma_f32_16x16x32_bf16 v[36:39], v[196:199], v[120:123], v[36:39]
    v_mfma_f32_16x16x32_bf16 v[36:39], v[160:163], v[180:183], v[36:39]
    v_mfma_f32_16x16x32_bf16 v[36:39], v[132:135], v[204:207], v[36:39]
    v_mfma_f32_16x16x32_bf16 v[40:43], v[144:147], v[188:191], v[40:43]
    v_mfma_f32_16x16x32_bf16 v[40:43], v[164:167], v[244:247], v[40:43]
    v_mfma_f32_16x16x32_bf16 v[40:43], v[148:151], v[252:255], v[40:43]
    v_mfma_f32_16x16x32_bf16 v[40:43], v[152:155], v[112:115], v[40:43]
    v_mfma_f32_16x16x32_bf16 v[40:43], v[212:215], v[120:123], v[40:43]
    v_mfma_f32_16x16x32_bf16 v[44:47], v[144:147], v[244:247], v[44:47]
    v_mfma_f32_16x16x32_bf16 v[44:47], v[164:167], v[252:255], v[44:47]
    v_mfma_f32_16x16x32_bf16 v[44:47], v[148:151], v[112:115], v[44:47]
    v_mfma_f32_16x16x32_bf16 v[44:47], v[152:155], v[120:123], v[44:47]
    v_mfma_f32_16x16x32_bf16 v[44:47], v[212:215], v[180:183], v[44:47]
    ds_read_b128 v[216:219], v9 offset:30720
    v_mfma_f32_16x16x32_bf16 v[48:51], v[144:147], v[252:255], v[48:51]
    ds_read_b128 v[168:171], v25 offset:30720
    v_mfma_f32_16x16x32_bf16 v[48:51], v[164:167], v[112:115], v[48:51]
    ds_read_b128 v[172:175], v9 offset:36864
    v_mfma_f32_16x16x32_bf16 v[48:51], v[148:151], v[120:123], v[48:51]
    ds_read_b128 v[200:203], v1 offset:31232
    v_mfma_f32_16x16x32_bf16 v[48:51], v[152:155], v[180:183], v[48:51]
    ds_read_b128 v[176:179], v9 offset:43008
    v_mfma_f32_16x16x32_bf16 v[48:51], v[212:215], v[204:207], v[48:51]
    ds_read_b128 v[208:211], v25 offset:31744
    v_mfma_f32_16x16x32_bf16 v[52:55], v[236:239], v[188:191], v[52:55]
    ds_read_b128 v[156:159], v9 offset:49152
    v_mfma_f32_16x16x32_bf16 v[52:55], v[184:187], v[244:247], v[52:55]
    ds_read_b128 v[224:227], v1 offset:32256
    v_mfma_f32_16x16x32_bf16 v[52:55], v[108:111], v[252:255], v[52:55]
    ds_read_b128 v[220:223], v9 offset:55296
    v_mfma_f32_16x16x32_bf16 v[52:55], v[116:119], v[112:115], v[52:55]
    ds_read_b128 v[232:235], v25 offset:32768
    v_mfma_f32_16x16x32_bf16 v[52:55], v[124:127], v[120:123], v[52:55]
    ds_read_b128 v[140:143], v1 offset:33280
    v_mfma_f32_16x16x32_bf16 v[56:59], v[236:239], v[244:247], v[56:59]
    ds_read_b128 v[240:243], v26 offset:32256
    v_mfma_f32_16x16x32_bf16 v[56:59], v[184:187], v[252:255], v[56:59]
    ds_read_b128 v[136:139], v2 offset:32768
    v_mfma_f32_16x16x32_bf16 v[56:59], v[108:111], v[112:115], v[56:59]
    ds_read_b128 v[248:251], v25 offset:33792
    v_mfma_f32_16x16x32_bf16 v[56:59], v[116:119], v[120:123], v[56:59]
    ds_read_b128 v[228:231], v10 offset:30720
    v_mfma_f32_16x16x32_bf16 v[56:59], v[124:127], v[180:183], v[56:59]
    ds_read_b128 v[128:131], v10 offset:36864
    v_mfma_f32_16x16x32_bf16 v[60:63], v[236:239], v[252:255], v[60:63]
    ds_read_b128 v[192:195], v10 offset:43008
    v_mfma_f32_16x16x32_bf16 v[60:63], v[184:187], v[112:115], v[60:63]
    ds_read_b128 v[196:199], v10 offset:49152
    v_mfma_f32_16x16x32_bf16 v[60:63], v[108:111], v[120:123], v[60:63]
    ds_read_b128 v[160:163], v10 offset:55296
    v_mfma_f32_16x16x32_bf16 v[60:63], v[116:119], v[180:183], v[60:63]
    ds_read_b128 v[132:135], v11 offset:30720
    v_mfma_f32_16x16x32_bf16 v[60:63], v[124:127], v[204:207], v[60:63]
    ds_read_b128 v[144:147], v11 offset:36864
    s_waitcnt lgkmcnt(8)
    v_mfma_f32_16x16x32_bf16 v[64:67], v[216:219], v[168:171], v[64:67]
    ds_read_b128 v[164:167], v11 offset:43008
    v_mfma_f32_16x16x32_bf16 v[64:67], v[172:175], v[200:203], v[64:67]
    ds_read_b128 v[148:151], v11 offset:49152
    v_mfma_f32_16x16x32_bf16 v[64:67], v[176:179], v[208:211], v[64:67]
    ds_read_b128 v[152:155], v11 offset:55296
    v_mfma_f32_16x16x32_bf16 v[64:67], v[156:159], v[224:227], v[64:67]
    v_mfma_f32_16x16x32_bf16 v[64:67], v[220:223], v[232:235], v[64:67]
    v_mfma_f32_16x16x32_bf16 v[68:71], v[216:219], v[200:203], v[68:71]
    v_mfma_f32_16x16x32_bf16 v[68:71], v[172:175], v[208:211], v[68:71]
    v_mfma_f32_16x16x32_bf16 v[68:71], v[176:179], v[224:227], v[68:71]
    v_mfma_f32_16x16x32_bf16 v[68:71], v[156:159], v[232:235], v[68:71]
    v_mfma_f32_16x16x32_bf16 v[68:71], v[220:223], v[140:143], v[68:71]
    v_mfma_f32_16x16x32_bf16 v[104:107], v[156:159], v[240:243], v[104:107]
    v_mfma_f32_16x16x32_bf16 v[104:107], v[220:223], v[136:139], v[104:107]
    v_mfma_f32_16x16x32_bf16 v[72:75], v[216:219], v[208:211], v[72:75]
    v_mfma_f32_16x16x32_bf16 v[72:75], v[172:175], v[224:227], v[72:75]
    s_waitcnt lgkmcnt(0)
    s_barrier
    v_mfma_f32_16x16x32_bf16 v[72:75], v[176:179], v[232:235], v[72:75]
    v_mfma_f32_16x16x32_bf16 v[72:75], v[156:159], v[140:143], v[72:75]
    v_mfma_f32_16x16x32_bf16 v[72:75], v[220:223], v[248:251], v[72:75]
    v_mfma_f32_16x16x32_bf16 v[76:79], v[228:231], v[168:171], v[76:79]
    v_mfma_f32_16x16x32_bf16 v[76:79], v[128:131], v[200:203], v[76:79]
    v_mfma_f32_16x16x32_bf16 v[76:79], v[192:195], v[208:211], v[76:79]
    v_mfma_f32_16x16x32_bf16 v[76:79], v[196:199], v[224:227], v[76:79]
    v_mfma_f32_16x16x32_bf16 v[76:79], v[160:163], v[232:235], v[76:79]
    v_mfma_f32_16x16x32_bf16 v[80:83], v[228:231], v[200:203], v[80:83]
    v_mfma_f32_16x16x32_bf16 v[80:83], v[128:131], v[208:211], v[80:83]
    v_mfma_f32_16x16x32_bf16 v[80:83], v[192:195], v[224:227], v[80:83]
    v_mfma_f32_16x16x32_bf16 v[80:83], v[196:199], v[232:235], v[80:83]
    v_mfma_f32_16x16x32_bf16 v[80:83], v[160:163], v[140:143], v[80:83]
    ds_read_b128 v[212:215], v12 offset:0
    v_mfma_f32_16x16x32_bf16 v[84:87], v[228:231], v[208:211], v[84:87]
    ds_read_b128 v[188:191], v25 offset:0
    v_mfma_f32_16x16x32_bf16 v[84:87], v[128:131], v[224:227], v[84:87]
    ds_read_b128 v[244:247], v12 offset:6144
    v_mfma_f32_16x16x32_bf16 v[84:87], v[192:195], v[232:235], v[84:87]
    ds_read_b128 v[252:255], v1 offset:512
    v_mfma_f32_16x16x32_bf16 v[84:87], v[196:199], v[140:143], v[84:87]
    ds_read_b128 v[236:239], v12 offset:12288
    v_mfma_f32_16x16x32_bf16 v[84:87], v[160:163], v[248:251], v[84:87]
    ds_read_b128 v[112:115], v25 offset:1024
    v_mfma_f32_16x16x32_bf16 v[88:91], v[132:135], v[168:171], v[88:91]
    ds_read_b128 v[184:187], v12 offset:18432
    v_mfma_f32_16x16x32_bf16 v[88:91], v[144:147], v[200:203], v[88:91]
    ds_read_b128 v[120:123], v1 offset:1536
    v_mfma_f32_16x16x32_bf16 v[88:91], v[164:167], v[208:211], v[88:91]
    ds_read_b128 v[108:111], v12 offset:24576
    v_mfma_f32_16x16x32_bf16 v[88:91], v[148:151], v[224:227], v[88:91]
    ds_read_b128 v[180:183], v25 offset:2048
    v_mfma_f32_16x16x32_bf16 v[88:91], v[152:155], v[232:235], v[88:91]
    ds_read_b128 v[116:119], v1 offset:2560
    v_mfma_f32_16x16x32_bf16 v[92:95], v[132:135], v[200:203], v[92:95]
    ds_read_b128 v[204:207], v26 offset:1536
    v_mfma_f32_16x16x32_bf16 v[92:95], v[144:147], v[208:211], v[92:95]
    ds_read_b128 v[124:127], v2 offset:2048
    v_mfma_f32_16x16x32_bf16 v[92:95], v[164:167], v[224:227], v[92:95]
    ds_read_b128 v[240:243], v25 offset:3072
    v_mfma_f32_16x16x32_bf16 v[92:95], v[148:151], v[232:235], v[92:95]
    ds_read_b128 v[136:139], v13 offset:0
    v_mfma_f32_16x16x32_bf16 v[92:95], v[152:155], v[140:143], v[92:95]
    ds_read_b128 v[216:219], v13 offset:6144
    v_mfma_f32_16x16x32_bf16 v[96:99], v[132:135], v[208:211], v[96:99]
    ds_read_b128 v[172:175], v13 offset:12288
    v_mfma_f32_16x16x32_bf16 v[96:99], v[144:147], v[224:227], v[96:99]
    ds_read_b128 v[176:179], v13 offset:18432
    v_subrev_u32 v3, s46, v9
    v_mfma_f32_16x16x32_bf16 v[96:99], v[164:167], v[232:235], v[96:99]
    ds_read_b128 v[156:159], v13 offset:24576
    v_subrev_u32 v6, s46, v12
    v_mfma_f32_16x16x32_bf16 v[96:99], v[148:151], v[140:143], v[96:99]
    s_branch L_is9
.p2align 12
L_pg9:
    s_setpc_b64 s[62:63]
L_is9:
    ds_read_b128 v[220:223], v14 offset:0
    v_mfma_f32_16x16x32_bf16 v[96:99], v[152:155], v[248:251], v[96:99]
    ds_read_b128 v[228:231], v14 offset:6144
    s_waitcnt lgkmcnt(8)
    v_mfma_f32_16x16x32_bf16 v[28:31], v[212:215], v[188:191], v[28:31]
    ds_read_b128 v[128:131], v14 offset:12288
    v_mfma_f32_16x16x32_bf16 v[28:31], v[244:247], v[252:255], v[28:31]
    ds_read_b128 v[192:195], v14 offset:18432
    v_mfma_f32_16x16x32_bf16 v[28:31], v[236:239], v[112:115], v[28:31]
    ds_read_b128 v[196:199], v14 offset:24576
    v_mfma_f32_16x16x32_bf16 v[28:31], v[184:187], v[120:123], v[28:31]
    v_mfma_f32_16x16x32_bf16 v[28:31], v[108:111], v[180:183], v[28:31]
    v_mfma_f32_16x16x32_bf16 v[32:35], v[212:215], v[252:255], v[32:35]
    v_mfma_f32_16x16x32_bf16 v[32:35], v[244:247], v[112:115], v[32:35]
    v_mfma_f32_16x16x32_bf16 v[32:35], v[236:239], v[120:123], v[32:35]
    v_mfma_f32_16x16x32_bf16 v[32:35], v[184:187], v[180:183], v[32:35]
    v_mfma_f32_16x16x32_bf16 v[32:35], v[108:111], v[116:119], v[32:35]
    v_mfma_f32_16x16x32_bf16 v[100:103], v[184:187], v[204:207], v[100:103]
    v_mfma_f32_16x16x32_bf16 v[100:103], v[108:111], v[124:127], v[100:103]
    v_mfma_f32_16x16x32_bf16 v[36:39], v[212:215], v[112:115], v[36:39]
    v_mfma_f32_16x16x32_bf16 v[36:39], v[244:247], v[120:123], v[36:39]
    v_mfma_f32_16x16x32_bf16 v[36:39], v[236:239], v[180:183], v[36:39]
    s_waitcnt lgkmcnt(0)
    s_barrier
    v_mfma_f32_16x16x32_bf16 v[36:39], v[184:187], v[116:119], v[36:39]
    v_mfma_f32_16x16x32_bf16 v[36:39], v[108:111], v[240:243], v[36:39]
    v_mfma_f32_16x16x32_bf16 v[40:43], v[136:139], v[188:191], v[40:43]
    v_mfma_f32_16x16x32_bf16 v[40:43], v[216:219], v[252:255], v[40:43]
    v_mfma_f32_16x16x32_bf16 v[40:43], v[172:175], v[112:115], v[40:43]
    v_mfma_f32_16x16x32_bf16 v[40:43], v[176:179], v[120:123], v[40:43]
    v_mfma_f32_16x16x32_bf16 v[40:43], v[156:159], v[180:183], v[40:43]
    v_mfma_f32_16x16x32_bf16 v[44:47], v[136:139], v[252:255], v[44:47]
    v_mfma_f32_16x16x32_bf16 v[44:47], v[216:219], v[112:115], v[44:47]
    v_mfma_f32_16x16x32_bf16 v[44:47], v[172:175], v[120:123], v[44:47]
    v_mfma_f32_16x16x32_bf16 v[44:47], v[176:179], v[180:183], v[44:47]
    v_mfma_f32_16x16x32_bf16 v[44:47], v[156:159], v[116:119], v[44:47]
    v_mfma_f32_16x16x32_bf16 v[48:51], v[136:139], v[112:115], v[48:51]
    ds_read_b128 v[160:163], v9 offset:0
    v_mfma_f32_16x16x32_bf16 v[48:51], v[216:219], v[120:123], v[48:51]
    ds_read_b128 v[168:171], v25 offset:10240
    v_mfma_f32_16x16x32_bf16 v[48:51], v[172:175], v[180:183], v[48:51]
    ds_read_b128 v[200:203], v9 offset:6144
    v_mfma_f32_16x16x32_bf16 v[48:51], v[176:179], v[116:119], v[48:51]
    ds_read_b128 v[208:211], v1 offset:10752
    v_mfma_f32_16x16x32_bf16 v[48:51], v[156:159], v[240:243], v[48:51]
    ds_read_b128 v[132:135], v9 offset:12288
    v_mfma_f32_16x16x32_bf16 v[52:55], v[220:223], v[188:191], v[52:55]
    ds_read_b128 v[224:227], v25 offset:11264
    v_mfma_f32_16x16x32_bf16 v[52:55], v[228:231], v[252:255], v[52:55]
    ds_read_b128 v[144:147], v9 offset:18432
    v_mfma_f32_16x16x32_bf16 v[52:55], v[128:131], v[112:115], v[52:55]
    ds_read_b128 v[232:235], v1 offset:11776
    v_mfma_f32_16x16x32_bf16 v[52:55], v[192:195], v[120:123], v[52:55]
    ds_read_b128 v[164:167], v9 offset:24576
    v_mfma_f32_16x16x32_bf16 v[52:55], v[196:199], v[180:183], v[52:55]
    ds_read_b128 v[140:143], v25 offset:12288
    v_mfma_f32_16x16x32_bf16 v[56:59], v[220:223], v[252:255], v[56:59]
    ds_read_b128 v[148:151], v1 offset:12800
    v_mfma_f32_16x16x32_bf16 v[56:59], v[228:231], v[112:115], v[56:59]
    ds_read_b128 v[248:251], v2 offset:11264
    v_mfma_f32_16x16x32_bf16 v[56:59], v[128:131], v[120:123], v[56:59]
    ds_read_b128 v[152:155], v26 offset:11776
    v_mfma_f32_16x16x32_bf16 v[56:59], v[192:195], v[180:183], v[56:59]
    ds_read_b128 v[204:207], v2 offset:12288
    v_mfma_f32_16x16x32_bf16 v[56:59], v[196:199], v[116:119], v[56:59]
    ds_read_b128 v[124:127], v25 offset:13312
    v_mfma_f32_16x16x32_bf16 v[60:63], v[220:223], v[112:115], v[60:63]
    ds_read_b128 v[212:215], v10 offset:0
    v_mfma_f32_16x16x32_bf16 v[60:63], v[228:231], v[120:123], v[60:63]
    ds_read_b128 v[244:247], v10 offset:6144
    v_mfma_f32_16x16x32_bf16 v[60:63], v[128:131], v[180:183], v[60:63]
    ds_read_b128 v[236:239], v10 offset:12288
    v_mfma_f32_16x16x32_bf16 v[60:63], v[192:195], v[116:119], v[60:63]
    ds_read_b128 v[184:187], v10 offset:18432
    v_mfma_f32_16x16x32_bf16 v[60:63], v[196:199], v[240:243], v[60:63]
    ds_read_b128 v[108:111], v10 offset:24576
    s_waitcnt lgkmcnt(8)
    v_mfma_f32_16x16x32_bf16 v[64:67], v[160:163], v[168:171], v[64:67]
    ds_read_b128 v[136:139], v11 offset:0
    v_mfma_f32_16x16x32_bf16 v[64:67], v[200:203], v[208:211], v[64:67]
    ds_read_b128 v[216:219], v11 offset:6144
    v_mfma_f32_16x16x32_bf16 v[64:67], v[132:135], v[224:227], v[64:67]
    ds_read_b128 v[172:175], v11 offset:12288
    v_mfma_f32_16x16x32_bf16 v[64:67], v[144:147], v[232:235], v[64:67]
    ds_read_b128 v[176:179], v11 offset:18432
    ds_read_b128 v[156:159], v11 offset:24576
    v_mfma_f32_16x16x32_bf16 v[64:67], v[164:167], v[140:143], v[64:67]
    v_mfma_f32_16x16x32_bf16 v[68:71], v[160:163], v[208:211], v[68:71]
    v_mfma_f32_16x16x32_bf16 v[68:71], v[200:203], v[224:227], v[68:71]
    v_mfma_f32_16x16x32_bf16 v[68:71], v[132:135], v[232:235], v[68:71]
    v_mfma_f32_16x16x32_bf16 v[68:71], v[144:147], v[140:143], v[68:71]
    v_mfma_f32_16x16x32_bf16 v[68:71], v[164:167], v[148:151], v[68:71]
    v_mfma_f32_16x16x32_bf16 v[104:107], v[132:135], v[248:251], v[104:107]
    s_waitcnt lgkmcnt(2)
    v_mfma_f32_16x16x32_bf16 v[104:107], v[144:147], v[152:155], v[104:107]
    v_mfma_f32_16x16x32_bf16 v[104:107], v[164:167], v[204:207], v[104:107]
    v_mfma_f32_16x16x32_bf16 v[72:75], v[160:163], v[224:227], v[72:75]
    v_mfma_f32_16x16x32_bf16 v[72:75], v[200:203], v[232:235], v[72:75]
    s_waitcnt lgkmcnt(0)
    s_barrier
    v_mfma_f32_16x16x32_bf16 v[72:75], v[132:135], v[140:143], v[72:75]
    v_mfma_f32_16x16x32_bf16 v[72:75], v[144:147], v[148:151], v[72:75]
    v_mfma_f32_16x16x32_bf16 v[72:75], v[164:167], v[124:127], v[72:75]
    v_mfma_f32_16x16x32_bf16 v[76:79], v[212:215], v[168:171], v[76:79]
    v_mfma_f32_16x16x32_bf16 v[76:79], v[244:247], v[208:211], v[76:79]
    v_mfma_f32_16x16x32_bf16 v[76:79], v[236:239], v[224:227], v[76:79]
    v_mfma_f32_16x16x32_bf16 v[76:79], v[184:187], v[232:235], v[76:79]
    v_mfma_f32_16x16x32_bf16 v[76:79], v[108:111], v[140:143], v[76:79]
    v_mfma_f32_16x16x32_bf16 v[80:83], v[212:215], v[208:211], v[80:83]
    v_mfma_f32_16x16x32_bf16 v[80:83], v[244:247], v[224:227], v[80:83]
    v_mfma_f32_16x16x32_bf16 v[80:83], v[236:239], v[232:235], v[80:83]
    v_mfma_f32_16x16x32_bf16 v[80:83], v[184:187], v[140:143], v[80:83]
    v_mfma_f32_16x16x32_bf16 v[80:83], v[108:111], v[148:151], v[80:83]
    ds_read_b128 v[188:191], v9 offset:30720
    v_mfma_f32_16x16x32_bf16 v[84:87], v[212:215], v[224:227], v[84:87]
    ds_read_b128 v[252:255], v25 offset:20480
    v_mfma_f32_16x16x32_bf16 v[84:87], v[244:247], v[232:235], v[84:87]
    ds_read_b128 v[112:115], v9 offset:36864
    v_mfma_f32_16x16x32_bf16 v[84:87], v[236:239], v[140:143], v[84:87]
    ds_read_b128 v[220:223], v1 offset:20992
    v_mfma_f32_16x16x32_bf16 v[84:87], v[184:187], v[148:151], v[84:87]
    ds_read_b128 v[120:123], v9 offset:43008
    v_mfma_f32_16x16x32_bf16 v[84:87], v[108:111], v[124:127], v[84:87]
    ds_read_b128 v[228:231], v25 offset:21504
    v_mfma_f32_16x16x32_bf16 v[88:91], v[136:139], v[168:171], v[88:91]
    ds_read_b128 v[180:183], v9 offset:49152
    v_mfma_f32_16x16x32_bf16 v[88:91], v[216:219], v[208:211], v[88:91]
    ds_read_b128 v[128:131], v1 offset:22016
    v_mfma_f32_16x16x32_bf16 v[88:91], v[172:175], v[224:227], v[88:91]
    ds_read_b128 v[116:119], v9 offset:55296
    v_mfma_f32_16x16x32_bf16 v[88:91], v[176:179], v[232:235], v[88:91]
    ds_read_b128 v[192:195], v25 offset:22528
    v_mfma_f32_16x16x32_bf16 v[88:91], v[156:159], v[140:143], v[88:91]
    ds_read_b128 v[240:243], v1 offset:23040
    v_mfma_f32_16x16x32_bf16 v[92:95], v[136:139], v[208:211], v[92:95]
    ds_read_b128 v[196:199], v2 offset:21504
    v_mfma_f32_16x16x32_bf16 v[92:95], v[216:219], v[224:227], v[92:95]
    ds_read_b128 v[248:251], v26 offset:22016
    v_mfma_f32_16x16x32_bf16 v[92:95], v[172:175], v[232:235], v[92:95]
    ds_read_b128 v[152:155], v2 offset:22528
    v_mfma_f32_16x16x32_bf16 v[92:95], v[176:179], v[140:143], v[92:95]
    ds_read_b128 v[204:207], v25 offset:23552
    v_mfma_f32_16x16x32_bf16 v[92:95], v[156:159], v[148:151], v[92:95]
    ds_read_b128 v[160:163], v10 offset:30720
    v_mfma_f32_16x16x32_bf16 v[96:99], v[136:139], v[224:227], v[96:99]
    ds_read_b128 v[200:203], v10 offset:36864
    v_mfma_f32_16x16x32_bf16 v[96:99], v[216:219], v[232:235], v[96:99]
    ds_read_b128 v[132:135], v10 offset:43008
    v_mfma_f32_16x16x32_bf16 v[96:99], v[172:175], v[140:143], v[96:99]
    ds_read_b128 v[144:147], v10 offset:49152
    v_mfma_f32_16x16x32_bf16 v[96:99], v[176:179], v[148:151], v[96:99]
    ds_read_b128 v[164:167], v10 offset:55296
    v_mfma_f32_16x16x32_bf16 v[96:99], v[156:159], v[124:127], v[96:99]
    ds_read_b128 v[212:215], v11 offset:30720
    s_waitcnt lgkmcnt(8)
    v_mfma_f32_16x16x32_bf16 v[28:31], v[188:191], v[252:255], v[28:31]
    ds_read_b128 v[244:247], v11 offset:36864
    v_mfma_f32_16x16x32_bf16 v[28:31], v[112:115], v[220:223], v[28:31]
    ds_read_b128 v[236:239], v11 offset:43008
    v_mfma_f32_16x16x32_bf16 v[28:31], v[120:123], v[228:231], v[28:31]
    ds_read_b128 v[184:187], v11 offset:49152
    v_mfma_f32_16x16x32_bf16 v[28:31], v[180:183], v[128:131], v[28:31]
    ds_read_b128 v[108:111], v11 offset:55296
    v_mfma_f32_16x16x32_bf16 v[28:31], v[116:119], v[192:195], v[28:31]
    v_mfma_f32_16x16x32_bf16 v[32:35], v[188:191], v[220:223], v[32:35]
    v_mfma_f32_16x16x32_bf16 v[32:35], v[112:115], v[228:231], v[32:35]
    v_mfma_f32_16x16x32_bf16 v[32:35], v[120:123], v[128:131], v[32:35]
    v_mfma_f32_16x16x32_bf16 v[32:35], v[180:183], v[192:195], v[32:35]
    v_mfma_f32_16x16x32_bf16 v[32:35], v[116:119], v[240:243], v[32:35]
    v_mfma_f32_16x16x32_bf16 v[100:103], v[120:123], v[196:199], v[100:103]
    v_mfma_f32_16x16x32_bf16 v[100:103], v[180:183], v[248:251], v[100:103]
    s_waitcnt lgkmcnt(0)
    v_mfma_f32_16x16x32_bf16 v[100:103], v[116:119], v[152:155], v[100:103]
    v_mul_f32 v28, s48, v28
    v_mul_f32 v29, s48, v29
    v_mfma_f32_16x16x32_bf16 v[36:39], v[188:191], v[228:231], v[36:39]
    v_mul_f32 v30, s48, v30
    v_mul_f32 v31, s48, v31
    v_mfma_f32_16x16x32_bf16 v[36:39], v[112:115], v[128:131], v[36:39]
    s_barrier
    v_mfma_f32_16x16x32_bf16 v[36:39], v[120:123], v[192:195], v[36:39]
    v_mul_f32 v32, s48, v32
    v_mul_f32 v33, s48, v33
    v_mfma_f32_16x16x32_bf16 v[36:39], v[180:183], v[240:243], v[36:39]
    v_mul_f32 v34, s48, v34
    v_mul_f32 v35, s48, v35
    v_mfma_f32_16x16x32_bf16 v[36:39], v[116:119], v[204:207], v[36:39]
    v_mul_f32 v100, s48, v100
    v_mul_f32 v101, s48, v101
    v_mfma_f32_16x16x32_bf16 v[40:43], v[160:163], v[252:255], v[40:43]
    v_mul_f32 v102, s48, v102
    v_mul_f32 v103, s48, v103
    v_mfma_f32_16x16x32_bf16 v[40:43], v[200:203], v[220:223], v[40:43]
    v_mfma_f32_16x16x32_bf16 v[40:43], v[132:135], v[228:231], v[40:43]
    v_mfma_f32_16x16x32_bf16 v[40:43], v[144:147], v[128:131], v[40:43]
    v_mfma_f32_16x16x32_bf16 v[40:43], v[164:167], v[192:195], v[40:43]
    v_mul_f32 v36, s48, v36
    v_mul_f32 v37, s48, v37
    v_mfma_f32_16x16x32_bf16 v[44:47], v[160:163], v[220:223], v[44:47]
    v_mul_f32 v38, s48, v38
    v_mul_f32 v39, s48, v39
    v_mfma_f32_16x16x32_bf16 v[44:47], v[200:203], v[228:231], v[44:47]
    v_mfma_f32_16x16x32_bf16 v[44:47], v[132:135], v[128:131], v[44:47]
    v_mfma_f32_16x16x32_bf16 v[44:47], v[144:147], v[192:195], v[44:47]
    v_mfma_f32_16x16x32_bf16 v[44:47], v[164:167], v[240:243], v[44:47]
    ds_read_b128 v[168:171], v12 offset:0
    v_mul_f32 v40, s48, v40
    v_mfma_f32_16x16x32_bf16 v[48:51], v[160:163], v[228:231], v[48:51]
    ds_read_b128 v[208:211], v25 offset:30720
    v_mul_f32 v41, s48, v41
    v_mfma_f32_16x16x32_bf16 v[48:51], v[200:203], v[128:131], v[48:51]
    ds_read_b128 v[224:227], v12 offset:6144
    v_mul_f32 v42, s48, v42
    v_mfma_f32_16x16x32_bf16 v[48:51], v[132:135], v[192:195], v[48:51]
    ds_read_b128 v[136:139], v1 offset:31232
    v_mul_f32 v43, s48, v43
    v_mfma_f32_16x16x32_bf16 v[48:51], v[144:147], v[240:243], v[48:51]
    ds_read_b128 v[232:235], v12 offset:12288
    v_mul_f32 v44, s48, v44
    v_mfma_f32_16x16x32_bf16 v[48:51], v[164:167], v[204:207], v[48:51]
    ds_read_b128 v[216:219], v25 offset:31744
    v_mul_f32 v45, s48, v45
    v_mfma_f32_16x16x32_bf16 v[52:55], v[212:215], v[252:255], v[52:55]
    ds_read_b128 v[140:143], v12 offset:18432
    v_mul_f32 v46, s48, v46
    v_mfma_f32_16x16x32_bf16 v[52:55], v[244:247], v[220:223], v[52:55]
    ds_read_b128 v[172:175], v1 offset:32256
    v_mul_f32 v47, s48, v47
    v_mfma_f32_16x16x32_bf16 v[52:55], v[236:239], v[228:231], v[52:55]
    ds_read_b128 v[148:151], v12 offset:24576
    v_mul_f32 v48, s48, v48
    v_mfma_f32_16x16x32_bf16 v[52:55], v[184:187], v[128:131], v[52:55]
    ds_read_b128 v[176:179], v25 offset:32768
    v_mul_f32 v49, s48, v49
    v_mfma_f32_16x16x32_bf16 v[52:55], v[108:111], v[192:195], v[52:55]
    ds_read_b128 v[124:127], v1 offset:33280
    v_mul_f32 v50, s48, v50
    v_mfma_f32_16x16x32_bf16 v[56:59], v[212:215], v[220:223], v[56:59]
    ds_read_b128 v[156:159], v26 offset:32256
    v_mul_f32 v51, s48, v51
    v_mfma_f32_16x16x32_bf16 v[56:59], v[244:247], v[228:231], v[56:59]
    ds_read_b128 v[196:199], v2 offset:32768
    v_mfma_f32_16x16x32_bf16 v[56:59], v[236:239], v[128:131], v[56:59]
    ds_read_b128 v[248:251], v25 offset:33792
    v_mul_f32 v52, s48, v52
    v_mfma_f32_16x16x32_bf16 v[56:59], v[184:187], v[192:195], v[56:59]
    ds_read_b128 v[152:155], v13 offset:0
    v_mul_f32 v53, s48, v53
    v_mfma_f32_16x16x32_bf16 v[56:59], v[108:111], v[240:243], v[56:59]
    ds_read_b128 v[188:191], v13 offset:6144
    v_mul_f32 v54, s48, v54
    v_mfma_f32_16x16x32_bf16 v[60:63], v[212:215], v[228:231], v[60:63]
    ds_read_b128 v[112:115], v13 offset:12288
    v_mul_f32 v55, s48, v55
    v_mfma_f32_16x16x32_bf16 v[60:63], v[244:247], v[128:131], v[60:63]
    ds_read_b128 v[120:123], v13 offset:18432
    v_mfma_f32_16x16x32_bf16 v[60:63], v[236:239], v[192:195], v[60:63]
    ds_read_b128 v[180:183], v13 offset:24576
    v_mul_f32 v56, s48, v56
    v_mfma_f32_16x16x32_bf16 v[60:63], v[184:187], v[240:243], v[60:63]
    ds_read_b128 v[116:119], v14 offset:0
    v_mul_f32 v57, s48, v57
    v_mfma_f32_16x16x32_bf16 v[60:63], v[108:111], v[204:207], v[60:63]
    ds_read_b128 v[160:163], v14 offset:6144
    v_mul_f32 v58, s48, v58
    s_waitcnt lgkmcnt(8)
    v_mfma_f32_16x16x32_bf16 v[64:67], v[168:171], v[208:211], v[64:67]
    ds_read_b128 v[200:203], v14 offset:12288
    v_mul_f32 v59, s48, v59
    v_mfma_f32_16x16x32_bf16 v[64:67], v[224:227], v[136:139], v[64:67]
    ds_read_b128 v[132:135], v14 offset:18432
    v_mfma_f32_16x16x32_bf16 v[64:67], v[232:235], v[216:219], v[64:67]
    ds_read_b128 v[144:147], v14 offset:24576
    v_mul_f32 v60, s48, v60
    v_mfma_f32_16x16x32_bf16 v[64:67], v[140:143], v[172:175], v[64:67]
    v_mul_f32 v61, s48, v61
    v_mul_f32 v62, s48, v62
    v_mfma_f32_16x16x32_bf16 v[64:67], v[148:151], v[176:179], v[64:67]
    v_mul_f32 v63, s48, v63
    v_mfma_f32_16x16x32_bf16 v[68:71], v[168:171], v[136:139], v[68:71]
    v_mfma_f32_16x16x32_bf16 v[68:71], v[224:227], v[216:219], v[68:71]
    v_mfma_f32_16x16x32_bf16 v[68:71], v[232:235], v[172:175], v[68:71]
    v_mfma_f32_16x16x32_bf16 v[68:71], v[140:143], v[176:179], v[68:71]
    v_mfma_f32_16x16x32_bf16 v[68:71], v[148:151], v[124:127], v[68:71]
    v_mfma_f32_16x16x32_bf16 v[104:107], v[140:143], v[156:159], v[104:107]
    v_mfma_f32_16x16x32_bf16 v[104:107], v[148:151], v[196:199], v[104:107]
    v_mfma_f32_16x16x32_bf16 v[72:75], v[168:171], v[216:219], v[72:75]
    v_fmac_f32 v28, s49, v64
    v_fmac_f32 v29, s49, v65
    v_mfma_f32_16x16x32_bf16 v[72:75], v[224:227], v[172:175], v[72:75]
    s_waitcnt lgkmcnt(0)
    s_barrier
    v_mfma_f32_16x16x32_bf16 v[72:75], v[232:235], v[176:179], v[72:75]
    v_fmac_f32 v30, s49, v66
    v_fmac_f32 v31, s49, v67
    v_mfma_f32_16x16x32_bf16 v[72:75], v[140:143], v[124:127], v[72:75]
    v_fmamk_f32 v64, v64, 0xbff9a934, v28
    v_fmamk_f32 v65, v65, 0xbff9a934, v29
    v_mfma_f32_16x16x32_bf16 v[72:75], v[148:151], v[248:251], v[72:75]
    v_fmamk_f32 v66, v66, 0xbff9a934, v30
    v_fmamk_f32 v67, v67, 0xbff9a934, v31
    v_mfma_f32_16x16x32_bf16 v[76:79], v[152:155], v[208:211], v[76:79]
    v_fmac_f32 v32, s49, v68
    v_fmac_f32 v33, s49, v69
    v_mfma_f32_16x16x32_bf16 v[76:79], v[188:191], v[136:139], v[76:79]
    v_fmac_f32 v34, s49, v70
    v_fmac_f32 v35, s49, v71
    v_mfma_f32_16x16x32_bf16 v[76:79], v[112:115], v[216:219], v[76:79]
    v_fmamk_f32 v68, v68, 0xbff9a934, v32
    v_fmamk_f32 v69, v69, 0xbff9a934, v33
    v_mfma_f32_16x16x32_bf16 v[76:79], v[120:123], v[172:175], v[76:79]
    v_fmamk_f32 v70, v70, 0xbff9a934, v34
    v_fmamk_f32 v71, v71, 0xbff9a934, v35
    v_mfma_f32_16x16x32_bf16 v[76:79], v[180:183], v[176:179], v[76:79]
    v_fmac_f32 v100, s49, v104
    v_fmac_f32 v101, s49, v105
    v_mfma_f32_16x16x32_bf16 v[80:83], v[152:155], v[136:139], v[80:83]
    v_fmac_f32 v102, s49, v106
    v_fmac_f32 v103, s49, v107
    v_mfma_f32_16x16x32_bf16 v[80:83], v[188:191], v[216:219], v[80:83]
    v_fmamk_f32 v104, v104, 0xbff9a934, v100
    v_fmamk_f32 v105, v105, 0xbff9a934, v101
    v_mfma_f32_16x16x32_bf16 v[80:83], v[112:115], v[172:175], v[80:83]
    v_fmamk_f32 v106, v106, 0xbff9a934, v102
    v_fmamk_f32 v107, v107, 0xbff9a934, v103
    v_mfma_f32_16x16x32_bf16 v[80:83], v[120:123], v[176:179], v[80:83]
    v_fmac_f32 v36, s49, v72
    v_fmac_f32 v37, s49, v73
    v_mfma_f32_16x16x32_bf16 v[80:83], v[180:183], v[124:127], v[80:83]
    ds_read_b128 v[164:167], v9 offset:0
    v_fmac_f32 v38, s49, v74
    v_mfma_f32_16x16x32_bf16 v[84:87], v[152:155], v[216:219], v[84:87]
    ds_read_b128 v[252:255], v25 offset:0
    v_fmac_f32 v39, s49, v75
    v_mfma_f32_16x16x32_bf16 v[84:87], v[188:191], v[172:175], v[84:87]
    ds_read_b128 v[220:223], v9 offset:6144
    v_fmamk_f32 v72, v72, 0xbff9a934, v36
    v_mfma_f32_16x16x32_bf16 v[84:87], v[112:115], v[176:179], v[84:87]
    ds_read_b128 v[228:231], v1 offset:512
    v_fmamk_f32 v73, v73, 0xbff9a934, v37
    v_mfma_f32_16x16x32_bf16 v[84:87], v[120:123], v[124:127], v[84:87]
    ds_read_b128 v[212:215], v9 offset:12288
    v_fmamk_f32 v74, v74, 0xbff9a934, v38
    v_mfma_f32_16x16x32_bf16 v[84:87], v[180:183], v[248:251], v[84:87]
    ds_read_b128 v[128:131], v25 offset:1024
    v_fmamk_f32 v75, v75, 0xbff9a934, v39
    v_mfma_f32_16x16x32_bf16 v[88:91], v[116:119], v[208:211], v[88:91]
    ds_read_b128 v[244:247], v9 offset:18432
    v_fmac_f32 v40, s49, v76
    v_mfma_f32_16x16x32_bf16 v[88:91], v[160:163], v[136:139], v[88:91]
    ds_read_b128 v[192:195], v1 offset:1536
    v_fmac_f32 v41, s49, v77
    v_mfma_f32_16x16x32_bf16 v[88:91], v[200:203], v[216:219], v[88:91]
    ds_read_b128 v[236:239], v9 offset:24576
    v_fmac_f32 v42, s49, v78
    v_mfma_f32_16x16x32_bf16 v[88:91], v[132:135], v[172:175], v[88:91]
    ds_read_b128 v[240:243], v25 offset:2048
    v_fmac_f32 v43, s49, v79
    v_mfma_f32_16x16x32_bf16 v[88:91], v[144:147], v[176:179], v[88:91]
    ds_read_b128 v[184:187], v1 offset:2560
    v_fmamk_f32 v76, v76, 0xbff9a934, v40
    v_mfma_f32_16x16x32_bf16 v[92:95], v[116:119], v[136:139], v[92:95]
    ds_read_b128 v[204:207], v26 offset:1536
    v_fmamk_f32 v77, v77, 0xbff9a934, v41
    v_mfma_f32_16x16x32_bf16 v[92:95], v[160:163], v[216:219], v[92:95]
    ds_read_b128 v[108:111], v2 offset:2048
    v_fmamk_f32 v78, v78, 0xbff9a934, v42
    v_mfma_f32_16x16x32_bf16 v[92:95], v[200:203], v[172:175], v[92:95]
    ds_read_b128 v[156:159], v25 offset:3072
    v_fmamk_f32 v79, v79, 0xbff9a934, v43
    v_mfma_f32_16x16x32_bf16 v[92:95], v[132:135], v[176:179], v[92:95]
    ds_read_b128 v[196:199], v10 offset:0
    v_fmac_f32 v44, s49, v80
    v_mfma_f32_16x16x32_bf16 v[92:95], v[144:147], v[124:127], v[92:95]
    ds_read_b128 v[168:171], v10 offset:6144
    v_fmac_f32 v45, s49, v81
    v_mfma_f32_16x16x32_bf16 v[96:99], v[116:119], v[216:219], v[96:99]
    ds_read_b128 v[224:227], v10 offset:12288
    v_fmac_f32 v46, s49, v82
    v_mfma_f32_16x16x32_bf16 v[96:99], v[160:163], v[172:175], v[96:99]
    ds_read_b128 v[232:235], v10 offset:18432
    v_fmac_f32 v47, s49, v83
    v_mfma_f32_16x16x32_bf16 v[96:99], v[200:203], v[176:179], v[96:99]
    ds_read_b128 v[140:143], v10 offset:24576
    v_fmamk_f32 v80, v80, 0xbff9a934, v44
    v_mfma_f32_16x16x32_bf16 v[96:99], v[132:135], v[124:127], v[96:99]
    ds_read_b128 v[148:151], v11 offset:0
    v_fmamk_f32 v81, v81, 0xbff9a934, v45
    v_mfma_f32_16x16x32_bf16 v[96:99], v[144:147], v[248:251], v[96:99]
    ds_read_b128 v[152:155], v11 offset:6144
    v_fmamk_f32 v82, v82, 0xbff9a934, v46
    s_waitcnt lgkmcnt(8)
    v_mfma_f32_16x16x32_bf16 v[28:31], v[164:167], v[252:255], v[28:31]
    ds_read_b128 v[188:191], v11 offset:12288
    v_fmamk_f32 v83, v83, 0xbff9a934, v47
    v_mfma_f32_16x16x32_bf16 v[28:31], v[220:223], v[228:231], v[28:31]
    ds_read_b128 v[112:115], v11 offset:18432
    v_fmac_f32 v48, s49, v84
    v_mfma_f32_16x16x32_bf16 v[28:31], v[212:215], v[128:131], v[28:31]
    ds_read_b128 v[120:123], v11 offset:24576
    v_fmac_f32 v49, s49, v85
    v_mfma_f32_16x16x32_bf16 v[28:31], v[244:247], v[192:195], v[28:31]
    v_fmac_f32 v50, s49, v86
    v_fmac_f32 v51, s49, v87
    v_mfma_f32_16x16x32_bf16 v[28:31], v[236:239], v[240:243], v[28:31]
    v_fmamk_f32 v84, v84, 0xbff9a934, v48
    v_fmamk_f32 v85, v85, 0xbff9a934, v49
    v_mfma_f32_16x16x32_bf16 v[32:35], v[164:167], v[228:231], v[32:35]
    v_fmamk_f32 v86, v86, 0xbff9a934, v50
    v_fmamk_f32 v87, v87, 0xbff9a934, v51
    v_mfma_f32_16x16x32_bf16 v[32:35], v[220:223], v[128:131], v[32:35]
    v_fmac_f32 v52, s49, v88
    v_fmac_f32 v53, s49, v89
    v_mfma_f32_16x16x32_bf16 v[32:35], v[212:215], v[192:195], v[32:35]
    v_fmac_f32 v54, s49, v90
    v_fmac_f32 v55, s49, v91
    v_mfma_f32_16x16x32_bf16 v[32:35], v[244:247], v[240:243], v[32:35]
    v_fmamk_f32 v88, v88, 0xbff9a934, v52
    v_fmamk_f32 v89, v89, 0xbff9a934, v53
    v_mfma_f32_16x16x32_bf16 v[32:35], v[236:239], v[184:187], v[32:35]
    v_fmamk_f32 v90, v90, 0xbff9a934, v54
    v_fmamk_f32 v91, v91, 0xbff9a934, v55
    v_mfma_f32_16x16x32_bf16 v[100:103], v[244:247], v[204:207], v[100:103]
    v_fmac_f32 v56, s49, v92
    v_fmac_f32 v57, s49, v93
    v_mfma_f32_16x16x32_bf16 v[100:103], v[236:239], v[108:111], v[100:103]
    v_fmac_f32 v58, s49, v94
    v_fmac_f32 v59, s49, v95
    v_mfma_f32_16x16x32_bf16 v[36:39], v[164:167], v[128:131], v[36:39]
    v_fmamk_f32 v92, v92, 0xbff9a934, v56
    v_fmamk_f32 v93, v93, 0xbff9a934, v57
    v_mfma_f32_16x16x32_bf16 v[36:39], v[220:223], v[192:195], v[36:39]
    v_fmamk_f32 v94, v94, 0xbff9a934, v58
    v_fmamk_f32 v95, v95, 0xbff9a934, v59
    v_mfma_f32_16x16x32_bf16 v[36:39], v[212:215], v[240:243], v[36:39]
    s_waitcnt lgkmcnt(0)
    s_barrier
    v_mfma_f32_16x16x32_bf16 v[36:39], v[244:247], v[184:187], v[36:39]
    v_fmac_f32 v60, s49, v96
    v_fmac_f32 v61, s49, v97
    v_mfma_f32_16x16x32_bf16 v[36:39], v[236:239], v[156:159], v[36:39]
    v_fmac_f32 v62, s49, v98
    v_fmac_f32 v63, s49, v99
    v_mfma_f32_16x16x32_bf16 v[40:43], v[196:199], v[252:255], v[40:43]
    v_fmamk_f32 v96, v96, 0xbff9a934, v60
    v_fmamk_f32 v97, v97, 0xbff9a934, v61
    v_mfma_f32_16x16x32_bf16 v[40:43], v[168:171], v[228:231], v[40:43]
    v_fmamk_f32 v98, v98, 0xbff9a934, v62
    v_fmamk_f32 v99, v99, 0xbff9a934, v63
    v_mfma_f32_16x16x32_bf16 v[40:43], v[224:227], v[128:131], v[40:43]
    v_mul_f32 v64, s56, v64
    v_mul_f32 v65, s56, v65
    v_mfma_f32_16x16x32_bf16 v[40:43], v[232:235], v[192:195], v[40:43]
    v_mul_f32 v66, s56, v66
    v_mul_f32 v67, s56, v67
    v_mfma_f32_16x16x32_bf16 v[40:43], v[140:143], v[240:243], v[40:43]
    v_mul_f32 v68, s56, v68
    v_mul_f32 v69, s56, v69
    v_mfma_f32_16x16x32_bf16 v[44:47], v[196:199], v[228:231], v[44:47]
    v_mul_f32 v70, s56, v70
    v_mul_f32 v71, s56, v71
    v_mfma_f32_16x16x32_bf16 v[44:47], v[168:171], v[128:131], v[44:47]
    v_mul_f32 v104, s56, v104
    v_mul_f32 v105, s56, v105
    v_mfma_f32_16x16x32_bf16 v[44:47], v[224:227], v[192:195], v[44:47]
    v_mul_f32 v106, s56, v106
    v_mul_f32 v107, s56, v107
    v_mfma_f32_16x16x32_bf16 v[44:47], v[232:235], v[240:243], v[44:47]
    v_mul_f32 v72, s56, v72
    v_mul_f32 v73, s56, v73
    v_mfma_f32_16x16x32_bf16 v[44:47], v[140:143], v[184:187], v[44:47]
    v_mul_f32 v74, s56, v74
    v_mul_f32 v75, s56, v75
    v_mfma_f32_16x16x32_bf16 v[48:51], v[196:199], v[128:131], v[48:51]
    ds_read_b128 v[180:183], v9 offset:30720
    v_mul_f32 v76, s56, v76
    v_mfma_f32_16x16x32_bf16 v[48:51], v[168:171], v[192:195], v[48:51]
    ds_read_b128 v[208:211], v25 offset:10240
    v_mul_f32 v77, s56, v77
    v_mfma_f32_16x16x32_bf16 v[48:51], v[224:227], v[240:243], v[48:51]
    ds_read_b128 v[136:139], v9 offset:36864
    v_mul_f32 v78, s56, v78
    v_mfma_f32_16x16x32_bf16 v[48:51], v[232:235], v[184:187], v[48:51]
    ds_read_b128 v[216:219], v1 offset:10752
    v_mul_f32 v79, s56, v79
    v_mfma_f32_16x16x32_bf16 v[48:51], v[140:143], v[156:159], v[48:51]
    ds_read_b128 v[116:119], v9 offset:43008
    v_mul_f32 v80, s56, v80
    v_mfma_f32_16x16x32_bf16 v[52:55], v[148:151], v[252:255], v[52:55]
    ds_read_b128 v[172:175], v25 offset:11264
    v_mul_f32 v81, s56, v81
    v_mfma_f32_16x16x32_bf16 v[52:55], v[152:155], v[228:231], v[52:55]
    ds_read_b128 v[160:163], v9 offset:49152
    v_mul_f32 v82, s56, v82
    v_mfma_f32_16x16x32_bf16 v[52:55], v[188:191], v[128:131], v[52:55]
    ds_read_b128 v[176:179], v1 offset:11776
    v_mul_f32 v83, s56, v83
    v_mfma_f32_16x16x32_bf16 v[52:55], v[112:115], v[192:195], v[52:55]
    ds_read_b128 v[200:203], v9 offset:55296
    v_mul_f32 v84, s56, v84
    v_mfma_f32_16x16x32_bf16 v[52:55], v[120:123], v[240:243], v[52:55]
    ds_read_b128 v[124:127], v25 offset:12288
    v_mul_f32 v85, s56, v85
    v_mfma_f32_16x16x32_bf16 v[56:59], v[148:151], v[228:231], v[56:59]
    ds_read_b128 v[132:135], v1 offset:12800
    v_mul_f32 v86, s56, v86
    v_mfma_f32_16x16x32_bf16 v[56:59], v[152:155], v[128:131], v[56:59]
    ds_read_b128 v[248:251], v2 offset:11264
    v_mul_f32 v87, s56, v87
    v_mfma_f32_16x16x32_bf16 v[56:59], v[188:191], v[192:195], v[56:59]
    ds_read_b128 v[144:147], v26 offset:11776
    v_mul_f32 v88, s56, v88
    v_mfma_f32_16x16x32_bf16 v[56:59], v[112:115], v[240:243], v[56:59]
    ds_read_b128 v[204:207], v2 offset:12288
    v_mul_f32 v89, s56, v89
    v_mfma_f32_16x16x32_bf16 v[56:59], v[120:123], v[184:187], v[56:59]
    ds_read_b128 v[108:111], v25 offset:13312
    v_mul_f32 v90, s56, v90
    v_mfma_f32_16x16x32_bf16 v[60:63], v[148:151], v[128:131], v[60:63]
    ds_read_b128 v[164:167], v10 offset:30720
    v_mul_f32 v91, s56, v91
    v_mfma_f32_16x16x32_bf16 v[60:63], v[152:155], v[192:195], v[60:63]
    ds_read_b128 v[220:223], v10 offset:36864
    v_mul_f32 v92, s56, v92
    v_mfma_f32_16x16x32_bf16 v[60:63], v[188:191], v[240:243], v[60:63]
    ds_read_b128 v[212:215], v10 offset:43008
    v_mul_f32 v93, s56, v93
    v_mfma_f32_16x16x32_bf16 v[60:63], v[112:115], v[184:187], v[60:63]
    ds_read_b128 v[244:247], v10 offset:49152
    v_mul_f32 v94, s56, v94
    v_mfma_f32_16x16x32_bf16 v[60:63], v[120:123], v[156:159], v[60:63]
    ds_read_b128 v[236:239], v10 offset:55296
    v_mul_f32 v95, s56, v95
    s_waitcnt lgkmcnt(8)
    v_mfma_f32_16x16x32_bf16 v[64:67], v[180:183], v[208:211], v[64:67]
    ds_read_b128 v[196:199], v11 offset:30720
    v_mul_f32 v96, s56, v96
    v_mfma_f32_16x16x32_bf16 v[64:67], v[136:139], v[216:219], v[64:67]
    ds_read_b128 v[168:171], v11 offset:36864
    v_mul_f32 v97, s56, v97
    v_mfma_f32_16x16x32_bf16 v[64:67], v[116:119], v[172:175], v[64:67]
    ds_read_b128 v[224:227], v11 offset:43008
    v_mul_f32 v98, s56, v98
    v_mfma_f32_16x16x32_bf16 v[64:67], v[160:163], v[176:179], v[64:67]
    ds_read_b128 v[232:235], v11 offset:49152
    ds_read_b128 v[140:143], v11 offset:55296
    v_mfma_f32_16x16x32_bf16 v[64:67], v[200:203], v[124:127], v[64:67]
    v_mul_f32 v99, s56, v99
    v_mfma_f32_16x16x32_bf16 v[68:71], v[180:183], v[216:219], v[68:71]
    v_mfma_f32_16x16x32_bf16 v[68:71], v[136:139], v[172:175], v[68:71]
    v_mfma_f32_16x16x32_bf16 v[68:71], v[116:119], v[176:179], v[68:71]
    v_mfma_f32_16x16x32_bf16 v[68:71], v[160:163], v[124:127], v[68:71]
    v_mfma_f32_16x16x32_bf16 v[68:71], v[200:203], v[132:135], v[68:71]
    v_mfma_f32_16x16x32_bf16 v[104:107], v[116:119], v[248:251], v[104:107]
    s_waitcnt lgkmcnt(2)
    v_mfma_f32_16x16x32_bf16 v[104:107], v[160:163], v[144:147], v[104:107]
    v_mfma_f32_16x16x32_bf16 v[104:107], v[200:203], v[204:207], v[104:107]
    v_mfma_f32_16x16x32_bf16 v[72:75], v[180:183], v[172:175], v[72:75]
    v_mfma_f32_16x16x32_bf16 v[72:75], v[136:139], v[176:179], v[72:75]
    s_waitcnt lgkmcnt(0)
    s_barrier
    v_mfma_f32_16x16x32_bf16 v[72:75], v[116:119], v[124:127], v[72:75]
    v_mfma_f32_16x16x32_bf16 v[72:75], v[160:163], v[132:135], v[72:75]
    v_mfma_f32_16x16x32_bf16 v[72:75], v[200:203], v[108:111], v[72:75]
    v_mfma_f32_16x16x32_bf16 v[76:79], v[164:167], v[208:211], v[76:79]
    v_mfma_f32_16x16x32_bf16 v[76:79], v[220:223], v[216:219], v[76:79]
    v_mfma_f32_16x16x32_bf16 v[76:79], v[212:215], v[172:175], v[76:79]
    v_mfma_f32_16x16x32_bf16 v[76:79], v[244:247], v[176:179], v[76:79]
    v_mfma_f32_16x16x32_bf16 v[76:79], v[236:239], v[124:127], v[76:79]
    v_mfma_f32_16x16x32_bf16 v[80:83], v[164:167], v[216:219], v[80:83]
    v_mfma_f32_16x16x32_bf16 v[80:83], v[220:223], v[172:175], v[80:83]
    v_mfma_f32_16x16x32_bf16 v[80:83], v[212:215], v[176:179], v[80:83]
    v_mfma_f32_16x16x32_bf16 v[80:83], v[244:247], v[124:127], v[80:83]
    v_mfma_f32_16x16x32_bf16 v[80:83], v[236:239], v[132:135], v[80:83]
    v_mfma_f32_16x16x32_bf16 v[84:87], v[164:167], v[172:175], v[84:87]
    v_mfma_f32_16x16x32_bf16 v[84:87], v[220:223], v[176:179], v[84:87]
    v_mfma_f32_16x16x32_bf16 v[84:87], v[212:215], v[124:127], v[84:87]
    v_mfma_f32_16x16x32_bf16 v[84:87], v[244:247], v[132:135], v[84:87]
    v_mfma_f32_16x16x32_bf16 v[84:87], v[236:239], v[108:111], v[84:87]
    v_mfma_f32_16x16x32_bf16 v[88:91], v[196:199], v[208:211], v[88:91]
    s_branch L_is10
.p2align 12
L_pg10:
    s_setpc_b64 s[62:63]
L_is10:
    ds_read_b128 v[252:255], v6 offset:0
    v_mfma_f32_16x16x32_bf16 v[88:91], v[168:171], v[216:219], v[88:91]
    ds_read_b128 v[228:231], v25 offset:20480
    v_mfma_f32_16x16x32_bf16 v[88:91], v[224:227], v[172:175], v[88:91]
    ds_read_b128 v[128:131], v6 offset:2048
    v_mfma_f32_16x16x32_bf16 v[88:91], v[232:235], v[176:179], v[88:91]
    ds_read_b128 v[148:151], v1 offset:20992
    v_mfma_f32_16x16x32_bf16 v[88:91], v[140:143], v[124:127], v[88:91]
    ds_read_b128 v[192:195], v6 offset:4096
    v_mfma_f32_16x16x32_bf16 v[92:95], v[196:199], v[216:219], v[92:95]
    ds_read_b128 v[152:155], v25 offset:21504
    v_mfma_f32_16x16x32_bf16 v[92:95], v[168:171], v[172:175], v[92:95]
    ds_read_b128 v[240:243], v6 offset:6144
    v_mfma_f32_16x16x32_bf16 v[92:95], v[224:227], v[176:179], v[92:95]
    ds_read_b128 v[188:191], v1 offset:22016
    v_mfma_f32_16x16x32_bf16 v[92:95], v[232:235], v[124:127], v[92:95]
    ds_read_b128 v[184:187], v6 offset:8192
    ds_read_b128 v[112:115], v25 offset:22528
    v_mfma_f32_16x16x32_bf16 v[92:95], v[140:143], v[132:135], v[92:95]
    ds_read_b128 v[156:159], v1 offset:23040
    v_mfma_f32_16x16x32_bf16 v[96:99], v[196:199], v[172:175], v[96:99]
    ds_read_b128 v[120:123], v2 offset:21504
    v_mfma_f32_16x16x32_bf16 v[96:99], v[168:171], v[176:179], v[96:99]
    ds_read_b128 v[248:251], v26 offset:22016
    v_mfma_f32_16x16x32_bf16 v[96:99], v[224:227], v[124:127], v[96:99]
    ds_read_b128 v[144:147], v2 offset:22528
    v_mfma_f32_16x16x32_bf16 v[96:99], v[232:235], v[132:135], v[96:99]
    v_mfma_f32_16x16x32_bf16 v[96:99], v[140:143], v[108:111], v[96:99]
    ds_read_b128 v[204:207], v6 offset:10240
    s_waitcnt lgkmcnt(8)
    v_mfma_f32_16x16x32_bf16 v[28:31], v[252:255], v[228:231], v[28:31]
    ds_read_b128 v[180:183], v6 offset:12288
    v_mfma_f32_16x16x32_bf16 v[28:31], v[128:131], v[148:151], v[28:31]
    ds_read_b128 v[136:139], v6 offset:14336
    v_mfma_f32_16x16x32_bf16 v[28:31], v[192:195], v[152:155], v[28:31]
    ds_read_b128 v[116:119], v6 offset:16384
    s_waitcnt lgkmcnt(7)
    v_mfma_f32_16x16x32_bf16 v[28:31], v[240:243], v[188:191], v[28:31]
    ds_read_b128 v[160:163], v6 offset:18432
    ds_read_b128 v[200:203], v6 offset:20480
    v_mfma_f32_16x16x32_bf16 v[28:31], v[184:187], v[112:115], v[28:31]
    ds_read_b128 v[164:167], v6 offset:22528
    ds_read_b128 v[220:223], v6 offset:24576
    v_mfma_f32_16x16x32_bf16 v[32:35], v[252:255], v[148:151], v[32:35]
    ds_read_b128 v[212:215], v6 offset:26624
    ds_read_b128 v[244:247], v6 offset:28672
    v_mfma_f32_16x16x32_bf16 v[32:35], v[128:131], v[152:155], v[32:35]
    ds_read_b128 v[236:239], v25 offset:23552
    v_mfma_f32_16x16x32_bf16 v[32:35], v[192:195], v[188:191], v[32:35]
    ds_read_b128 v[208:211], v25 offset:30720
    v_mfma_f32_16x16x32_bf16 v[32:35], v[240:243], v[112:115], v[32:35]
    ds_read_b128 v[216:219], v1 offset:31232
    v_mfma_f32_16x16x32_bf16 v[32:35], v[184:187], v[156:159], v[32:35]
    ds_read_b128 v[172:175], v25 offset:31744
    s_waitcnt lgkmcnt(11)
    v_mfma_f32_16x16x32_bf16 v[100:103], v[192:195], v[120:123], v[100:103]
    ds_read_b128 v[196:199], v1 offset:32256
    v_mfma_f32_16x16x32_bf16 v[100:103], v[240:243], v[248:251], v[100:103]
    ds_read_b128 v[176:179], v25 offset:32768
    v_mfma_f32_16x16x32_bf16 v[100:103], v[184:187], v[144:147], v[100:103]
    ds_read_b128 v[168:171], v1 offset:33280
    v_mfma_f32_16x16x32_bf16 v[36:39], v[252:255], v[152:155], v[36:39]
    ds_read_b128 v[124:127], v26 offset:32256
    v_mfma_f32_16x16x32_bf16 v[36:39], v[128:131], v[188:191], v[36:39]
    s_waitcnt lgkmcnt(8)
    s_barrier
    v_mfma_f32_16x16x32_bf16 v[36:39], v[192:195], v[112:115], v[36:39]
    ds_read_b128 v[224:227], v2 offset:32768
    v_mfma_f32_16x16x32_bf16 v[36:39], v[240:243], v[156:159], v[36:39]
    s_waitcnt lgkmcnt(6)
    v_mfma_f32_16x16x32_bf16 v[36:39], v[184:187], v[236:239], v[36:39]
    v_mfma_f32_16x16x32_bf16 v[64:67], v[204:207], v[208:211], v[64:67]
    v_mfma_f32_16x16x32_bf16 v[64:67], v[180:183], v[216:219], v[64:67]
    ds_read_b128 v[132:135], v25 offset:33792
    s_waitcnt lgkmcnt(4)
    v_mfma_f32_16x16x32_bf16 v[64:67], v[136:139], v[172:175], v[64:67]
    ds_read_b128 v[232:235], v25 offset:0
    v_mfma_f32_16x16x32_bf16 v[64:67], v[116:119], v[196:199], v[64:67]
    ds_read_b128 v[108:111], v1 offset:512
    v_mfma_f32_16x16x32_bf16 v[64:67], v[160:163], v[176:179], v[64:67]
    ds_read_b128 v[140:143], v25 offset:1024
    v_mfma_f32_16x16x32_bf16 v[68:71], v[204:207], v[216:219], v[68:71]
    ds_read_b128 v[120:123], v1 offset:1536
    v_mfma_f32_16x16x32_bf16 v[68:71], v[180:183], v[172:175], v[68:71]
    ds_read_b128 v[248:251], v25 offset:2048
    v_mfma_f32_16x16x32_bf16 v[68:71], v[136:139], v[196:199], v[68:71]
    ds_read_b128 v[144:147], v1 offset:2560
    v_mfma_f32_16x16x32_bf16 v[68:71], v[116:119], v[176:179], v[68:71]
    ds_read_b128 v[252:255], v26 offset:1536
    s_waitcnt lgkmcnt(8)
    v_mfma_f32_16x16x32_bf16 v[68:71], v[160:163], v[168:171], v[68:71]
    ds_read_b128 v[128:131], v2 offset:2048
    v_mfma_f32_16x16x32_bf16 v[104:107], v[116:119], v[124:127], v[104:107]
    ds_read_b128 v[192:195], v25 offset:3072
    v_mfma_f32_16x16x32_bf16 v[104:107], v[160:163], v[224:227], v[104:107]
    ds_read_b128 v[240:243], v2 offset:11264
    v_mfma_f32_16x16x32_bf16 v[72:75], v[204:207], v[172:175], v[72:75]
    ds_read_b128 v[184:187], v26 offset:11776
    v_mfma_f32_16x16x32_bf16 v[72:75], v[180:183], v[196:199], v[72:75]
    ds_read_b128 v[124:127], v2 offset:12288
    v_mfma_f32_16x16x32_bf16 v[72:75], v[136:139], v[176:179], v[72:75]
    ds_read_b128 v[224:227], v3 offset:4096
    v_mfma_f32_16x16x32_bf16 v[72:75], v[116:119], v[168:171], v[72:75]
    ds_read_b128 v[204:207], v3 offset:6144
    s_waitcnt lgkmcnt(8)
    v_mfma_f32_16x16x32_bf16 v[72:75], v[160:163], v[132:135], v[72:75]
    ds_read_b128 v[180:183], v3 offset:8192
    v_mfma_f32_16x16x32_bf16 v[28:31], v[200:203], v[232:235], v[28:31]
    ds_read_b128 v[136:139], v3 offset:0
    v_mfma_f32_16x16x32_bf16 v[28:31], v[164:167], v[108:111], v[28:31]
    ds_read_b128 v[116:119], v25 offset:10240
    v_mfma_f32_16x16x32_bf16 v[28:31], v[220:223], v[140:143], v[28:31]
    ds_read_b128 v[160:163], v3 offset:2048
    v_mfma_f32_16x16x32_bf16 v[28:31], v[212:215], v[120:123], v[28:31]
    v_mfma_f32_16x16x32_bf16 v[28:31], v[244:247], v[248:251], v[28:31]
    v_mfma_f32_16x16x32_bf16 v[32:35], v[200:203], v[108:111], v[32:35]
    v_mfma_f32_16x16x32_bf16 v[32:35], v[164:167], v[140:143], v[32:35]
    v_mfma_f32_16x16x32_bf16 v[32:35], v[220:223], v[120:123], v[32:35]
    v_mfma_f32_16x16x32_bf16 v[32:35], v[212:215], v[248:251], v[32:35]
    v_mfma_f32_16x16x32_bf16 v[32:35], v[244:247], v[144:147], v[32:35]
    s_waitcnt lgkmcnt(1)
    v_mfma_f32_16x16x32_bf16 v[100:103], v[212:215], v[252:255], v[100:103]
    ds_read_b128 v[252:255], v1 offset:10752
    v_mfma_f32_16x16x32_bf16 v[100:103], v[244:247], v[128:131], v[100:103]
    ds_read_b128 v[128:131], v25 offset:11264
    v_mfma_f32_16x16x32_bf16 v[36:39], v[200:203], v[140:143], v[36:39]
    ds_read_b128 v[200:203], v1 offset:11776
    v_mfma_f32_16x16x32_bf16 v[36:39], v[164:167], v[120:123], v[36:39]
    ds_read_b128 v[164:167], v25 offset:12288
    v_mfma_f32_16x16x32_bf16 v[36:39], v[220:223], v[248:251], v[36:39]
    ds_read_b128 v[220:223], v1 offset:12800
    v_mfma_f32_16x16x32_bf16 v[36:39], v[212:215], v[144:147], v[36:39]
    ds_read_b128 v[212:215], v25 offset:13312
    v_mfma_f32_16x16x32_bf16 v[36:39], v[244:247], v[192:195], v[36:39]
    ds_read_b128 v[244:247], v3 offset:10240
    v_mfma_f32_16x16x32_bf16 v[104:107], v[224:227], v[240:243], v[104:107]
    ds_read_b128 v[240:243], v3 offset:12288
    v_mfma_f32_16x16x32_bf16 v[104:107], v[204:207], v[184:187], v[104:107]
    ds_read_b128 v[184:187], v3 offset:14336
    v_mfma_f32_16x16x32_bf16 v[104:107], v[180:183], v[124:127], v[104:107]
    ds_read_b128 v[124:127], v3 offset:16384
    v_mfma_f32_16x16x32_bf16 v[64:67], v[136:139], v[116:119], v[64:67]
    s_waitcnt lgkmcnt(7)
    v_mfma_f32_16x16x32_bf16 v[64:67], v[160:163], v[252:255], v[64:67]
    v_mfma_f32_16x16x32_bf16 v[64:67], v[224:227], v[128:131], v[64:67]
    v_mfma_f32_16x16x32_bf16 v[64:67], v[204:207], v[200:203], v[64:67]
    s_waitcnt lgkmcnt(4)
    v_mfma_f32_16x16x32_bf16 v[64:67], v[180:183], v[164:167], v[64:67]
    v_mfma_f32_16x16x32_bf16 v[68:71], v[136:139], v[252:255], v[68:71]
    v_fmac_f32 v100, s57, v104
    v_fmac_f32 v101, s57, v105
    v_mfma_f32_16x16x32_bf16 v[68:71], v[160:163], v[128:131], v[68:71]
    v_fmac_f32 v102, s57, v106
    v_fmac_f32 v103, s57, v107
    v_mfma_f32_16x16x32_bf16 v[68:71], v[224:227], v[200:203], v[68:71]
    v_fmac_f32 v104, s58, v100
    v_fmac_f32 v105, s58, v101
    v_mfma_f32_16x16x32_bf16 v[68:71], v[204:207], v[164:167], v[68:71]
    v_fmac_f32 v106, s58, v102
    v_fmac_f32 v107, s58, v103
    v_mfma_f32_16x16x32_bf16 v[68:71], v[180:183], v[220:223], v[68:71]
    ds_write_b128 v16, v[100:103] offset:1024
    ds_write_b128 v16, v[104:107] offset:1536
    v_mfma_f32_16x16x32_bf16 v[72:75], v[136:139], v[128:131], v[72:75]
    ds_read_b128 v[136:139], v3 offset:18432
    v_fmac_f32 v28, s57, v64
    v_mfma_f32_16x16x32_bf16 v[72:75], v[160:163], v[200:203], v[72:75]
    s_barrier
    v_mfma_f32_16x16x32_bf16 v[72:75], v[224:227], v[164:167], v[72:75]
    ds_read_b128 v[160:163], v3 offset:20480
    v_fmac_f32 v29, s57, v65
    v_mfma_f32_16x16x32_bf16 v[72:75], v[204:207], v[220:223], v[72:75]
    ds_read_b128 v[224:227], v3 offset:22528
    v_fmac_f32 v30, s57, v66
    v_mfma_f32_16x16x32_bf16 v[72:75], v[180:183], v[212:215], v[72:75]
    ds_read_b128 v[204:207], v3 offset:24576
    v_fmac_f32 v31, s57, v67
    s_waitcnt lgkmcnt(6)
    v_mfma_f32_16x16x32_bf16 v[40:43], v[244:247], v[228:231], v[40:43]
    ds_read_b128 v[180:183], v3 offset:26624
    v_fmac_f32 v64, s58, v28
    v_mfma_f32_16x16x32_bf16 v[40:43], v[240:243], v[148:151], v[40:43]
    v_fmac_f32 v65, s58, v29
    v_fmac_f32 v66, s58, v30
    v_mfma_f32_16x16x32_bf16 v[40:43], v[184:187], v[152:155], v[40:43]
    v_fmac_f32 v67, s58, v31
    v_cvt_pk_bf16_f32 v28, v28, v29
    v_mfma_f32_16x16x32_bf16 v[40:43], v[124:127], v[188:191], v[40:43]
    v_cvt_pk_bf16_f32 v29, v30, v31
    ds_write_b64 v15, v[28:29] offset:0
    s_waitcnt lgkmcnt(5)
    v_mfma_f32_16x16x32_bf16 v[40:43], v[136:139], v[112:115], v[40:43]
    v_cvt_pk_bf16_f32 v64, v64, v65
    v_cvt_pk_bf16_f32 v65, v66, v67
    v_mfma_f32_16x16x32_bf16 v[44:47], v[244:247], v[148:151], v[44:47]
    ds_write_b64 v15, v[64:65] offset:512
    v_fmac_f32 v32, s57, v68
    v_mfma_f32_16x16x32_bf16 v[44:47], v[240:243], v[152:155], v[44:47]
    v_fmac_f32 v33, s57, v69
    v_fmac_f32 v34, s57, v70
    v_mfma_f32_16x16x32_bf16 v[44:47], v[184:187], v[188:191], v[44:47]
    v_fmac_f32 v35, s57, v71
    v_fmac_f32 v68, s58, v32
    v_mfma_f32_16x16x32_bf16 v[44:47], v[124:127], v[112:115], v[44:47]
    v_fmac_f32 v69, s58, v33
    v_fmac_f32 v70, s58, v34
    v_mfma_f32_16x16x32_bf16 v[44:47], v[136:139], v[156:159], v[44:47]
    v_fmac_f32 v71, s58, v35
    v_cvt_pk_bf16_f32 v32, v32, v33
    v_mfma_f32_16x16x32_bf16 v[48:51], v[244:247], v[152:155], v[48:51]
    ds_read_b128 v[244:247], v3 offset:28672
    v_cvt_pk_bf16_f32 v33, v34, v35
    v_mfma_f32_16x16x32_bf16 v[48:51], v[240:243], v[188:191], v[48:51]
    ds_read_b128 v[240:243], v3 offset:30720
    ds_write_b64 v15, v[32:33] offset:1024
    v_mfma_f32_16x16x32_bf16 v[48:51], v[184:187], v[112:115], v[48:51]
    ds_read_b128 v[184:187], v3 offset:32768
    v_cvt_pk_bf16_f32 v68, v68, v69
    v_mfma_f32_16x16x32_bf16 v[48:51], v[124:127], v[156:159], v[48:51]
    s_waitcnt lgkmcnt(4)
    s_barrier
    v_mfma_f32_16x16x32_bf16 v[48:51], v[136:139], v[236:239], v[48:51]
    ds_read_b128 v[124:127], v3 offset:34816
    v_cvt_pk_bf16_f32 v69, v70, v71
    v_mfma_f32_16x16x32_bf16 v[76:79], v[160:163], v[208:211], v[76:79]
    ds_read_b128 v[136:139], v3 offset:36864
    ds_write_b64 v15, v[68:69] offset:1536
    v_mfma_f32_16x16x32_bf16 v[76:79], v[224:227], v[216:219], v[76:79]
    v_fmac_f32 v36, s57, v72
    v_fmac_f32 v37, s57, v73
    v_mfma_f32_16x16x32_bf16 v[76:79], v[204:207], v[172:175], v[76:79]
    v_fmac_f32 v38, s57, v74
    v_fmac_f32 v39, s57, v75
    v_mfma_f32_16x16x32_bf16 v[76:79], v[180:183], v[196:199], v[76:79]
    v_fmac_f32 v72, s58, v36
    v_fmac_f32 v73, s58, v37
    s_waitcnt lgkmcnt(6)
    v_mfma_f32_16x16x32_bf16 v[76:79], v[244:247], v[176:179], v[76:79]
    v_fmac_f32 v74, s58, v38
    v_fmac_f32 v75, s58, v39
    v_mfma_f32_16x16x32_bf16 v[80:83], v[160:163], v[216:219], v[80:83]
    s_waitcnt lgkmcnt(0)
    s_barrier
    v_mfma_f32_16x16x32_bf16 v[80:83], v[224:227], v[172:175], v[80:83]
    v_cvt_pk_bf16_f32 v36, v36, v37
    v_cvt_pk_bf16_f32 v37, v38, v39
    v_mfma_f32_16x16x32_bf16 v[80:83], v[204:207], v[196:199], v[80:83]
    ds_write_b64 v15, v[36:37] offset:2048
    v_cvt_pk_bf16_f32 v72, v72, v73
    v_mfma_f32_16x16x32_bf16 v[80:83], v[180:183], v[176:179], v[80:83]
    v_cvt_pk_bf16_f32 v73, v74, v75
    ds_write_b64 v15, v[72:73] offset:2560
    v_mfma_f32_16x16x32_bf16 v[80:83], v[244:247], v[168:171], v[80:83]
    v_mfma_f32_16x16x32_bf16 v[84:87], v[160:163], v[172:175], v[84:87]
    ds_read_b128 v[160:163], v3 offset:38912
    v_mfma_f32_16x16x32_bf16 v[84:87], v[224:227], v[196:199], v[84:87]
    ds_read_b128 v[224:227], v3 offset:40960
    v_mfma_f32_16x16x32_bf16 v[84:87], v[204:207], v[176:179], v[84:87]
    ds_read_b128 v[204:207], v3 offset:43008
    v_mfma_f32_16x16x32_bf16 v[84:87], v[180:183], v[168:171], v[84:87]
    s_waitcnt lgkmcnt(3)
    s_barrier
    v_mfma_f32_16x16x32_bf16 v[84:87], v[244:247], v[132:135], v[84:87]
    ds_read_b128 v[180:183], v3 offset:45056
    v_mfma_f32_16x16x32_bf16 v[40:43], v[240:243], v[232:235], v[40:43]
    ds_read_b128 v[244:247], v3 offset:47104
    v_mfma_f32_16x16x32_bf16 v[40:43], v[184:187], v[108:111], v[40:43]
    v_mfma_f32_16x16x32_bf16 v[40:43], v[124:127], v[140:143], v[40:43]
    v_mfma_f32_16x16x32_bf16 v[40:43], v[136:139], v[120:123], v[40:43]
    s_waitcnt lgkmcnt(4)
    v_mfma_f32_16x16x32_bf16 v[40:43], v[160:163], v[248:251], v[40:43]
    v_mfma_f32_16x16x32_bf16 v[44:47], v[240:243], v[108:111], v[44:47]
    v_mfma_f32_16x16x32_bf16 v[44:47], v[184:187], v[140:143], v[44:47]
    v_mfma_f32_16x16x32_bf16 v[44:47], v[124:127], v[120:123], v[44:47]
    v_mfma_f32_16x16x32_bf16 v[44:47], v[136:139], v[248:251], v[44:47]
    v_mfma_f32_16x16x32_bf16 v[44:47], v[160:163], v[144:147], v[44:47]
    v_mfma_f32_16x16x32_bf16 v[48:51], v[240:243], v[140:143], v[48:51]
    ds_read_b128 v[240:243], v3 offset:49152
    v_mfma_f32_16x16x32_bf16 v[48:51], v[184:187], v[120:123], v[48:51]
    ds_read_b128 v[184:187], v3 offset:51200
    v_mfma_f32_16x16x32_bf16 v[48:51], v[124:127], v[248:251], v[48:51]
    ds_read_b128 v[124:127], v3 offset:53248
    v_mfma_f32_16x16x32_bf16 v[48:51], v[136:139], v[144:147], v[48:51]
    ds_read_b128 v[136:139], v3 offset:55296
    v_mfma_f32_16x16x32_bf16 v[48:51], v[160:163], v[192:195], v[48:51]
    ds_read_b128 v[160:163], v3 offset:57344
    s_waitcnt lgkmcnt(5)
    v_mfma_f32_16x16x32_bf16 v[76:79], v[224:227], v[116:119], v[76:79]
    v_mfma_f32_16x16x32_bf16 v[76:79], v[204:207], v[252:255], v[76:79]
    v_mfma_f32_16x16x32_bf16 v[76:79], v[180:183], v[128:131], v[76:79]
    v_mfma_f32_16x16x32_bf16 v[76:79], v[244:247], v[200:203], v[76:79]
    s_waitcnt lgkmcnt(4)
    v_mfma_f32_16x16x32_bf16 v[76:79], v[240:243], v[164:167], v[76:79]
    v_mfma_f32_16x16x32_bf16 v[80:83], v[224:227], v[252:255], v[80:83]
    v_mfma_f32_16x16x32_bf16 v[80:83], v[204:207], v[128:131], v[80:83]
    v_mfma_f32_16x16x32_bf16 v[80:83], v[180:183], v[200:203], v[80:83]
    v_mfma_f32_16x16x32_bf16 v[80:83], v[244:247], v[164:167], v[80:83]
    v_mfma_f32_16x16x32_bf16 v[80:83], v[240:243], v[220:223], v[80:83]
    v_mfma_f32_16x16x32_bf16 v[84:87], v[224:227], v[128:131], v[84:87]
    ds_read_b128 v[224:227], v3 offset:59392
    v_mfma_f32_16x16x32_bf16 v[84:87], v[204:207], v[200:203], v[84:87]
    ds_read_b128 v[204:207], v6 offset:0
    v_fmac_f32 v40, s57, v76
    v_mfma_f32_16x16x32_bf16 v[84:87], v[180:183], v[164:167], v[84:87]
    ds_read_b128 v[180:183], v6 offset:2048
    v_fmac_f32 v41, s57, v77
    v_mfma_f32_16x16x32_bf16 v[84:87], v[244:247], v[220:223], v[84:87]
    ds_read_b128 v[244:247], v6 offset:4096
    v_fmac_f32 v42, s57, v78
    v_mfma_f32_16x16x32_bf16 v[84:87], v[240:243], v[212:215], v[84:87]
    ds_read_b128 v[240:243], v6 offset:6144
    v_fmac_f32 v43, s57, v79
    s_waitcnt lgkmcnt(5)
    v_mfma_f32_16x16x32_bf16 v[52:55], v[184:187], v[228:231], v[52:55]
    ds_read_b128 v[228:231], v6 offset:8192
    v_fmac_f32 v76, s58, v40
    v_mfma_f32_16x16x32_bf16 v[52:55], v[124:127], v[148:151], v[52:55]
    v_fmac_f32 v77, s58, v41
    v_fmac_f32 v78, s58, v42
    v_mfma_f32_16x16x32_bf16 v[52:55], v[136:139], v[152:155], v[52:55]
    v_fmac_f32 v79, s58, v43
    v_cvt_pk_bf16_f32 v40, v40, v41
    v_mfma_f32_16x16x32_bf16 v[52:55], v[160:163], v[188:191], v[52:55]
    v_cvt_pk_bf16_f32 v41, v42, v43
    ds_write_b64 v15, v[40:41] offset:12288
    s_waitcnt lgkmcnt(6)
    v_mfma_f32_16x16x32_bf16 v[52:55], v[224:227], v[112:115], v[52:55]
    v_cvt_pk_bf16_f32 v76, v76, v77
    v_cvt_pk_bf16_f32 v77, v78, v79
    v_mfma_f32_16x16x32_bf16 v[56:59], v[184:187], v[148:151], v[56:59]
    ds_write_b64 v15, v[76:77] offset:12800
    v_fmac_f32 v44, s57, v80
    v_mfma_f32_16x16x32_bf16 v[56:59], v[124:127], v[152:155], v[56:59]
    v_fmac_f32 v45, s57, v81
    v_fmac_f32 v46, s57, v82
    v_mfma_f32_16x16x32_bf16 v[56:59], v[136:139], v[188:191], v[56:59]
    v_fmac_f32 v47, s57, v83
    v_fmac_f32 v80, s58, v44
    v_mfma_f32_16x16x32_bf16 v[56:59], v[160:163], v[112:115], v[56:59]
    v_fmac_f32 v81, s58, v45
    v_fmac_f32 v82, s58, v46
    v_mfma_f32_16x16x32_bf16 v[56:59], v[224:227], v[156:159], v[56:59]
    s_waitcnt lgkmcnt(0)
    s_barrier
    v_mfma_f32_16x16x32_bf16 v[60:63], v[184:187], v[152:155], v[60:63]
    ds_read_b128 v[148:151], v6 offset:10240
    v_fmac_f32 v83, s58, v47
    v_mfma_f32_16x16x32_bf16 v[60:63], v[124:127], v[188:191], v[60:63]
    ds_read_b128 v[152:155], v6 offset:12288
    v_cvt_pk_bf16_f32 v44, v44, v45
    v_mfma_f32_16x16x32_bf16 v[60:63], v[136:139], v[112:115], v[60:63]
    ds_read_b128 v[184:187], v6 offset:14336
    v_cvt_pk_bf16_f32 v45, v46, v47
    v_mfma_f32_16x16x32_bf16 v[60:63], v[160:163], v[156:159], v[60:63]
    ds_read_b128 v[188:191], v6 offset:16384
    ds_write_b64 v15, v[44:45] offset:13312
    v_mfma_f32_16x16x32_bf16 v[60:63], v[224:227], v[236:239], v[60:63]
    ds_read_b128 v[124:127], v6 offset:18432
    v_cvt_pk_bf16_f32 v80, v80, v81
    v_mfma_f32_16x16x32_bf16 v[88:91], v[204:207], v[208:211], v[88:91]
    ds_read_b128 v[112:115], v6 offset:20480
    v_cvt_pk_bf16_f32 v81, v82, v83
    v_mfma_f32_16x16x32_bf16 v[88:91], v[180:183], v[216:219], v[88:91]
    ds_read_b128 v[136:139], v6 offset:22528
    ds_write_b64 v15, v[80:81] offset:13824
    v_mfma_f32_16x16x32_bf16 v[88:91], v[244:247], v[172:175], v[88:91]
    ds_read_b128 v[156:159], v6 offset:24576
    v_fmac_f32 v48, s57, v84
    v_mfma_f32_16x16x32_bf16 v[88:91], v[240:243], v[196:199], v[88:91]
    ds_read_b128 v[160:163], v6 offset:26624
    v_fmac_f32 v49, s57, v85
    v_mfma_f32_16x16x32_bf16 v[88:91], v[228:231], v[176:179], v[88:91]
    ds_read_b128 v[236:239], v6 offset:28672
    v_fmac_f32 v50, s57, v86
    v_mfma_f32_16x16x32_bf16 v[92:95], v[204:207], v[216:219], v[92:95]
    v_fmac_f32 v51, s57, v87
    v_fmac_f32 v84, s58, v48
    v_mfma_f32_16x16x32_bf16 v[92:95], v[180:183], v[172:175], v[92:95]
    s_waitcnt lgkmcnt(3)
    s_barrier
    v_mfma_f32_16x16x32_bf16 v[92:95], v[244:247], v[196:199], v[92:95]
    v_fmac_f32 v85, s58, v49
    v_fmac_f32 v86, s58, v50
    v_mfma_f32_16x16x32_bf16 v[92:95], v[240:243], v[176:179], v[92:95]
    v_fmac_f32 v87, s58, v51
    v_cvt_pk_bf16_f32 v48, v48, v49
    v_mfma_f32_16x16x32_bf16 v[92:95], v[228:231], v[168:171], v[92:95]
    v_cvt_pk_bf16_f32 v49, v50, v51
    ds_write_b64 v15, v[48:49] offset:14336
    v_mfma_f32_16x16x32_bf16 v[96:99], v[204:207], v[172:175], v[96:99]
    v_cvt_pk_bf16_f32 v84, v84, v85
    v_cvt_pk_bf16_f32 v85, v86, v87
    v_mfma_f32_16x16x32_bf16 v[96:99], v[180:183], v[196:199], v[96:99]
    ds_write_b64 v15, v[84:85] offset:14848
    v_mfma_f32_16x16x32_bf16 v[96:99], v[244:247], v[176:179], v[96:99]
    v_mfma_f32_16x16x32_bf16 v[96:99], v[240:243], v[168:171], v[96:99]
    v_mfma_f32_16x16x32_bf16 v[96:99], v[228:231], v[132:135], v[96:99]
    v_mfma_f32_16x16x32_bf16 v[52:55], v[148:151], v[232:235], v[52:55]
    s_waitcnt lgkmcnt(0)
    s_barrier
    v_mfma_f32_16x16x32_bf16 v[52:55], v[152:155], v[108:111], v[52:55]
    v_mfma_f32_16x16x32_bf16 v[52:55], v[184:187], v[140:143], v[52:55]
    v_mfma_f32_16x16x32_bf16 v[52:55], v[188:191], v[120:123], v[52:55]
    v_mfma_f32_16x16x32_bf16 v[52:55], v[124:127], v[248:251], v[52:55]
    v_mfma_f32_16x16x32_bf16 v[88:91], v[112:115], v[116:119], v[88:91]
    v_mfma_f32_16x16x32_bf16 v[88:91], v[136:139], v[252:255], v[88:91]
    v_mfma_f32_16x16x32_bf16 v[88:91], v[156:159], v[128:131], v[88:91]
    v_mfma_f32_16x16x32_bf16 v[88:91], v[160:163], v[200:203], v[88:91]
    v_mfma_f32_16x16x32_bf16 v[88:91], v[236:239], v[164:167], v[88:91]
    v_mfma_f32_16x16x32_bf16 v[56:59], v[148:151], v[108:111], v[56:59]
    v_mfma_f32_16x16x32_bf16 v[56:59], v[152:155], v[140:143], v[56:59]
    v_mfma_f32_16x16x32_bf16 v[56:59], v[184:187], v[120:123], v[56:59]
    v_mfma_f32_16x16x32_bf16 v[56:59], v[188:191], v[248:251], v[56:59]
    v_mfma_f32_16x16x32_bf16 v[56:59], v[124:127], v[144:147], v[56:59]
    v_mfma_f32_16x16x32_bf16 v[92:95], v[112:115], v[252:255], v[92:95]
    v_mfma_f32_16x16x32_bf16 v[92:95], v[136:139], v[128:131], v[92:95]
    v_mfma_f32_16x16x32_bf16 v[92:95], v[156:159], v[200:203], v[92:95]
    v_fmac_f32 v52, s57, v88
    v_fmac_f32 v53, s57, v89
    v_mfma_f32_16x16x32_bf16 v[92:95], v[160:163], v[164:167], v[92:95]
    v_fmac_f32 v54, s57, v90
    v_fmac_f32 v55, s57, v91
    v_mfma_f32_16x16x32_bf16 v[92:95], v[236:239], v[220:223], v[92:95]
    v_fmac_f32 v88, s58, v52
    v_fmac_f32 v89, s58, v53
    v_mfma_f32_16x16x32_bf16 v[60:63], v[148:151], v[140:143], v[60:63]
    v_fmac_f32 v90, s58, v54
    v_fmac_f32 v91, s58, v55
    v_mfma_f32_16x16x32_bf16 v[60:63], v[152:155], v[120:123], v[60:63]
    v_cvt_pk_bf16_f32 v52, v52, v53
    v_cvt_pk_bf16_f32 v53, v54, v55
    v_mfma_f32_16x16x32_bf16 v[60:63], v[184:187], v[248:251], v[60:63]
    ds_write_b64 v15, v[52:53] offset:0
    v_cvt_pk_bf16_f32 v88, v88, v89
    v_mfma_f32_16x16x32_bf16 v[60:63], v[188:191], v[144:147], v[60:63]
    v_cvt_pk_bf16_f32 v89, v90, v91
    ds_write_b64 v15, v[88:89] offset:512
    v_mfma_f32_16x16x32_bf16 v[60:63], v[124:127], v[192:195], v[60:63]
    v_fmac_f32 v56, s57, v92
    v_fmac_f32 v57, s57, v93
    v_mfma_f32_16x16x32_bf16 v[96:99], v[112:115], v[128:131], v[96:99]
    v_fmac_f32 v58, s57, v94
    v_fmac_f32 v59, s57, v95
    v_mfma_f32_16x16x32_bf16 v[96:99], v[136:139], v[200:203], v[96:99]
    v_fmac_f32 v92, s58, v56
    v_fmac_f32 v93, s58, v57
    v_mfma_f32_16x16x32_bf16 v[96:99], v[156:159], v[164:167], v[96:99]
    v_fmac_f32 v94, s58, v58
    v_fmac_f32 v95, s58, v59
    v_mfma_f32_16x16x32_bf16 v[96:99], v[160:163], v[220:223], v[96:99]
    s_waitcnt lgkmcnt(0)
    s_barrier
    v_mfma_f32_16x16x32_bf16 v[96:99], v[236:239], v[212:215], v[96:99]
    v_cvt_pk_bf16_f32 v56, v56, v57
    v_cvt_pk_bf16_f32 v57, v58, v59
    ds_write_b64 v15, v[56:57] offset:1024
    v_cvt_pk_bf16_f32 v92, v92, v93
    v_cvt_pk_bf16_f32 v93, v94, v95
    ds_write_b64 v15, v[92:93] offset:1536
    s_nop 2
    v_fmac_f32 v60, s57, v96
    v_fmac_f32 v61, s57, v97
    v_fmac_f32 v62, s57, v98
    v_fmac_f32 v63, s57, v99
    v_fmac_f32 v96, s58, v60
    v_fmac_f32 v97, s58, v61
    v_fmac_f32 v98, s58, v62
    v_fmac_f32 v99, s58, v63
    v_cvt_pk_bf16_f32 v60, v60, v61
    v_cvt_pk_bf16_f32 v61, v62, v63
    s_waitcnt lgkmcnt(0)
    s_barrier
    ds_write_b64 v15, v[60:61] offset:2048
    v_cvt_pk_bf16_f32 v96, v96, v97
    v_cvt_pk_bf16_f32 v97, v98, v99
    ds_write_b64 v15, v[96:97] offset:2560
    s_waitcnt lgkmcnt(0)
    s_endpgm
L_slow:
    s_mov_b32 s59, 0
L_slow1:
    buffer_load_dword v19, v20, s[28:31], 0 offen sc1
    s_waitcnt vmcnt(0)
    v_cmp_eq_u32 vcc, 0x1, v19
    s_cmp_eq_u64 vcc, 3
    s_cbranch_scc1 L_ready
    s_sleep 6
    s_add_u32 s59, s59, 1
    s_cmp_lt_u32 s59, 2000
    s_cbranch_scc1 L_slow1
    s_add_u32 s100, s47, 133120
    s_mov_b32 s59, 0
L_slow2:
    s_mul_i32 s46, s59, 3641
    s_lshr_b32 s46, s46, 16
    s_mul_i32 s47, s46, 18
    s_sub_u32 s47, s59, s47
    s_cmp_ge_u32 s46, 5
    s_cselect_b32 s48, 5, 0
    s_cselect_b32 s50, 1, 5
    s_cselect_b32 s51, 5, 1
    s_sub_u32 s49, s46, s48
    s_mul_i32 s50, s50, s49
    s_mul_i32 s50, s50, 18432
    s_mul_i32 s51, s51, 18432
    s_mul_i32 s56, s47, 86
    s_lshr_b32 s56, s56, 8
    s_mul_i32 s57, s56, 3072 - 192
    s_lshl_b32 s58, s47, 6
    s_add_u32 s50, s50, s57
    s_add_u32 s50, s50, s58
    v_lshrrev_b32 v252, 2, v0
    v_mul_u32_u24 v252, 192, v252
    v_and_b32 v253, 3, v0
    v_lshl_add_u32 v252, v253, 4, v252
    s_waitcnt vmcnt(0)
    buffer_load_dwordx4 v[188:191], v252, s[16:19], s50 offen
    s_add_u32 s50, s50, s51
    buffer_load_dwordx4 v[196:199], v252, s[16:19], s50 offen
    s_add_u32 s50, s50, s51
    buffer_load_dwordx4 v[204:207], v252, s[16:19], s50 offen
    s_add_u32 s50, s50, s51
    buffer_load_dwordx4 v[212:215], v252, s[16:19], s50 offen
    s_add_u32 s50, s50, s51
    buffer_load_dwordx4 v[220:223], v252, s[16:19], s50 offen
    s_lshl_b32 s48, s48, 2
    s_add_u32 s48, s48, s49
    s_mul_i32 s48, s48, 18432
    s_mul_i32 s58, s56, 3
    s_sub_u32 s58, s47, s58
    s_lshl_b32 s58, s58, 11
    s_add_u32 s48, s48, s58
    s_lshr_b32 s58, s56, 1
    s_mul_i32 s58, s58, 6144
    s_add_u32 s48, s48, s58
    s_and_b32 s58, s56, 1
    s_lshl_b32 s58, s58, 9
    s_add_u32 s48, s48, s58
    s_mov_b32 s47, 0xffff0000
    v_lshlrev_b32 v253, 4, v0
    v_add_u32 v255, s100, v253
    v_bfe_u32 v254, v0, 2, 2
    v_bfe_u32 v224, v0, 4, 1
    v_lshl_add_u32 v254, v224, 3, v254
    v_lshlrev_b32 v254, 6, v254
    v_and_b32 v224, 3, v0
    v_lshl_add_u32 v254, v224, 3, v254
    v_and_b32 v224, 32, v0
    v_add_u32 v254, v254, v224
    v_add_u32 v254, s100, v254
    v_lshl_add_u32 v253, v224, 4, v253
    s_mov_b32 s50, 0x3e572045
    s_mov_b32 s51, 0xbf303b34
    s_waitcnt vmcnt(4)
    v_lshlrev_b32 v224, 16, v188
    v_and_b32 v225, s47, v188
    v_lshlrev_b32 v226, 16, v189
    v_and_b32 v227, s47, v189
    v_lshlrev_b32 v228, 16, v190
    v_and_b32 v229, s47, v190
    v_lshlrev_b32 v230, 16, v191
    v_and_b32 v231, s47, v191
    v_mul_f32 v232, s50, v224
    v_mul_f32 v233, s50, v225
    v_mul_f32 v234, s50, v226
    v_mul_f32 v235, s50, v227
    v_mul_f32 v236, s50, v228
    v_mul_f32 v237, s50, v229
    v_mul_f32 v238, s50, v230
    v_mul_f32 v239, s50, v231
    v_mul_f32 v184, s51, v224
    v_mul_f32 v185, s51, v225
    v_mul_f32 v186, s51, v226
    v_mul_f32 v187, s51, v227
    v_mul_f32 v192, s51, v228
    v_mul_f32 v193, s51, v229
    v_mul_f32 v194, s51, v230
    v_mul_f32 v195, s51, v231
    s_mov_b32 s50, 0x3ea15834
    s_mov_b32 s51, 0xbedc4a01
    s_waitcnt vmcnt(3)
    v_lshlrev_b32 v224, 16, v196
    v_and_b32 v225, s47, v196
    v_lshlrev_b32 v226, 16, v197
    v_and_b32 v227, s47, v197
    v_lshlrev_b32 v228, 16, v198
    v_and_b32 v229, s47, v198
    v_lshlrev_b32 v230, 16, v199
    v_and_b32 v231, s47, v199
    v_mul_f32 v240, s50, v224
    v_mul_f32 v241, s50, v225
    v_mul_f32 v242, s50, v226
    v_mul_f32 v243, s50, v227
    v_mul_f32 v244, s50, v228
    v_mul_f32 v245, s50, v229
    v_mul_f32 v246, s50, v230
    v_mul_f32 v247, s50, v231
    v_mul_f32 v200, s51, v224
    v_mul_f32 v201, s51, v225
    v_mul_f32 v202, s51, v226
    v_mul_f32 v203, s51, v227
    v_mul_f32 v208, s51, v228
    v_mul_f32 v209, s51, v229
    v_mul_f32 v210, s51, v230
    v_mul_f32 v211, s51, v231
    s_mov_b32 s50, 0x3ef2044d
    s_mov_b32 s51, 0xbe89ae41
    s_waitcnt vmcnt(2)
    v_lshlrev_b32 v224, 16, v204
    v_and_b32 v225, s47, v204
    v_lshlrev_b32 v226, 16, v205
    v_and_b32 v227, s47, v205
    v_lshlrev_b32 v228, 16, v206
    v_and_b32 v229, s47, v206
    v_lshlrev_b32 v230, 16, v207
    v_and_b32 v231, s47, v207
    v_fmac_f32 v232, s50, v224
    v_fmac_f32 v233, s50, v225
    v_fmac_f32 v234, s50, v226
    v_fmac_f32 v235, s50, v227
    v_fmac_f32 v236, s50, v228
    v_fmac_f32 v237, s50, v229
    v_fmac_f32 v238, s50, v230
    v_fmac_f32 v239, s50, v231
    v_fmac_f32 v184, s51, v224
    v_fmac_f32 v185, s51, v225
    v_fmac_f32 v186, s51, v226
    v_fmac_f32 v187, s51, v227
    v_fmac_f32 v192, s51, v228
    v_fmac_f32 v193, s51, v229
    v_fmac_f32 v194, s51, v230
    v_fmac_f32 v195, s51, v231
    s_mov_b32 s50, 0x3f35833a
    s_mov_b32 s51, 0xbe2c19d1
    s_waitcnt vmcnt(1)
    v_lshlrev_b32 v224, 16, v212
    v_and_b32 v225, s47, v212
    v_lshlrev_b32 v226, 16, v213
    v_and_b32 v227, s47, v213
    v_lshlrev_b32 v228, 16, v214
    v_and_b32 v229, s47, v214
    v_lshlrev_b32 v230, 16, v215
    v_and_b32 v231, s47, v215
    v_fmac_f32 v240, s50, v224
    v_fmac_f32 v241, s50, v225
    v_fmac_f32 v242, s50, v226
    v_fmac_f32 v243, s50, v227
    v_fmac_f32 v244, s50, v228
    v_fmac_f32 v245, s50, v229
    v_fmac_f32 v246, s50, v230
    v_fmac_f32 v247, s50, v231
    v_fmac_f32 v200, s51, v224
    v_fmac_f32 v201, s51, v225
    v_fmac_f32 v202, s51, v226
    v_fmac_f32 v203, s51, v227
    v_fmac_f32 v208, s51, v228
    v_fmac_f32 v209, s51, v229
    v_fmac_f32 v210, s51, v230
    v_fmac_f32 v211, s51, v231
    s_mov_b32 s50, 0x3f88226c
    s_mov_b32 s51, 0xbdd72045
    s_waitcnt vmcnt(0)
    v_lshlrev_b32 v224, 16, v220
    v_and_b32 v225, s47, v220
    v_lshlrev_b32 v226, 16, v221
    v_and_b32 v227, s47, v221
    v_lshlrev_b32 v228, 16, v222
    v_and_b32 v229, s47, v222
    v_lshlrev_b32 v230, 16, v223
    v_and_b32 v231, s47, v223
    v_fmac_f32 v232, s50, v224
    v_fmac_f32 v233, s50, v225
    v_fmac_f32 v234, s50, v226
    v_fmac_f32 v235, s50, v227
    v_fmac_f32 v236, s50, v228
    v_fmac_f32 v237, s50, v229
    v_fmac_f32 v238, s50, v230
    v_fmac_f32 v239, s50, v231
    v_fmac_f32 v184, s51, v224
    v_fmac_f32 v185, s51, v225
    v_fmac_f32 v186, s51, v226
    v_fmac_f32 v187, s51, v227
    v_fmac_f32 v192, s51, v228
    v_fmac_f32 v193, s51, v229
    v_fmac_f32 v194, s51, v230
    v_fmac_f32 v195, s51, v231
    s_mov_b32 s50, 0xbfa00000
    v_add_f32 v224, v232, v240
    v_add_f32 v225, v233, v241
    v_add_f32 v226, v234, v242
    v_add_f32 v227, v235, v243
    v_add_f32 v228, v236, v244
    v_add_f32 v229, v237, v245
    v_add_f32 v230, v238, v246
    v_add_f32 v231, v239, v247
    v_sub_f32 v240, v232, v240
    v_sub_f32 v241, v233, v241
    v_sub_f32 v242, v234, v242
    v_sub_f32 v243, v235, v243
    v_sub_f32 v244, v236, v244
    v_sub_f32 v245, v237, v245
    v_sub_f32 v246, v238, v246
    v_sub_f32 v247, v239, v247
    v_cvt_pk_bf16_f32 v188, v224, v225
    v_cvt_pk_bf16_f32 v189, v226, v227
    v_cvt_pk_bf16_f32 v190, v228, v229
    v_cvt_pk_bf16_f32 v191, v230, v231
    ds_write_b128 v255, v[188:191] offset:0
    v_cvt_pk_bf16_f32 v196, v240, v241
    v_cvt_pk_bf16_f32 v197, v242, v243
    v_cvt_pk_bf16_f32 v198, v244, v245
    v_cvt_pk_bf16_f32 v199, v246, v247
    ds_write_b128 v255, v[196:199] offset:1024
    ds_read_b64_tr_b16 v[232:233], v254 offset:0
    ds_read_b64_tr_b16 v[234:235], v254 offset:256
    ds_read_b64_tr_b16 v[236:237], v254 offset:1024
    ds_read_b64_tr_b16 v[238:239], v254 offset:1280
    v_add_f32 v224, v184, v200
    v_add_f32 v225, v185, v201
    v_add_f32 v226, v186, v202
    v_add_f32 v227, v187, v203
    v_add_f32 v228, v192, v208
    v_add_f32 v229, v193, v209
    v_add_f32 v230, v194, v210
    v_add_f32 v231, v195, v211
    v_sub_f32 v200, v184, v200
    v_sub_f32 v201, v185, v201
    v_sub_f32 v202, v186, v202
    v_sub_f32 v203, v187, v203
    v_sub_f32 v208, v192, v208
    v_sub_f32 v209, v193, v209
    v_sub_f32 v210, v194, v210
    v_sub_f32 v211, v195, v211
    v_cvt_pk_bf16_f32 v204, v224, v225
    v_cvt_pk_bf16_f32 v205, v226, v227
    v_cvt_pk_bf16_f32 v206, v228, v229
    v_cvt_pk_bf16_f32 v207, v230, v231
    ds_write_b128 v255, v[204:207] offset:2048
    v_mul_f32 v200, s50, v200
    v_mul_f32 v201, s50, v201
    v_mul_f32 v202, s50, v202
    v_mul_f32 v203, s50, v203
    v_mul_f32 v208, s50, v208
    v_mul_f32 v209, s50, v209
    v_mul_f32 v210, s50, v210
    v_mul_f32 v211, s50, v211
    v_cvt_pk_bf16_f32 v212, v200, v201
    v_cvt_pk_bf16_f32 v213, v202, v203
    v_cvt_pk_bf16_f32 v214, v208, v209
    v_cvt_pk_bf16_f32 v215, v210, v211
    ds_write_b128 v255, v[212:215] offset:3072
    ds_read_b64_tr_b16 v[240:241], v254 offset:2048
    ds_read_b64_tr_b16 v[242:243], v254 offset:2304
    ds_read_b64_tr_b16 v[244:245], v254 offset:3072
    ds_read_b64_tr_b16 v[246:247], v254 offset:3328
    s_waitcnt lgkmcnt(8)
    buffer_store_dwordx4 v[232:235], v253, s[24:27], s48 offen sc1
    s_add_u32 s48, s48, 92160
    s_waitcnt lgkmcnt(6)
    buffer_store_dwordx4 v[236:239], v253, s[24:27], s48 offen sc1
    s_add_u32 s48, s48, 92160
    s_waitcnt lgkmcnt(2)
    buffer_store_dwordx4 v[240:243], v253, s[24:27], s48 offen sc1
    s_add_u32 s48, s48, 92160
    s_waitcnt lgkmcnt(0)
    buffer_store_dwordx4 v[244:247], v253, s[24:27], s48 offen sc1
    s_add_u32 s59, s59, 1
    s_cmp_lt_u32 s59, 180
    s_cbranch_scc1 L_slow2
    s_sub_u32 s47, s100, 133120
    s_waitcnt vmcnt(0)
    v_mfma_f32_16x16x32_bf16 v[36:39], v[84:87], v[32:35], 0
    v_mfma_f32_16x16x32_bf16 v[40:43], v[88:91], v[32:35], 0
    v_mfma_f32_16x16x32_bf16 v[44:47], v[92:95], v[32:35], 0
    v_mfma_f32_16x16x32_bf16 v[48:51], v[96:99], v[32:35], 0
    s_nop 5
    v_cvt_pk_bf16_f32 v172, v36, v37
    v_cvt_pk_bf16_f32 v173, v38, v39
    v_cvt_pk_bf16_f32 v174, v40, v41
    v_cvt_pk_bf16_f32 v175, v42, v43
    v_cvt_pk_bf16_f32 v200, v44, v45
    v_cvt_pk_bf16_f32 v201, v46, v47
    v_cvt_pk_bf16_f32 v202, v48, v49
    v_cvt_pk_bf16_f32 v203, v50, v51
    v_mfma_f32_16x16x32_bf16 v[36:39], v[68:71], v[176:179], 0
    v_mfma_f32_16x16x32_bf16 v[40:43], v[72:75], v[176:179], 0
    v_mfma_f32_16x16x32_bf16 v[44:47], v[76:79], v[176:179], 0
    v_mfma_f32_16x16x32_bf16 v[48:51], v[80:83], v[176:179], 0
    s_nop 5
    v_cvt_pk_bf16_f32 v224, v36, v37
    v_cvt_pk_bf16_f32 v225, v38, v39
    v_cvt_pk_bf16_f32 v226, v40, v41
    v_cvt_pk_bf16_f32 v227, v42, v43
    v_cvt_pk_bf16_f32 v228, v44, v45
    v_cvt_pk_bf16_f32 v229, v46, v47
    v_cvt_pk_bf16_f32 v230, v48, v49
    v_cvt_pk_bf16_f32 v231, v50, v51
    v_mfma_f32_16x16x32_bf16 v[36:39], v[84:87], v[176:179], 0
    v_mfma_f32_16x16x32_bf16 v[40:43], v[88:91], v[176:179], 0
    v_mfma_f32_16x16x32_bf16 v[44:47], v[92:95], v[176:179], 0
    v_mfma_f32_16x16x32_bf16 v[48:51], v[96:99], v[176:179], 0
    s_nop 5
    v_cvt_pk_bf16_f32 v232, v36, v37
    v_cvt_pk_bf16_f32 v233, v38, v39
    v_cvt_pk_bf16_f32 v234, v40, v41
    v_cvt_pk_bf16_f32 v235, v42, v43
    v_cvt_pk_bf16_f32 v236, v44, v45
    v_cvt_pk_bf16_f32 v237, v46, v47
    v_cvt_pk_bf16_f32 v238, v48, v49
    v_cvt_pk_bf16_f32 v239, v50, v51
    v_mfma_f32_16x16x32_bf16 v[36:39], v[100:103], v[32:35], 0
    v_mfma_f32_16x16x32_bf16 v[40:43], v[104:107], v[32:35], 0
    v_mfma_f32_16x16x32_bf16 v[44:47], v[108:111], v[32:35], 0
    v_mfma_f32_16x16x32_bf16 v[48:51], v[112:115], v[32:35], 0
    s_nop 5
    v_cvt_pk_bf16_f32 v240, v36, v37
    v_cvt_pk_bf16_f32 v241, v38, v39
    v_cvt_pk_bf16_f32 v242, v40, v41
    v_cvt_pk_bf16_f32 v243, v42, v43
    v_cvt_pk_bf16_f32 v244, v44, v45
    v_cvt_pk_bf16_f32 v245, v46, v47
    v_cvt_pk_bf16_f32 v246, v48, v49
    v_cvt_pk_bf16_f32 v247, v50, v51
    v_mfma_f32_16x16x32_bf16 v[36:39], v[116:119], v[32:35], 0
    v_mfma_f32_16x16x32_bf16 v[40:43], v[120:123], v[32:35], 0
    v_mfma_f32_16x16x32_bf16 v[44:47], v[124:127], v[32:35], 0
    v_mfma_f32_16x16x32_bf16 v[48:51], v[128:131], v[32:35], 0
    s_nop 5
    v_cvt_pk_bf16_f32 v248, v36, v37
    v_cvt_pk_bf16_f32 v249, v38, v39
    v_cvt_pk_bf16_f32 v250, v40, v41
    v_cvt_pk_bf16_f32 v251, v42, v43
    v_cvt_pk_bf16_f32 v252, v44, v45
    v_cvt_pk_bf16_f32 v253, v46, v47
    v_cvt_pk_bf16_f32 v254, v48, v49
    v_cvt_pk_bf16_f32 v255, v50, v51
    s_branch L_ready
.fill (51456 - (. - standalone__dilated_atrous__vision_kernel)) / 4, 4, 0xbf800000
    s_endpgm
.section .rodata,"a"
.p2align 6
.amdhsa_kernel standalone__dilated_atrous__vision_kernel
  .amdhsa_next_free_vgpr 256
  .amdhsa_next_free_sgpr 102
  .amdhsa_accum_offset 256
  .amdhsa_group_segment_fixed_size 0
  .amdhsa_kernarg_size 40
  .amdhsa_user_sgpr_count 2
  .amdhsa_user_sgpr_kernarg_segment_ptr 1
  .amdhsa_system_sgpr_workgroup_id_x 1
  .amdhsa_float_denorm_mode_32 3
.end_amdhsa_kernel
```
